```python
import torch

def _softmax(x, axis=-1):
    return torch.softmax(x, dim=axis)
def _gelu(x):
    return torch.nn.functional.gelu(x, approximate="tanh")
def _silu(x):
    return torch.nn.functional.silu(x)
def _sigmoid(x):
    return torch.sigmoid(x)
def _layernorm(x, axis=-1, eps=1e-5):
    m = x.mean(dim=axis, keepdim=True)
    v = x.var(dim=axis, keepdim=True, unbiased=False)
    return (x - m) / torch.sqrt(v + eps)
def _scatter_add(tgt, idx, src, axis=0):
    return tgt.clone().index_add_(axis, idx, src)
def _segment_sum(src, seg, n):
    out = torch.zeros((n,) + src.shape[1:], dtype=src.dtype)
    return out.index_add_(0, seg, src)
def _pad(x, pw):
    flat = tuple(v for pair in reversed(pw) for v in pair)
    return torch.nn.functional.pad(x, flat)

kernel_name = 'recurrent_scan__ssm_conv_s4d__mixer_channel_mlp__prompt'

def setup_inputs():

    _w = (lambda a: (lambda t: t.to(torch.bfloat16) if t.is_floating_point() else t)(torch.as_tensor(a)))
    def _A_setup():
        Bsz, L, D, N = 1, 2048, 640, 128
        return {
            "u": _w((lambda *s: torch.randn(*s, dtype=torch.bfloat16) * 0.05)(Bsz, L, D)),
            "log_A_real": _w((lambda *s: torch.randn(*s, dtype=torch.bfloat16) * 3.2)(D, N) * 0.5),
            "A_imag": _w((lambda *s: torch.randn(*s, dtype=torch.bfloat16) * 0.2)(D, N) * 3.14),
            "C_real": _w((lambda *s: torch.randn(*s, dtype=torch.bfloat16) * 0.8)(D, N) / N ** 0.5),
            "C_imag": _w((lambda *s: torch.randn(*s, dtype=torch.bfloat16) * 0.8)(D, N) / N ** 0.5),
            "log_dt": _w((lambda *s: torch.randn(*s, dtype=torch.bfloat16) * 0.2)(D) * 0.5 - 4.0),
            "D_skip": _w((lambda *s: torch.randn(*s, dtype=torch.bfloat16) * 0.2)(D)),
        }
    _A_in = _A_setup()

    def _B_setup():
        B, S, D, F = 1, 2048, 640, 1728
        return {
            "x": _w((lambda *s: torch.randn(*s, dtype=torch.bfloat16) * 0.05)(B, S, D)),
            "w1": _w((lambda *s: torch.randn(*s, dtype=torch.bfloat16) * 1.6)(D, F) * (D ** -0.5)),
            "b1": _w((lambda *s: torch.randn(*s, dtype=torch.bfloat16) * 0.8)(F)),
            "w2": _w((lambda *s: torch.randn(*s, dtype=torch.bfloat16) * 0.1)(F, D) * (F ** -0.5)),
            "b2": _w((lambda *s: torch.randn(*s, dtype=torch.bfloat16) * 0.1)(D)),
        }
    _B_in = _B_setup()

    return {
        "A_u": _A_in["u"],
        "A_log_A_real": _A_in["log_A_real"],
        "A_A_imag": _A_in["A_imag"],
        "A_C_real": _A_in["C_real"],
        "A_C_imag": _A_in["C_imag"],
        "A_log_dt": _A_in["log_dt"],
        "A_D_skip": _A_in["D_skip"],
        "B_x": _B_in["x"],
        "B_w1": _B_in["w1"],
        "B_b1": _B_in["b1"],
        "B_w2": _B_in["w2"],
        "B_b2": _B_in["b2"],
    }

def reference(A_u, A_log_A_real, A_A_imag, A_C_real, A_C_imag, A_log_dt, A_D_skip, B_x, B_w1, B_b1, B_w2, B_b2):
    def _A_ref(u, log_A_real, A_imag, C_real, C_imag, log_dt, D_skip):
        L = u.shape[1]
        dt = torch.exp(log_dt)
        A = -torch.exp(log_A_real) + 1j * A_imag
        C = (C_real + 1j * C_imag) * dt[:, None]
        pos = (lambda x, dt: x.to(dt))(torch.arange(L), log_dt.dtype)
        P = torch.exp((A * dt[:, None])[:, :, None] * pos[None, None, :])
        K = 2.0 * torch.einsum("dn,dnl->dl", C, P).real
        L2 = 2 * L
        u_t = (lambda x, *d: x.permute(*d))(u, 0, 2, 1)
        Kf = (lambda x, *a, **k: torch.fft.rfft(x.float(), *a, **k))(K, L2)
        Uf = (lambda x, *a, **k: torch.fft.rfft(x.float(), *a, **k))(u_t, L2)
        y = (lambda x, *a, **k: torch.fft.irfft(x, *a, **k).to(torch.bfloat16))(Uf * Kf[None, :, :], L2)[:, :, :L]
        y = (lambda x, *d: x.permute(*d))(y, 0, 2, 1)
        return y + u * D_skip[None, None, :]

    def _B_ref(x, w1, b1, w2, b2):
        y = _layernorm(x, axis=-1)
        h = _gelu(torch.einsum("bsd,df->bsf", y, w1) + b1)
        return torch.einsum("bsf,fd->bsd", h, w2) + b2

    x = A_u
    xn = _layernorm(x, axis=-1)
    s = _A_ref(xn, A_log_A_real, A_A_imag, A_C_real, A_C_imag, A_log_dt, A_D_skip)
    g = _silu(_B_ref(xn, B_w1, B_b1, B_w2, B_b2))
    return x + s * g
```

```asm
; @launch grid=(256,1,1) block=(256,1,1) lds=163840
.amdgcn_target "amdgcn-amd-amdhsa--gfx950"
.text
.globl recurrent_scan__ssm_conv_s4d__mixer_channel_mlp__prompt_kernel
.p2align 8
.type recurrent_scan__ssm_conv_s4d__mixer_channel_mlp__prompt_kernel,@function
recurrent_scan__ssm_conv_s4d__mixer_channel_mlp__prompt_kernel:
    s_cmp_ge_u32 s2, 256
    s_cbranch_scc1 recurrent_scan__ssm_conv_s4d__mixer_channel_mlp__prompt_kernel_end
    s_load_dwordx16 s[36:51], s[0:1], 0
    s_load_dwordx8 s[52:59], s[0:1], 64
    s_load_dwordx4 s[60:63], s[0:1], 96
    s_load_dwordx2 s[64:65], s[0:1], 112
    v_lshrrev_b32 v1, 6, v0
    s_nop 0
    v_readfirstlane_b32 s3, v1
    v_and_b32_e64 v0, 63, v0
    s_nop 0
    s_and_b32 s4, s2, 7
    s_lshr_b32 s5, s2, 3
    s_lshr_b32 s6, s4, 1
    s_lshl_b32 s30, s6, 2
    s_and_b32 s7, s5, 3
    s_add_u32 s30, s30, s7
    s_lshl_b32 s24, s30, 7
    s_and_b32 s33, s4, 1
    s_lshl_b32 s6, s4, 2
    s_add_u32 s74, s6, s7
    s_lshr_b32 s31, s5, 2
    s_lshl_b32 s6, s7, 1
    s_add_u32 s31, s31, s6
    s_and_b32 s75, s31, 7
    s_lshr_b32 s5, s5, 2
    s_sub_i32 s6, s5, 3
    s_max_i32 s6, s6, 0
    s_lshl_b32 s6, s6, 2
    s_add_u32 s6, s6, s7
    s_mul_i32 s31, s4, 20
    s_add_u32 s34, s6, s31
    s_lshl_b32 s70, s34, 2
    s_lshl_b32 s30, s30, 4
    s_lshl_b32 s6, s33, 3
    s_add_u32 s30, s30, s6
    s_add_u32 s30, s30, s5
    s_mul_i32 s6, s5, 3
    s_add_u32 s6, s6, 3
    s_lshl_b32 s7, s5, 2
    s_sub_u32 s7, s7, s33
    s_max_i32 s7, s7, 0
    s_min_u32 s7, s7, s6
    s_mul_i32 s6, s33, 27
    s_add_u32 s25, s7, s6
    s_sub_u32 s5, s5, s33
    s_cmp_lt_u32 s5, 3
    s_cselect_b32 s26, 1, 0
    s_and_b32 s32, s25, 1
    s_add_u32 s72, s70, s3
    s_mul_i32 s71, s3, 16640
    s_lshl_b32 s4, s72, 8
    v_lshl_add_u32 v251, v0, 2, s4
    v_lshrrev_b32 v34, 3, v0
    v_and_b32_e64 v35, 7, v0
    v_mul_u32_u24 v7, 1280, v34
    v_lshl_add_u32 v7, v35, 4, v7
    v_lshlrev_b32_e64 v62, 4, v0
    s_lshr_b32 s4, s2, 3
    s_lshl_b32 s4, s4, 2
    s_add_u32 s4, s4, s3
    s_lshl_b32 s4, s4, 9
    s_min_u32 s4, s4, 48640
    v_lshl_add_u32 v36, v0, 3, s4
    s_mov_b32 s10, 2621440
    s_mov_b32 s11, 0x00020000
    s_mov_b32 s18, 2211840
    s_mov_b32 s19, 0x00020000
    s_mov_b32 s23, 0x00020000
    s_mov_b32 s14, 14942208
    s_mov_b32 s15, 0x00020000
    s_waitcnt lgkmcnt(0)
    s_getpc_b64 s[6:7]
    global_load_dwordx2 a[240:241], v36, s[6:7]
    s_mov_b32 s8, s36
    s_mov_b32 s9, s37
    s_mov_b32 s16, s52
    s_mov_b32 s17, s53
    s_mov_b32 s12, s64
    s_mov_b32 s13, s65
    s_cmp_eq_u32 s26, 0
    s_cbranch_scc1 L_narrow_27
    s_cmp_eq_u32 s3, 3
    s_cbranch_scc1 L_pack_28
    s_lshr_b32 s5, s2, 3
    s_and_b32 s4, s2, 1
    s_lshl_b32 s4, s4, 2
    s_sub_u32 s5, s5, s4
    s_mul_i32 s4, s3, 12
    s_add_u32 s5, s5, s4
    s_and_b32 s4, s2, 7
    s_lshl_b32 s4, s4, 5
    s_add_u32 s100, s4, s5
    s_mul_i32 s99, s100, 10240
    s_lshl_b32 s98, s100, 7
    s_add_u32 s98, s98, 2621440
    s_cmp_lt_u32 s5, 32
    s_nop 0
    s_cselect_b32 s99, s99, 16777216
    s_cselect_b32 s98, s98, 16777216
    buffer_load_dwordx4 v[64:67], v7, s[8:11], s99 offen offset:0
    buffer_load_dwordx4 v[68:71], v7, s[8:11], s99 offen offset:128
    buffer_load_dwordx4 v[72:75], v7, s[8:11], s99 offen offset:256
    buffer_load_dwordx4 v[76:79], v7, s[8:11], s99 offen offset:384
    buffer_load_dwordx4 v[80:83], v7, s[8:11], s99 offen offset:512
    buffer_load_dwordx4 v[84:87], v7, s[8:11], s99 offen offset:640
    buffer_load_dwordx4 v[88:91], v7, s[8:11], s99 offen offset:768
    buffer_load_dwordx4 v[92:95], v7, s[8:11], s99 offen offset:896
    buffer_load_dwordx4 v[96:99], v7, s[8:11], s99 offen offset:1024
    buffer_load_dwordx4 v[100:103], v7, s[8:11], s99 offen offset:1152
    s_mul_i32 s5, s75, 20
    s_add_u32 s5, s5, 2048
    v_add_u32 v2, s5, v0
    s_lshr_b32 s5, s74, 1
    s_lshl_b32 s5, s5, 4
    s_add_u32 s5, s5, 2284
    v_add_u32 v3, s5, v0
    v_cmp_le_u32 vcc, 20, v0
    s_add_u32 s5, s34, 2048
    s_add_u32 s30, s30, 2304
    v_cndmask_b32_e64 v2, v2, v3, vcc
    v_writelane_b32 v2, s30, 36
    v_writelane_b32 v2, s5, 37
    v_lshlrev_b32_e64 v254, 4, v2
    s_mov_b32 s4, 14876672
    s_mov_b32 exec_hi, 0x3f
    buffer_load_dword v255, v254, s[12:15], s4 offen sc1
    s_mov_b64 exec, -1
    s_and_b32 s4, s3, 1
    s_lshl_b32 s4, s4, 6
    v_add_u32_e64 v2, s4, v0
    s_and_b32 s4, s25, -2
    s_lshl_b32 s4, s4, 6
    v_lshl_add_u32 v229, v2, 1, s4
    v_lshlrev_b32_e64 v2, 2, v2
    v_add_u32 v228, 133632, v2
    s_mov_b32 s20, s54
    s_mov_b32 s21, s55
    s_mov_b32 s22, 3456
    s_mov_b32 s23, 0x00020000
    buffer_load_ushort v229, v229, s[20:23], 0 offen
    v_lshrrev_b32 v2, 3, v0
    v_and_b32 v3, 7, v0
    v_lshrrev_b32 v4, 1, v2
    v_xor_b32 v3, v3, v4
    v_mul_u32_u24 v2, 1280, v2
    v_lshl_add_u32 v216, v3, 4, v2
    v_xor_b32_e64 v3, 4, v3
    v_lshl_add_u32 v217, v3, 4, v2
    v_add_u32 v217, 9216, v217
    v_add_u32 v218, 18432, v216
    v_add_u32 v219, 18432, v217
    v_lshrrev_b32 v2, 4, v0
    v_and_b32 v3, 15, v0
    v_lshlrev_b32 v4, 2, v2
    v_xor_b32 v3, v3, v4
    v_mul_u32_u24 v2, 3456, v2
    v_lshl_add_u32 v220, v3, 4, v2
    v_add_u32 v221, 12800, v220
    v_add_u32 v222, 25600, v220
    v_add_u32 v223, 38400, v220
    s_lshl_b32 s4, s3, 5
    s_add_u32 s4, s4, s24
    s_mul_i32 s27, s4, 1280
    s_and_b32 s4, s25, -2
    s_lshl_b32 s4, s4, 6
    s_mul_i32 s5, s3, 55296
    s_add_u32 s28, s4, s5
    s_lshl_b32 s29, s3, 12
    v_and_b32 v2, 31, v0
    v_lshlrev_b32 v3, 7, v2
    v_bfe_u32 v4, v0, 1, 3
    v_lshrrev_b32 v5, 5, v0
    v_xor_b32 v4, v4, v5
    v_lshl_add_u32 v3, v4, 4, v3
    v_add_u32_e64 v244, s29, v3
    v_add_u32 v244, 2048, v244
    v_xor_b32 v245, 32, v244
    v_xor_b32 v246, 64, v244
    v_xor_b32 v247, 96, v244
    v_bfe_u32 v2, v0, 2, 2
    v_lshl_add_u32 v3, v5, 3, v2
    v_lshlrev_b32_e64 v3, 8, v3
    v_bfe_u32 v4, v0, 4, 1
    v_lshl_add_u32 v3, v4, 5, v3
    v_and_b32_e64 v4, 3, v0
    v_lshl_add_u32 v3, v4, 3, v3
    v_add_u32 v3, 18432, v3
    s_add_u32 s4, s26, 3
    s_add_u32 s5, s3, 0
    s_sub_u32 s6, s5, s4
    s_cmp_ge_u32 s5, s4
    s_cselect_b32 s5, s6, s5
    s_sub_u32 s6, s5, s4
    s_cmp_ge_u32 s5, s4
    s_cselect_b32 s5, s6, s5
    s_add_u32 s66, s5, s32
    v_xor_b32 v4, s66, v2
    v_lshl_add_u32 v240, v4, 6, v3
    s_add_u32 s5, s3, 1
    s_sub_u32 s6, s5, s4
    s_cmp_ge_u32 s5, s4
    s_cselect_b32 s5, s6, s5
    s_sub_u32 s6, s5, s4
    s_cmp_ge_u32 s5, s4
    s_cselect_b32 s5, s6, s5
    s_add_u32 s67, s5, s32
    v_xor_b32_e64 v4, s67, v2
    v_lshl_add_u32 v241, v4, 6, v3
    s_add_u32 s5, s3, 2
    s_sub_u32 s6, s5, s4
    s_cmp_ge_u32 s5, s4
    s_cselect_b32 s5, s6, s5
    s_sub_u32 s6, s5, s4
    s_cmp_ge_u32 s5, s4
    s_cselect_b32 s5, s6, s5
    s_add_u32 s68, s5, s32
    v_xor_b32_e64 v4, s68, v2
    v_lshl_add_u32 v242, v4, 6, v3
    s_add_u32 s5, s3, 3
    s_sub_u32 s6, s5, s4
    s_cmp_ge_u32 s5, s4
    s_cselect_b32 s5, s6, s5
    s_sub_u32 s6, s5, s4
    s_cmp_ge_u32 s5, s4
    s_cselect_b32 s5, s6, s5
    s_add_u32 s69, s5, s32
    v_xor_b32_e64 v4, s69, v2
    v_lshl_add_u32 v243, v4, 6, v3
    v_add_u32 v208, 65536, v240
    v_add_u32 v209, 65536, v241
    v_add_u32 v210, 65536, v242
    v_add_u32 v211, 65536, v243
    v_add_u32 v212, 65536, v244
    v_add_u32 v213, 65536, v245
    v_add_u32 v214, 65536, v246
    v_add_u32 v215, 65536, v247
    v_lshrrev_b32 v4, 4, v0
    v_xor_b32 v4, v4, v0
    v_and_b32 v4, 1, v4
    v_subrev_u32 v4, 1, v4
    v_and_b32 v236, 0x3f803f80, v4
    v_and_b32 v237, 0x3f803f80, v4
    v_and_b32 v238, 0x3f803f80, v4
    v_and_b32 v239, 0x3f803f80, v4
    v_lshlrev_b32_e64 v60, 4, v5
    v_bfe_u32 v4, v0, 4, 1
    v_mul_u32_u24 v4, 55296, v4
    v_lshl_add_u32 v4, v5, 8, v4
    v_and_b32_e64 v5, 15, v0
    v_lshl_add_u32 v59, v5, 4, v4
    v_and_b32 v4, 1, v0
    v_lshlrev_b32 v37, 7, v4
    s_mul_i32 s96, s3, 10240
    s_add_u32 s96, s96, 2048
    v_bfe_u32 v63, v0, 2, 2
    v_sub_u32 v63, 3, v63
    v_lshlrev_b32 v63, 7, v63
    v_lshrrev_b32_e64 v3, 4, v0
    v_lshl_add_u32 v63, v3, 5, v63
    v_and_b32_e64 v3, 3, v0
    v_lshl_add_u32 v63, v3, 3, v63
    v_add_u32 v63, s96, v63
    s_waitcnt vmcnt(2)
    s_mov_b32 s4, 0x3f803f80
    v_dot2_f32_bf16 v22, v64, s4, 0
    v_dot2_f32_bf16 v23, v64, v64, 0
    v_dot2_f32_bf16 v22, v65, s4, v22
    v_dot2_f32_bf16 v23, v65, v65, v23
    v_dot2_f32_bf16 v22, v66, s4, v22
    v_dot2_f32_bf16 v23, v66, v66, v23
    v_dot2_f32_bf16 v22, v67, s4, v22
    v_dot2_f32_bf16 v23, v67, v67, v23
    v_dot2_f32_bf16 v22, v68, s4, v22
    v_dot2_f32_bf16 v23, v68, v68, v23
    v_dot2_f32_bf16 v22, v69, s4, v22
    v_dot2_f32_bf16 v23, v69, v69, v23
    v_dot2_f32_bf16 v22, v70, s4, v22
    v_dot2_f32_bf16 v23, v70, v70, v23
    v_dot2_f32_bf16 v22, v71, s4, v22
    v_dot2_f32_bf16 v23, v71, v71, v23
    v_dot2_f32_bf16 v22, v72, s4, v22
    v_dot2_f32_bf16 v23, v72, v72, v23
    v_dot2_f32_bf16 v22, v73, s4, v22
    v_dot2_f32_bf16 v23, v73, v73, v23
    v_dot2_f32_bf16 v22, v74, s4, v22
    v_dot2_f32_bf16 v23, v74, v74, v23
    v_dot2_f32_bf16 v22, v75, s4, v22
    v_dot2_f32_bf16 v23, v75, v75, v23
    v_dot2_f32_bf16 v22, v76, s4, v22
    v_dot2_f32_bf16 v23, v76, v76, v23
    v_dot2_f32_bf16 v22, v77, s4, v22
    v_dot2_f32_bf16 v23, v77, v77, v23
    v_dot2_f32_bf16 v22, v78, s4, v22
    v_dot2_f32_bf16 v23, v78, v78, v23
    v_dot2_f32_bf16 v22, v79, s4, v22
    v_dot2_f32_bf16 v23, v79, v79, v23
    v_dot2_f32_bf16 v22, v80, s4, v22
    v_dot2_f32_bf16 v23, v80, v80, v23
    v_dot2_f32_bf16 v22, v81, s4, v22
    v_dot2_f32_bf16 v23, v81, v81, v23
    v_dot2_f32_bf16 v22, v82, s4, v22
    v_dot2_f32_bf16 v23, v82, v82, v23
    v_dot2_f32_bf16 v22, v83, s4, v22
    v_dot2_f32_bf16 v23, v83, v83, v23
    v_dot2_f32_bf16 v22, v84, s4, v22
    v_dot2_f32_bf16 v23, v84, v84, v23
    v_dot2_f32_bf16 v22, v85, s4, v22
    v_dot2_f32_bf16 v23, v85, v85, v23
    v_dot2_f32_bf16 v22, v86, s4, v22
    v_dot2_f32_bf16 v23, v86, v86, v23
    v_dot2_f32_bf16 v22, v87, s4, v22
    v_dot2_f32_bf16 v23, v87, v87, v23
    v_dot2_f32_bf16 v22, v88, s4, v22
    v_dot2_f32_bf16 v23, v88, v88, v23
    v_dot2_f32_bf16 v22, v89, s4, v22
    v_dot2_f32_bf16 v23, v89, v89, v23
    v_dot2_f32_bf16 v22, v90, s4, v22
    v_dot2_f32_bf16 v23, v90, v90, v23
    v_dot2_f32_bf16 v22, v91, s4, v22
    v_dot2_f32_bf16 v23, v91, v91, v23
    v_dot2_f32_bf16 v22, v92, s4, v22
    v_dot2_f32_bf16 v23, v92, v92, v23
    v_dot2_f32_bf16 v22, v93, s4, v22
    v_dot2_f32_bf16 v23, v93, v93, v23
    v_dot2_f32_bf16 v22, v94, s4, v22
    v_dot2_f32_bf16 v23, v94, v94, v23
    v_dot2_f32_bf16 v22, v95, s4, v22
    v_dot2_f32_bf16 v23, v95, v95, v23
    v_dot2_f32_bf16 v22, v96, s4, v22
    v_dot2_f32_bf16 v23, v96, v96, v23
    v_dot2_f32_bf16 v22, v97, s4, v22
    v_dot2_f32_bf16 v23, v97, v97, v23
    v_dot2_f32_bf16 v22, v98, s4, v22
    v_dot2_f32_bf16 v23, v98, v98, v23
    v_dot2_f32_bf16 v22, v99, s4, v22
    v_dot2_f32_bf16 v23, v99, v99, v23
    v_dot2_f32_bf16 v22, v100, s4, v22
    v_dot2_f32_bf16 v23, v100, v100, v23
    v_dot2_f32_bf16 v22, v101, s4, v22
    v_dot2_f32_bf16 v23, v101, v101, v23
    v_dot2_f32_bf16 v22, v102, s4, v22
    v_dot2_f32_bf16 v23, v102, v102, v23
    v_dot2_f32_bf16 v22, v103, s4, v22
    v_dot2_f32_bf16 v23, v103, v103, v23
    s_nop 2
    v_add_f32_dpp v22, v22, v22 quad_perm:[1,0,3,2] row_mask:0xf bank_mask:0xf
    v_add_f32_dpp v23, v23, v23 quad_perm:[1,0,3,2] row_mask:0xf bank_mask:0xf
    s_nop 0
    v_add_f32_dpp v22, v22, v22 quad_perm:[2,3,0,1] row_mask:0xf bank_mask:0xf
    v_add_f32_dpp v23, v23, v23 quad_perm:[2,3,0,1] row_mask:0xf bank_mask:0xf
    s_nop 0
    v_add_f32_dpp v22, v22, v22 row_half_mirror row_mask:0xf bank_mask:0xf
    v_add_f32_dpp v23, v23, v23 row_half_mirror row_mask:0xf bank_mask:0xf
    s_nop 0
    v_mul_f32 v22, 0x3acccccd, v22
    v_mul_f32 v23, 0x3acccccd, v23
    v_fma_f32 v23, -v22, v22, v23
    v_max_f32_e64 v23, 0, v23
    v_cvt_pk_bf16_f32 v24, v22, v23
    v_and_b32 v25, 0xffff0000, v24
    v_lshlrev_b32_e64 v24, 16, v24
    v_add_f32 v25, 0x3727c5ac, v25
    v_cvt_pk_bf16_f32 v25, v25, v25
    v_and_b32 v25, 0xffff0000, v25
    v_sqrt_f32 v25, v25
    s_nop 0
    v_cvt_pk_bf16_f32 v25, v25, v25
    v_and_b32 v25, 0xffff0000, v25
    v_rcp_f32 v30, v25
    v_sub_f32 v26, v22, v24
    v_mul_f32 v26, v26, v30
    v_mul_f32 v27, v23, v30
    v_mul_f32_e64 v27, v27, v30
    v_cvt_pk_bf16_f32 v26, v26, v27
    v_and_b32 v27, 0xffff0000, v26
    v_lshlrev_b32_e64 v26, 16, v26
    v_add_f32 v27, 0x3727c5ac, v27
    v_cvt_pk_bf16_f32 v27, v27, v27
    v_and_b32 v27, 0xffff0000, v27
    v_sqrt_f32 v27, v27
    s_nop 0
    v_cvt_pk_bf16_f32 v27, v27, v27
    v_and_b32 v27, 0xffff0000, v27
    v_rcp_f32 v27, v27
    v_mul_f32 v31, v24, v30
    v_sub_f32 v31, 0, v31
    v_mul_f32 v28, v30, v27
    v_sub_f32 v29, v31, v26
    v_mul_f32 v29, v29, v27
    v_cmp_eq_u32 vcc, 0, v35
    v_lshlrev_b32 v5, 4, v34
    v_mov_b32 v6, 16777216
    v_cndmask_b32_e64 v35, v6, v5, vcc
    buffer_store_dwordx4 v[28:31], v35, s[12:15], s98 offen sc1
    v_lshl_add_u32 v5, v0, 4, s96
    s_add_u32 s4, s99, 4096
    s_add_u32 s5, s99, 8192
    v_lshlrev_b32_e64 v32, 16, v64
    v_and_b32 v33, 0xffff0000, v64
    v_pk_fma_f32 v[32:33], v[32:33], v[30:31], v[30:31] op_sel:[0,0,1] op_sel_hi:[1,0,1]
    v_cvt_pk_bf16_f32 v64, v32, v33
    v_lshlrev_b32_e64 v32, 16, v65
    v_and_b32 v33, 0xffff0000, v65
    v_pk_fma_f32 v[32:33], v[32:33], v[30:31], v[30:31] op_sel:[0,0,1] op_sel_hi:[1,0,1]
    v_cvt_pk_bf16_f32 v65, v32, v33
    v_lshlrev_b32_e64 v32, 16, v66
    v_and_b32 v33, 0xffff0000, v66
    v_pk_fma_f32 v[32:33], v[32:33], v[30:31], v[30:31] op_sel:[0,0,1] op_sel_hi:[1,0,1]
    v_cvt_pk_bf16_f32 v66, v32, v33
    v_lshlrev_b32_e64 v32, 16, v67
    v_and_b32 v33, 0xffff0000, v67
    v_pk_fma_f32 v[32:33], v[32:33], v[30:31], v[30:31] op_sel:[0,0,1] op_sel_hi:[1,0,1]
    v_cvt_pk_bf16_f32 v67, v32, v33
    v_lshlrev_b32_e64 v32, 16, v68
    v_and_b32 v33, 0xffff0000, v68
    v_pk_fma_f32 v[32:33], v[32:33], v[30:31], v[30:31] op_sel:[0,0,1] op_sel_hi:[1,0,1]
    v_cvt_pk_bf16_f32 v68, v32, v33
    v_lshlrev_b32_e64 v32, 16, v69
    v_and_b32 v33, 0xffff0000, v69
    v_pk_fma_f32 v[32:33], v[32:33], v[30:31], v[30:31] op_sel:[0,0,1] op_sel_hi:[1,0,1]
    v_cvt_pk_bf16_f32 v69, v32, v33
    v_lshlrev_b32_e64 v32, 16, v70
    v_and_b32 v33, 0xffff0000, v70
    v_pk_fma_f32 v[32:33], v[32:33], v[30:31], v[30:31] op_sel:[0,0,1] op_sel_hi:[1,0,1]
    v_cvt_pk_bf16_f32 v70, v32, v33
    v_lshlrev_b32_e64 v32, 16, v71
    v_and_b32 v33, 0xffff0000, v71
    v_pk_fma_f32 v[32:33], v[32:33], v[30:31], v[30:31] op_sel:[0,0,1] op_sel_hi:[1,0,1]
    v_cvt_pk_bf16_f32 v71, v32, v33
    v_lshlrev_b32_e64 v32, 16, v72
    v_and_b32 v33, 0xffff0000, v72
    v_pk_fma_f32 v[32:33], v[32:33], v[30:31], v[30:31] op_sel:[0,0,1] op_sel_hi:[1,0,1]
    v_cvt_pk_bf16_f32 v72, v32, v33
    v_lshlrev_b32_e64 v32, 16, v73
    v_and_b32 v33, 0xffff0000, v73
    v_pk_fma_f32 v[32:33], v[32:33], v[30:31], v[30:31] op_sel:[0,0,1] op_sel_hi:[1,0,1]
    v_cvt_pk_bf16_f32 v73, v32, v33
    v_lshlrev_b32_e64 v32, 16, v74
    v_and_b32 v33, 0xffff0000, v74
    v_pk_fma_f32 v[32:33], v[32:33], v[30:31], v[30:31] op_sel:[0,0,1] op_sel_hi:[1,0,1]
    v_cvt_pk_bf16_f32 v74, v32, v33
    v_lshlrev_b32_e64 v32, 16, v75
    v_and_b32 v33, 0xffff0000, v75
    v_pk_fma_f32 v[32:33], v[32:33], v[30:31], v[30:31] op_sel:[0,0,1] op_sel_hi:[1,0,1]
    v_cvt_pk_bf16_f32 v75, v32, v33
    v_lshlrev_b32_e64 v32, 16, v76
    v_and_b32 v33, 0xffff0000, v76
    v_pk_fma_f32 v[32:33], v[32:33], v[30:31], v[30:31] op_sel:[0,0,1] op_sel_hi:[1,0,1]
    v_cvt_pk_bf16_f32 v76, v32, v33
    v_lshlrev_b32_e64 v32, 16, v77
    v_and_b32 v33, 0xffff0000, v77
    v_pk_fma_f32 v[32:33], v[32:33], v[30:31], v[30:31] op_sel:[0,0,1] op_sel_hi:[1,0,1]
    v_cvt_pk_bf16_f32 v77, v32, v33
    v_lshlrev_b32_e64 v32, 16, v78
    v_and_b32 v33, 0xffff0000, v78
    v_pk_fma_f32 v[32:33], v[32:33], v[30:31], v[30:31] op_sel:[0,0,1] op_sel_hi:[1,0,1]
    v_cvt_pk_bf16_f32 v78, v32, v33
    v_lshlrev_b32_e64 v32, 16, v79
    v_and_b32 v33, 0xffff0000, v79
    v_pk_fma_f32 v[32:33], v[32:33], v[30:31], v[30:31] op_sel:[0,0,1] op_sel_hi:[1,0,1]
    v_cvt_pk_bf16_f32 v79, v32, v33
    v_lshlrev_b32_e64 v32, 16, v80
    v_and_b32 v33, 0xffff0000, v80
    v_pk_fma_f32 v[32:33], v[32:33], v[30:31], v[30:31] op_sel:[0,0,1] op_sel_hi:[1,0,1]
    v_cvt_pk_bf16_f32 v80, v32, v33
    v_lshlrev_b32_e64 v32, 16, v81
    v_and_b32 v33, 0xffff0000, v81
    v_pk_fma_f32 v[32:33], v[32:33], v[30:31], v[30:31] op_sel:[0,0,1] op_sel_hi:[1,0,1]
    v_cvt_pk_bf16_f32 v81, v32, v33
    v_lshlrev_b32_e64 v32, 16, v82
    v_and_b32 v33, 0xffff0000, v82
    v_pk_fma_f32 v[32:33], v[32:33], v[30:31], v[30:31] op_sel:[0,0,1] op_sel_hi:[1,0,1]
    v_cvt_pk_bf16_f32 v82, v32, v33
    v_lshlrev_b32_e64 v32, 16, v83
    v_and_b32 v33, 0xffff0000, v83
    v_pk_fma_f32 v[32:33], v[32:33], v[30:31], v[30:31] op_sel:[0,0,1] op_sel_hi:[1,0,1]
    v_cvt_pk_bf16_f32 v83, v32, v33
    ds_write_b128 v5, v[64:67] offset:0
    ds_write_b128 v5, v[68:71] offset:1024
    ds_write_b128 v5, v[72:75] offset:2048
    ds_write_b128 v5, v[76:79] offset:3072
    ds_write_b128 v5, v[80:83] offset:4096
    ds_read_b64_tr_b16 v[64:65], v63 offset:512
    ds_read_b64_tr_b16 v[66:67], v63 offset:0
    ds_read_b64_tr_b16 v[68:69], v63 offset:1536
    ds_read_b64_tr_b16 v[70:71], v63 offset:1024
    ds_read_b64_tr_b16 v[72:73], v63 offset:2560
    ds_read_b64_tr_b16 v[74:75], v63 offset:2048
    ds_read_b64_tr_b16 v[76:77], v63 offset:3584
    ds_read_b64_tr_b16 v[78:79], v63 offset:3072
    ds_read_b64_tr_b16 v[80:81], v63 offset:4608
    ds_read_b64_tr_b16 v[82:83], v63 offset:4096
    v_lshlrev_b32_e64 v32, 16, v84
    v_and_b32 v33, 0xffff0000, v84
    v_pk_fma_f32 v[32:33], v[32:33], v[30:31], v[30:31] op_sel:[0,0,1] op_sel_hi:[1,0,1]
    v_cvt_pk_bf16_f32 v84, v32, v33
    v_lshlrev_b32_e64 v32, 16, v85
    v_and_b32 v33, 0xffff0000, v85
    v_pk_fma_f32 v[32:33], v[32:33], v[30:31], v[30:31] op_sel:[0,0,1] op_sel_hi:[1,0,1]
    v_cvt_pk_bf16_f32 v85, v32, v33
    v_lshlrev_b32_e64 v32, 16, v86
    v_and_b32 v33, 0xffff0000, v86
    v_pk_fma_f32 v[32:33], v[32:33], v[30:31], v[30:31] op_sel:[0,0,1] op_sel_hi:[1,0,1]
    v_cvt_pk_bf16_f32 v86, v32, v33
    v_lshlrev_b32_e64 v32, 16, v87
    v_and_b32 v33, 0xffff0000, v87
    v_pk_fma_f32 v[32:33], v[32:33], v[30:31], v[30:31] op_sel:[0,0,1] op_sel_hi:[1,0,1]
    v_cvt_pk_bf16_f32 v87, v32, v33
    v_lshlrev_b32_e64 v32, 16, v88
    v_and_b32 v33, 0xffff0000, v88
    v_pk_fma_f32 v[32:33], v[32:33], v[30:31], v[30:31] op_sel:[0,0,1] op_sel_hi:[1,0,1]
    v_cvt_pk_bf16_f32 v88, v32, v33
    v_lshlrev_b32_e64 v32, 16, v89
    v_and_b32 v33, 0xffff0000, v89
    v_pk_fma_f32 v[32:33], v[32:33], v[30:31], v[30:31] op_sel:[0,0,1] op_sel_hi:[1,0,1]
    v_cvt_pk_bf16_f32 v89, v32, v33
    v_lshlrev_b32_e64 v32, 16, v90
    v_and_b32 v33, 0xffff0000, v90
    v_pk_fma_f32 v[32:33], v[32:33], v[30:31], v[30:31] op_sel:[0,0,1] op_sel_hi:[1,0,1]
    v_cvt_pk_bf16_f32 v90, v32, v33
    v_lshlrev_b32_e64 v32, 16, v91
    v_and_b32 v33, 0xffff0000, v91
    v_pk_fma_f32 v[32:33], v[32:33], v[30:31], v[30:31] op_sel:[0,0,1] op_sel_hi:[1,0,1]
    v_cvt_pk_bf16_f32 v91, v32, v33
    v_lshlrev_b32_e64 v32, 16, v92
    v_and_b32 v33, 0xffff0000, v92
    v_pk_fma_f32 v[32:33], v[32:33], v[30:31], v[30:31] op_sel:[0,0,1] op_sel_hi:[1,0,1]
    v_cvt_pk_bf16_f32 v92, v32, v33
    v_lshlrev_b32_e64 v32, 16, v93
    v_and_b32 v33, 0xffff0000, v93
    v_pk_fma_f32 v[32:33], v[32:33], v[30:31], v[30:31] op_sel:[0,0,1] op_sel_hi:[1,0,1]
    v_cvt_pk_bf16_f32 v93, v32, v33
    v_lshlrev_b32_e64 v32, 16, v94
    v_and_b32 v33, 0xffff0000, v94
    v_pk_fma_f32 v[32:33], v[32:33], v[30:31], v[30:31] op_sel:[0,0,1] op_sel_hi:[1,0,1]
    v_cvt_pk_bf16_f32 v94, v32, v33
    v_lshlrev_b32_e64 v32, 16, v95
    v_and_b32 v33, 0xffff0000, v95
    v_pk_fma_f32 v[32:33], v[32:33], v[30:31], v[30:31] op_sel:[0,0,1] op_sel_hi:[1,0,1]
    v_cvt_pk_bf16_f32 v95, v32, v33
    v_lshlrev_b32_e64 v32, 16, v96
    v_and_b32 v33, 0xffff0000, v96
    v_pk_fma_f32 v[32:33], v[32:33], v[30:31], v[30:31] op_sel:[0,0,1] op_sel_hi:[1,0,1]
    v_cvt_pk_bf16_f32 v96, v32, v33
    v_lshlrev_b32_e64 v32, 16, v97
    v_and_b32 v33, 0xffff0000, v97
    v_pk_fma_f32 v[32:33], v[32:33], v[30:31], v[30:31] op_sel:[0,0,1] op_sel_hi:[1,0,1]
    v_cvt_pk_bf16_f32 v97, v32, v33
    v_lshlrev_b32_e64 v32, 16, v98
    v_and_b32 v33, 0xffff0000, v98
    v_pk_fma_f32 v[32:33], v[32:33], v[30:31], v[30:31] op_sel:[0,0,1] op_sel_hi:[1,0,1]
    v_cvt_pk_bf16_f32 v98, v32, v33
    v_lshlrev_b32_e64 v32, 16, v99
    v_and_b32 v33, 0xffff0000, v99
    v_pk_fma_f32 v[32:33], v[32:33], v[30:31], v[30:31] op_sel:[0,0,1] op_sel_hi:[1,0,1]
    v_cvt_pk_bf16_f32 v99, v32, v33
    v_lshlrev_b32_e64 v32, 16, v100
    v_and_b32 v33, 0xffff0000, v100
    v_pk_fma_f32 v[32:33], v[32:33], v[30:31], v[30:31] op_sel:[0,0,1] op_sel_hi:[1,0,1]
    v_cvt_pk_bf16_f32 v100, v32, v33
    v_lshlrev_b32_e64 v32, 16, v101
    v_and_b32 v33, 0xffff0000, v101
    v_pk_fma_f32 v[32:33], v[32:33], v[30:31], v[30:31] op_sel:[0,0,1] op_sel_hi:[1,0,1]
    v_cvt_pk_bf16_f32 v101, v32, v33
    v_lshlrev_b32_e64 v32, 16, v102
    v_and_b32 v33, 0xffff0000, v102
    v_pk_fma_f32 v[32:33], v[32:33], v[30:31], v[30:31] op_sel:[0,0,1] op_sel_hi:[1,0,1]
    v_cvt_pk_bf16_f32 v102, v32, v33
    v_lshlrev_b32_e64 v32, 16, v103
    v_and_b32 v33, 0xffff0000, v103
    v_pk_fma_f32 v[32:33], v[32:33], v[30:31], v[30:31] op_sel:[0,0,1] op_sel_hi:[1,0,1]
    v_cvt_pk_bf16_f32 v103, v32, v33
    ds_write_b128 v5, v[84:87] offset:5120
    ds_write_b128 v5, v[88:91] offset:6144
    ds_write_b128 v5, v[92:95] offset:7168
    ds_write_b128 v5, v[96:99] offset:8192
    ds_write_b128 v5, v[100:103] offset:9216
    ds_read_b64_tr_b16 v[84:85], v63 offset:5632
    ds_read_b64_tr_b16 v[86:87], v63 offset:5120
    ds_read_b64_tr_b16 v[88:89], v63 offset:6656
    ds_read_b64_tr_b16 v[90:91], v63 offset:6144
    ds_read_b64_tr_b16 v[92:93], v63 offset:7680
    ds_read_b64_tr_b16 v[94:95], v63 offset:7168
    ds_read_b64_tr_b16 v[96:97], v63 offset:8704
    ds_read_b64_tr_b16 v[98:99], v63 offset:8192
    ds_read_b64_tr_b16 v[100:101], v63 offset:9728
    ds_read_b64_tr_b16 v[102:103], v63 offset:9216
    s_mov_b32 s30, s4
    s_mov_b32 s31, s5
    s_add_u32 m0, s29, 67584
    s_nop 0
    s_nop 0
    buffer_load_dwordx4 v216, s[8:11], s27 offen offset:0 lds
    buffer_load_dwordx4 v217, s[8:11], s27 offen offset:1024 lds
    buffer_load_dwordx4 v218, s[8:11], s27 offen offset:2048 lds
    buffer_load_dwordx4 v219, s[8:11], s27 offen offset:3072 lds
    s_add_u32 m0, s29, 83968
    s_add_u32 s27, s27, 128
    buffer_load_dwordx4 v220, s[16:19], s28 offen offset:0 lds
    buffer_load_dwordx4 v221, s[16:19], s28 offen offset:1024 lds
    buffer_load_dwordx4 v222, s[16:19], s28 offen offset:2048 lds
    buffer_load_dwordx4 v223, s[16:19], s28 offen offset:3072 lds
    s_add_u32 s28, s28, 221184
    s_add_u32 m0, s29, 100352
    s_nop 0
    s_nop 0
    buffer_load_dwordx4 v216, s[8:11], s27 offen offset:0 lds
    buffer_load_dwordx4 v217, s[8:11], s27 offen offset:1024 lds
    buffer_load_dwordx4 v218, s[8:11], s27 offen offset:2048 lds
    buffer_load_dwordx4 v219, s[8:11], s27 offen offset:3072 lds
    s_add_u32 m0, s29, 116736
    s_add_u32 s27, s27, 128
    buffer_load_dwordx4 v220, s[16:19], s28 offen offset:0 lds
    buffer_load_dwordx4 v221, s[16:19], s28 offen offset:1024 lds
    buffer_load_dwordx4 v222, s[16:19], s28 offen offset:2048 lds
    buffer_load_dwordx4 v223, s[16:19], s28 offen offset:3072 lds
    s_add_u32 s28, s28, 221184
    s_waitcnt lgkmcnt(15)
    buffer_store_dwordx4 v[64:67], v62, s[12:15], s99 offen offset:0 sc1
    s_waitcnt lgkmcnt(15)
    buffer_store_dwordx4 v[68:71], v62, s[12:15], s99 offen offset:1024 sc1
    s_waitcnt lgkmcnt(15)
    buffer_store_dwordx4 v[72:75], v62, s[12:15], s99 offen offset:2048 sc1
    s_waitcnt lgkmcnt(15)
    buffer_store_dwordx4 v[76:79], v62, s[12:15], s99 offen offset:3072 sc1
    s_waitcnt lgkmcnt(15)
    buffer_store_dwordx4 v[80:83], v62, s[12:15], s4 offen offset:0 sc1
    s_waitcnt lgkmcnt(8)
    buffer_store_dwordx4 v[84:87], v62, s[12:15], s4 offen offset:1024 sc1
    s_waitcnt lgkmcnt(6)
    buffer_store_dwordx4 v[88:91], v62, s[12:15], s4 offen offset:2048 sc1
    s_waitcnt lgkmcnt(4)
    buffer_store_dwordx4 v[92:95], v62, s[12:15], s4 offen offset:3072 sc1
    s_waitcnt lgkmcnt(2)
    buffer_store_dwordx4 v[96:99], v62, s[12:15], s5 offen offset:0 sc1
    s_waitcnt lgkmcnt(0)
    buffer_store_dwordx4 v[100:103], v62, s[12:15], s5 offen offset:1024 sc1
    s_waitcnt vmcnt(18)
    s_branch L_join_29
L_pack_28:
    s_lshr_b32 s5, s2, 3
    s_and_b32 s4, s2, 1
    s_lshl_b32 s4, s4, 2
    s_sub_u32 s5, s5, s4
    s_and_b32 s4, s2, 7
    s_mul_i32 s4, s4, 12
    s_add_u32 s97, s4, s5
    s_mov_b32 s20, s56
    s_mov_b32 s21, s57
    s_mov_b32 s22, 2211840
    s_mov_b32 s23, 0x00020000
    s_add_u32 s4, s97, 0
    s_mul_i32 s5, s4, 6554
    s_lshr_b32 s5, s5, 16
    s_mul_i32 s5, s5, 39680
    s_lshl_b32 s4, s4, 7
    s_add_u32 s5, s5, s4
    s_mov_b32 m0, 32768
    s_nop 0
    buffer_load_dwordx4 v7, s[20:23], s5 offen lds
    s_mov_b32 m0, 33792
    s_add_u32 s5, s5, 10240
    buffer_load_dwordx4 v7, s[20:23], s5 offen lds
    s_mov_b32 m0, 34816
    s_add_u32 s5, s5, 10240
    buffer_load_dwordx4 v7, s[20:23], s5 offen lds
    s_mov_b32 m0, 35840
    s_add_u32 s5, s5, 10240
    buffer_load_dwordx4 v7, s[20:23], s5 offen lds
    s_add_u32 s4, s97, 96
    s_mul_i32 s5, s4, 6554
    s_lshr_b32 s5, s5, 16
    s_mul_i32 s5, s5, 39680
    s_lshl_b32 s4, s4, 7
    s_add_u32 s5, s5, s4
    s_mov_b32 m0, 36864
    s_nop 0
    buffer_load_dwordx4 v7, s[20:23], s5 offen lds
    s_mov_b32 m0, 37888
    s_add_u32 s5, s5, 10240
    buffer_load_dwordx4 v7, s[20:23], s5 offen lds
    s_mov_b32 m0, 38912
    s_add_u32 s5, s5, 10240
    buffer_load_dwordx4 v7, s[20:23], s5 offen lds
    s_mov_b32 m0, 39936
    s_add_u32 s5, s5, 10240
    buffer_load_dwordx4 v7, s[20:23], s5 offen lds
    s_add_u32 s4, s97, 192
    s_mul_i32 s5, s4, 6554
    s_lshr_b32 s5, s5, 16
    s_mul_i32 s5, s5, 39680
    s_lshl_b32 s4, s4, 7
    s_add_u32 s5, s5, s4
    s_mov_b32 m0, 40960
    s_nop 0
    buffer_load_dwordx4 v7, s[20:23], s5 offen lds
    s_mov_b32 m0, 41984
    s_add_u32 s5, s5, 10240
    buffer_load_dwordx4 v7, s[20:23], s5 offen lds
    s_mov_b32 m0, 43008
    s_add_u32 s5, s5, 10240
    buffer_load_dwordx4 v7, s[20:23], s5 offen lds
    s_mov_b32 m0, 44032
    s_add_u32 s5, s5, 10240
    buffer_load_dwordx4 v7, s[20:23], s5 offen lds
    s_add_u32 s4, s97, 288
    s_mul_i32 s5, s4, 6554
    s_lshr_b32 s5, s5, 16
    s_mul_i32 s5, s5, 39680
    s_lshl_b32 s4, s4, 7
    s_add_u32 s5, s5, s4
    s_mov_b32 m0, 45056
    s_nop 0
    buffer_load_dwordx4 v7, s[20:23], s5 offen lds
    s_mov_b32 m0, 46080
    s_add_u32 s5, s5, 10240
    buffer_load_dwordx4 v7, s[20:23], s5 offen lds
    s_mov_b32 m0, 47104
    s_add_u32 s5, s5, 10240
    buffer_load_dwordx4 v7, s[20:23], s5 offen lds
    s_mov_b32 m0, 48128
    s_add_u32 s5, s5, 10240
    buffer_load_dwordx4 v7, s[20:23], s5 offen lds
    s_add_u32 s4, s97, 384
    s_mul_i32 s5, s4, 6554
    s_lshr_b32 s5, s5, 16
    s_mul_i32 s5, s5, 39680
    s_lshl_b32 s4, s4, 7
    s_add_u32 s5, s5, s4
    s_mov_b32 m0, 49152
    s_nop 0
    buffer_load_dwordx4 v7, s[20:23], s5 offen lds
    s_mov_b32 m0, 50176
    s_add_u32 s5, s5, 10240
    buffer_load_dwordx4 v7, s[20:23], s5 offen lds
    s_mov_b32 m0, 51200
    s_add_u32 s5, s5, 10240
    buffer_load_dwordx4 v7, s[20:23], s5 offen lds
    s_mov_b32 m0, 52224
    s_add_u32 s5, s5, 10240
    buffer_load_dwordx4 v7, s[20:23], s5 offen lds
    s_add_u32 s4, s97, 480
    s_mul_i32 s5, s4, 6554
    s_lshr_b32 s5, s5, 16
    s_mul_i32 s5, s5, 39680
    s_lshl_b32 s4, s4, 7
    s_add_u32 s5, s5, s4
    s_mov_b32 m0, 53248
    s_nop 0
    buffer_load_dwordx4 v7, s[20:23], s5 offen lds
    s_mov_b32 m0, 54272
    s_add_u32 s5, s5, 10240
    buffer_load_dwordx4 v7, s[20:23], s5 offen lds
    s_mov_b32 m0, 55296
    s_add_u32 s5, s5, 10240
    buffer_load_dwordx4 v7, s[20:23], s5 offen lds
    s_mov_b32 m0, 56320
    s_add_u32 s5, s5, 10240
    buffer_load_dwordx4 v7, s[20:23], s5 offen lds
    s_mul_i32 s5, s75, 20
    s_add_u32 s5, s5, 2048
    v_add_u32 v2, s5, v0
    s_lshr_b32 s5, s74, 1
    s_lshl_b32 s5, s5, 4
    s_add_u32 s5, s5, 2284
    v_add_u32 v3, s5, v0
    v_cmp_le_u32 vcc, 20, v0
    s_add_u32 s5, s34, 2048
    s_add_u32 s30, s30, 2304
    v_cndmask_b32_e64 v2, v2, v3, vcc
    v_writelane_b32 v2, s30, 36
    v_writelane_b32 v2, s5, 37
    v_lshlrev_b32_e64 v254, 4, v2
    s_mov_b32 s4, 14876672
    s_mov_b32 exec_hi, 0x3f
    buffer_load_dword v255, v254, s[12:15], s4 offen sc1
    s_mov_b64 exec, -1
    s_and_b32 s4, s3, 1
    s_lshl_b32 s4, s4, 6
    v_add_u32_e64 v2, s4, v0
    s_and_b32 s4, s25, -2
    s_lshl_b32 s4, s4, 6
    v_lshl_add_u32 v229, v2, 1, s4
    v_lshlrev_b32_e64 v2, 2, v2
    v_add_u32 v228, 133632, v2
    s_mov_b32 s20, s54
    s_mov_b32 s21, s55
    s_mov_b32 s22, 3456
    s_mov_b32 s23, 0x00020000
    buffer_load_ushort v229, v229, s[20:23], 0 offen
    v_lshrrev_b32 v2, 3, v0
    v_and_b32 v3, 7, v0
    v_lshrrev_b32 v4, 1, v2
    v_xor_b32 v3, v3, v4
    v_mul_u32_u24 v2, 1280, v2
    v_lshl_add_u32 v216, v3, 4, v2
    v_xor_b32_e64 v3, 4, v3
    v_lshl_add_u32 v217, v3, 4, v2
    v_add_u32 v217, 9216, v217
    v_add_u32 v218, 18432, v216
    v_add_u32 v219, 18432, v217
    v_lshrrev_b32 v2, 4, v0
    v_and_b32 v3, 15, v0
    v_lshlrev_b32 v4, 2, v2
    v_xor_b32 v3, v3, v4
    v_mul_u32_u24 v2, 3456, v2
    v_lshl_add_u32 v220, v3, 4, v2
    v_add_u32 v221, 12800, v220
    v_add_u32 v222, 25600, v220
    v_add_u32 v223, 38400, v220
    s_lshl_b32 s4, s3, 5
    s_add_u32 s4, s4, s24
    s_mul_i32 s27, s4, 1280
    s_and_b32 s4, s25, -2
    s_lshl_b32 s4, s4, 6
    s_mul_i32 s5, s3, 55296
    s_add_u32 s28, s4, s5
    s_lshl_b32 s29, s3, 12
    v_and_b32 v2, 31, v0
    v_lshlrev_b32 v3, 7, v2
    v_bfe_u32 v4, v0, 1, 3
    v_lshrrev_b32 v5, 5, v0
    v_xor_b32 v4, v4, v5
    v_lshl_add_u32 v3, v4, 4, v3
    v_add_u32_e64 v244, s29, v3
    v_add_u32 v244, 2048, v244
    v_xor_b32 v245, 32, v244
    v_xor_b32 v246, 64, v244
    v_xor_b32 v247, 96, v244
    v_bfe_u32 v2, v0, 2, 2
    v_lshl_add_u32 v3, v5, 3, v2
    v_lshlrev_b32_e64 v3, 8, v3
    v_bfe_u32 v4, v0, 4, 1
    v_lshl_add_u32 v3, v4, 5, v3
    v_and_b32_e64 v4, 3, v0
    v_lshl_add_u32 v3, v4, 3, v3
    v_add_u32 v3, 18432, v3
    s_add_u32 s4, s26, 3
    s_add_u32 s5, s3, 0
    s_sub_u32 s6, s5, s4
    s_cmp_ge_u32 s5, s4
    s_cselect_b32 s5, s6, s5
    s_sub_u32 s6, s5, s4
    s_cmp_ge_u32 s5, s4
    s_cselect_b32 s5, s6, s5
    s_add_u32 s66, s5, s32
    v_xor_b32 v4, s66, v2
    v_lshl_add_u32 v240, v4, 6, v3
    s_add_u32 s5, s3, 1
    s_sub_u32 s6, s5, s4
    s_cmp_ge_u32 s5, s4
    s_cselect_b32 s5, s6, s5
    s_sub_u32 s6, s5, s4
    s_cmp_ge_u32 s5, s4
    s_cselect_b32 s5, s6, s5
    s_add_u32 s67, s5, s32
    v_xor_b32_e64 v4, s67, v2
    v_lshl_add_u32 v241, v4, 6, v3
    s_add_u32 s5, s3, 2
    s_sub_u32 s6, s5, s4
    s_cmp_ge_u32 s5, s4
    s_cselect_b32 s5, s6, s5
    s_sub_u32 s6, s5, s4
    s_cmp_ge_u32 s5, s4
    s_cselect_b32 s5, s6, s5
    s_add_u32 s68, s5, s32
    v_xor_b32_e64 v4, s68, v2
    v_lshl_add_u32 v242, v4, 6, v3
    s_add_u32 s5, s3, 3
    s_sub_u32 s6, s5, s4
    s_cmp_ge_u32 s5, s4
    s_cselect_b32 s5, s6, s5
    s_sub_u32 s6, s5, s4
    s_cmp_ge_u32 s5, s4
    s_cselect_b32 s5, s6, s5
    s_add_u32 s69, s5, s32
    v_xor_b32_e64 v4, s69, v2
    v_lshl_add_u32 v243, v4, 6, v3
    v_add_u32 v208, 65536, v240
    v_add_u32 v209, 65536, v241
    v_add_u32 v210, 65536, v242
    v_add_u32 v211, 65536, v243
    v_add_u32 v212, 65536, v244
    v_add_u32 v213, 65536, v245
    v_add_u32 v214, 65536, v246
    v_add_u32 v215, 65536, v247
    v_lshrrev_b32 v4, 4, v0
    v_xor_b32 v4, v4, v0
    v_and_b32 v4, 1, v4
    v_subrev_u32 v4, 1, v4
    v_and_b32 v236, 0x3f803f80, v4
    v_and_b32 v237, 0x3f803f80, v4
    v_and_b32 v238, 0x3f803f80, v4
    v_and_b32 v239, 0x3f803f80, v4
    v_lshlrev_b32_e64 v60, 4, v5
    v_bfe_u32 v4, v0, 4, 1
    v_mul_u32_u24 v4, 55296, v4
    v_lshl_add_u32 v4, v5, 8, v4
    v_and_b32_e64 v5, 15, v0
    v_lshl_add_u32 v59, v5, 4, v4
    v_and_b32 v4, 1, v0
    v_lshlrev_b32 v37, 7, v4
    v_lshrrev_b32 v61, 5, v0
    v_lshlrev_b32 v61, 4, v61
    v_bfe_u32 v3, v0, 4, 1
    v_lshl_add_u32 v61, v3, 2, v61
    v_bfe_u32 v3, v0, 2, 2
    v_add_u32 v61, v61, v3
    v_lshlrev_b32 v61, 7, v61
    v_and_b32_e64 v3, 3, v0
    v_lshl_add_u32 v61, v3, 3, v61
    v_add_u32 v61, 32768, v61
    s_lshl_b32 s98, s97, 12
    s_add_u32 s98, s98, 5308416
    s_waitcnt vmcnt(22)
    ds_read_b64_tr_b16 v[64:65], v61 offset:0
    ds_read_b64_tr_b16 v[66:67], v61 offset:1024
    ds_read_b64_tr_b16 v[68:69], v61 offset:32
    ds_read_b64_tr_b16 v[70:71], v61 offset:1056
    ds_read_b64_tr_b16 v[72:73], v61 offset:64
    ds_read_b64_tr_b16 v[74:75], v61 offset:1088
    ds_read_b64_tr_b16 v[76:77], v61 offset:96
    ds_read_b64_tr_b16 v[78:79], v61 offset:1120
    s_waitcnt vmcnt(18)
    s_nop 0
    ds_read_b64_tr_b16 v[80:81], v61 offset:4096
    ds_read_b64_tr_b16 v[82:83], v61 offset:5120
    ds_read_b64_tr_b16 v[84:85], v61 offset:4128
    ds_read_b64_tr_b16 v[86:87], v61 offset:5152
    ds_read_b64_tr_b16 v[88:89], v61 offset:4160
    ds_read_b64_tr_b16 v[90:91], v61 offset:5184
    ds_read_b64_tr_b16 v[92:93], v61 offset:4192
    ds_read_b64_tr_b16 v[94:95], v61 offset:5216
    s_waitcnt vmcnt(14)
    s_nop 0
    ds_read_b64_tr_b16 v[96:97], v61 offset:8192
    ds_read_b64_tr_b16 v[98:99], v61 offset:9216
    ds_read_b64_tr_b16 v[100:101], v61 offset:8224
    ds_read_b64_tr_b16 v[102:103], v61 offset:9248
    ds_read_b64_tr_b16 v[104:105], v61 offset:8256
    ds_read_b64_tr_b16 v[106:107], v61 offset:9280
    ds_read_b64_tr_b16 v[108:109], v61 offset:8288
    ds_read_b64_tr_b16 v[110:111], v61 offset:9312
    s_waitcnt vmcnt(10)
    s_nop 0
    ds_read_b64_tr_b16 v[112:113], v61 offset:12288
    ds_read_b64_tr_b16 v[114:115], v61 offset:13312
    ds_read_b64_tr_b16 v[116:117], v61 offset:12320
    ds_read_b64_tr_b16 v[118:119], v61 offset:13344
    ds_read_b64_tr_b16 v[120:121], v61 offset:12352
    ds_read_b64_tr_b16 v[122:123], v61 offset:13376
    ds_read_b64_tr_b16 v[124:125], v61 offset:12384
    ds_read_b64_tr_b16 v[126:127], v61 offset:13408
    s_waitcnt vmcnt(6)
    s_nop 0
    ds_read_b64_tr_b16 v[128:129], v61 offset:16384
    ds_read_b64_tr_b16 v[130:131], v61 offset:17408
    ds_read_b64_tr_b16 v[132:133], v61 offset:16416
    ds_read_b64_tr_b16 v[134:135], v61 offset:17440
    ds_read_b64_tr_b16 v[136:137], v61 offset:16448
    ds_read_b64_tr_b16 v[138:139], v61 offset:17472
    ds_read_b64_tr_b16 v[140:141], v61 offset:16480
    ds_read_b64_tr_b16 v[142:143], v61 offset:17504
    s_waitcnt vmcnt(2)
    s_nop 0
    ds_read_b64_tr_b16 v[144:145], v61 offset:20480
    ds_read_b64_tr_b16 v[146:147], v61 offset:21504
    ds_read_b64_tr_b16 v[148:149], v61 offset:20512
    ds_read_b64_tr_b16 v[150:151], v61 offset:21536
    ds_read_b64_tr_b16 v[152:153], v61 offset:20544
    ds_read_b64_tr_b16 v[154:155], v61 offset:21568
    ds_read_b64_tr_b16 v[156:157], v61 offset:20576
    ds_read_b64_tr_b16 v[158:159], v61 offset:21600
    s_mov_b32 s30, s4
    s_mov_b32 s31, s5
    s_add_u32 m0, s29, 67584
    s_nop 0
    s_nop 0
    buffer_load_dwordx4 v216, s[8:11], s27 offen offset:0 lds
    buffer_load_dwordx4 v217, s[8:11], s27 offen offset:1024 lds
    buffer_load_dwordx4 v218, s[8:11], s27 offen offset:2048 lds
    buffer_load_dwordx4 v219, s[8:11], s27 offen offset:3072 lds
    s_add_u32 m0, s29, 83968
    s_add_u32 s27, s27, 128
    buffer_load_dwordx4 v220, s[16:19], s28 offen offset:0 lds
    buffer_load_dwordx4 v221, s[16:19], s28 offen offset:1024 lds
    buffer_load_dwordx4 v222, s[16:19], s28 offen offset:2048 lds
    buffer_load_dwordx4 v223, s[16:19], s28 offen offset:3072 lds
    s_add_u32 s28, s28, 221184
    s_add_u32 m0, s29, 100352
    s_nop 0
    s_nop 0
    buffer_load_dwordx4 v216, s[8:11], s27 offen offset:0 lds
    buffer_load_dwordx4 v217, s[8:11], s27 offen offset:1024 lds
    buffer_load_dwordx4 v218, s[8:11], s27 offen offset:2048 lds
    buffer_load_dwordx4 v219, s[8:11], s27 offen offset:3072 lds
    s_add_u32 m0, s29, 116736
    s_add_u32 s27, s27, 128
    buffer_load_dwordx4 v220, s[16:19], s28 offen offset:0 lds
    buffer_load_dwordx4 v221, s[16:19], s28 offen offset:1024 lds
    buffer_load_dwordx4 v222, s[16:19], s28 offen offset:2048 lds
    buffer_load_dwordx4 v223, s[16:19], s28 offen offset:3072 lds
    s_add_u32 s28, s28, 221184
    s_waitcnt lgkmcnt(15)
    buffer_store_dwordx4 v[64:67], v62, s[12:15], s98 offen offset:0 sc1
    buffer_store_dwordx4 v[68:71], v62, s[12:15], s98 offen offset:1024 sc1
    buffer_store_dwordx4 v[72:75], v62, s[12:15], s98 offen offset:2048 sc1
    buffer_store_dwordx4 v[76:79], v62, s[12:15], s98 offen offset:3072 sc1
    s_add_u32 s98, s98, 393216
    s_waitcnt lgkmcnt(15)
    buffer_store_dwordx4 v[80:83], v62, s[12:15], s98 offen offset:0 sc1
    buffer_store_dwordx4 v[84:87], v62, s[12:15], s98 offen offset:1024 sc1
    buffer_store_dwordx4 v[88:91], v62, s[12:15], s98 offen offset:2048 sc1
    buffer_store_dwordx4 v[92:95], v62, s[12:15], s98 offen offset:3072 sc1
    s_add_u32 s98, s98, 393216
    s_waitcnt lgkmcnt(15)
    buffer_store_dwordx4 v[96:99], v62, s[12:15], s98 offen offset:0 sc1
    buffer_store_dwordx4 v[100:103], v62, s[12:15], s98 offen offset:1024 sc1
    buffer_store_dwordx4 v[104:107], v62, s[12:15], s98 offen offset:2048 sc1
    buffer_store_dwordx4 v[108:111], v62, s[12:15], s98 offen offset:3072 sc1
    s_add_u32 s98, s98, 393216
    s_waitcnt lgkmcnt(15)
    buffer_store_dwordx4 v[112:115], v62, s[12:15], s98 offen offset:0 sc1
    buffer_store_dwordx4 v[116:119], v62, s[12:15], s98 offen offset:1024 sc1
    buffer_store_dwordx4 v[120:123], v62, s[12:15], s98 offen offset:2048 sc1
    buffer_store_dwordx4 v[124:127], v62, s[12:15], s98 offen offset:3072 sc1
    s_add_u32 s98, s98, 393216
    s_waitcnt lgkmcnt(8)
    buffer_store_dwordx4 v[128:131], v62, s[12:15], s98 offen offset:0 sc1
    buffer_store_dwordx4 v[132:135], v62, s[12:15], s98 offen offset:1024 sc1
    buffer_store_dwordx4 v[136:139], v62, s[12:15], s98 offen offset:2048 sc1
    buffer_store_dwordx4 v[140:143], v62, s[12:15], s98 offen offset:3072 sc1
    s_add_u32 s98, s98, 393216
    s_cmp_lt_u32 s97, 60
    s_cselect_b32 s98, s98, 16777216
    s_waitcnt lgkmcnt(0)
    buffer_store_dwordx4 v[144:147], v62, s[12:15], s98 offen offset:0 sc1
    buffer_store_dwordx4 v[148:151], v62, s[12:15], s98 offen offset:1024 sc1
    buffer_store_dwordx4 v[152:155], v62, s[12:15], s98 offen offset:2048 sc1
    buffer_store_dwordx4 v[156:159], v62, s[12:15], s98 offen offset:3072 sc1
    s_add_u32 s98, s98, 393216
    s_waitcnt vmcnt(32)
L_join_29:
    s_waitcnt lgkmcnt(0)
    s_barrier
    ds_read_b128 v[192:195], v212 offset:0
    ds_read_b64_tr_b16 v[128:129], v208 offset:0
    ds_read_b64_tr_b16 v[130:131], v208 offset:1024
    ds_read_b64_tr_b16 v[132:133], v209 offset:0
    ds_read_b64_tr_b16 v[134:135], v209 offset:1024
    ds_read_b64_tr_b16 v[136:137], v210 offset:0
    ds_read_b64_tr_b16 v[138:139], v210 offset:1024
    ds_read_b64_tr_b16 v[140:141], v211 offset:0
    ds_read_b64_tr_b16 v[142:143], v211 offset:1024
    s_waitcnt lgkmcnt(0)
    v_mfma_f32_32x32x16_bf16 v[64:79], v[128:131], v[192:195], 0
    ds_read_b128 v[196:199], v213 offset:0
    s_add_u32 m0, s29, 34816
    ds_read_b64_tr_b16 v[144:145], v208 offset:4096
    s_nop 0
    ds_read_b64_tr_b16 v[146:147], v208 offset:5120
    ds_read_b64_tr_b16 v[148:149], v209 offset:4096
    v_mfma_f32_16x16x32_bf16 v[232:235], v[128:131], v[236:239], 0
    v_mfma_f32_32x32x16_bf16 v[80:95], v[132:135], v[192:195], 0
    buffer_load_dwordx4 v216, s[8:11], s27 offen offset:0 lds
    ds_read_b64_tr_b16 v[150:151], v209 offset:5120
    v_mfma_f32_32x32x16_bf16 v[96:111], v[136:139], v[192:195], 0
    buffer_load_dwordx4 v217, s[8:11], s27 offen offset:1024 lds
    ds_read_b64_tr_b16 v[152:153], v210 offset:4096
    v_mfma_f32_32x32x16_bf16 v[112:127], v[140:143], v[192:195], 0
    buffer_load_dwordx4 v218, s[8:11], s27 offen offset:2048 lds
    ds_read_b64_tr_b16 v[154:155], v210 offset:5120
    ds_read_b64_tr_b16 v[156:157], v211 offset:4096
    buffer_load_dwordx4 v219, s[8:11], s27 offen offset:3072 lds
    ds_read_b64_tr_b16 v[158:159], v211 offset:5120
    s_add_u32 m0, s29, 51200
    ds_read_b128 v[200:203], v214 offset:0
    s_add_u32 s27, s27, 128
    ds_read_b64_tr_b16 v[160:161], v208 offset:8192
    s_waitcnt lgkmcnt(2)
    s_nop 0
    v_mfma_f32_32x32x16_bf16 v[64:79], v[144:147], v[196:199], v[64:79]
    ds_read_b64_tr_b16 v[162:163], v208 offset:9216
    buffer_load_dwordx4 v220, s[16:19], s28 offen offset:0 lds
    ds_read_b64_tr_b16 v[164:165], v209 offset:8192
    v_mfma_f32_16x16x32_bf16 v[232:235], v[144:147], v[236:239], v[232:235]
    v_mfma_f32_32x32x16_bf16 v[80:95], v[148:151], v[196:199], v[80:95]
    buffer_load_dwordx4 v221, s[16:19], s28 offen offset:1024 lds
    ds_read_b64_tr_b16 v[166:167], v209 offset:9216
    v_mfma_f32_32x32x16_bf16 v[96:111], v[152:155], v[196:199], v[96:111]
    buffer_load_dwordx4 v222, s[16:19], s28 offen offset:2048 lds
    ds_read_b64_tr_b16 v[168:169], v210 offset:8192
    v_mfma_f32_32x32x16_bf16 v[112:127], v[156:159], v[196:199], v[112:127]
    buffer_load_dwordx4 v223, s[16:19], s28 offen offset:3072 lds
    ds_read_b64_tr_b16 v[170:171], v210 offset:9216
    s_add_u32 s28, s28, 221184
    ds_read_b64_tr_b16 v[172:173], v211 offset:8192
    s_add_u32 m0, s29, 2048
    ds_read_b64_tr_b16 v[174:175], v211 offset:9216
    s_nop 0
    ds_read_b128 v[204:207], v215 offset:0
    buffer_load_dwordx4 v216, s[8:11], s27 offen offset:0 lds
    ds_read_b64_tr_b16 v[176:177], v208 offset:12288
    ds_read_b64_tr_b16 v[178:179], v208 offset:13312
    buffer_load_dwordx4 v217, s[8:11], s27 offen offset:1024 lds
    s_waitcnt lgkmcnt(3)
    v_mfma_f32_32x32x16_bf16 v[64:79], v[160:163], v[200:203], v[64:79]
    ds_read_b64_tr_b16 v[180:181], v209 offset:12288
    ds_read_b64_tr_b16 v[182:183], v209 offset:13312
    ds_read_b64_tr_b16 v[184:185], v210 offset:12288
    ds_read_b64_tr_b16 v[186:187], v210 offset:13312
    ds_read_b64_tr_b16 v[188:189], v211 offset:12288
    ds_read_b64_tr_b16 v[190:191], v211 offset:13312
    v_mfma_f32_16x16x32_bf16 v[232:235], v[160:163], v[236:239], v[232:235]
    v_mfma_f32_32x32x16_bf16 v[80:95], v[164:167], v[200:203], v[80:95]
    buffer_load_dwordx4 v218, s[8:11], s27 offen offset:2048 lds
    buffer_load_dwordx4 v219, s[8:11], s27 offen offset:3072 lds
    s_add_u32 m0, s29, 18432
    v_mfma_f32_32x32x16_bf16 v[96:111], v[168:171], v[200:203], v[96:111]
    s_add_u32 s27, s27, 128
    buffer_load_dwordx4 v220, s[16:19], s28 offen offset:0 lds
    buffer_load_dwordx4 v221, s[16:19], s28 offen offset:1024 lds
    buffer_load_dwordx4 v222, s[16:19], s28 offen offset:2048 lds
    buffer_load_dwordx4 v223, s[16:19], s28 offen offset:3072 lds
    s_add_u32 s28, s28, 221184
    v_mfma_f32_32x32x16_bf16 v[112:127], v[172:175], v[200:203], v[112:127]
    s_waitcnt vmcnt(16) lgkmcnt(0)
    s_waitcnt vmcnt(16)
    s_barrier
    s_cmp_lg_u32 s3, 0
    s_cbranch_scc1 L_apub_30
    s_mov_b32 s20, s62
    s_mov_b32 s21, s63
    s_mov_b32 s22, 256
    s_mov_b32 s23, 0x00020000
    s_and_b32 s4, s2, 1
    s_lshl_b32 s4, s4, 7
    s_mov_b64 exec, 1
    v_mov_b32_e64 v2, 1
    buffer_atomic_add v2, off, s[20:23], s4 offset:0 sc1
    s_mov_b64 exec, -1
L_apub_30:
    s_nop 0
    v_mfma_f32_32x32x16_bf16 v[64:79], v[176:179], v[204:207], v[64:79]
    ds_read_b128 v[192:195], v212 offset:32768
    ds_read_b64_tr_b16 v[128:129], v208 offset:32768
    ds_read_b64_tr_b16 v[130:131], v208 offset:33792
    ds_read_b64_tr_b16 v[132:133], v209 offset:32768
    ds_read_b64_tr_b16 v[134:135], v209 offset:33792
    ds_read_b64_tr_b16 v[136:137], v210 offset:32768
    v_mfma_f32_16x16x32_bf16 v[232:235], v[176:179], v[236:239], v[232:235]
    ds_read_b64_tr_b16 v[138:139], v210 offset:33792
    ds_read_b64_tr_b16 v[140:141], v211 offset:32768
    v_mfma_f32_32x32x16_bf16 v[80:95], v[180:183], v[204:207], v[80:95]
    ds_read_b64_tr_b16 v[142:143], v211 offset:33792
    s_add_u32 m0, s29, 67584
    s_nop 0
    v_mfma_f32_32x32x16_bf16 v[96:111], v[184:187], v[204:207], v[96:111]
    buffer_load_dwordx4 v216, s[8:11], s27 offen offset:0 lds
    v_mfma_f32_32x32x16_bf16 v[112:127], v[188:191], v[204:207], v[112:127]
    buffer_load_dwordx4 v217, s[8:11], s27 offen offset:1024 lds
    s_waitcnt lgkmcnt(0)
    v_mfma_f32_32x32x16_bf16 v[64:79], v[128:131], v[192:195], v[64:79]
    ds_read_b128 v[196:199], v213 offset:32768
    ds_read_b64_tr_b16 v[144:145], v208 offset:36864
    ds_read_b64_tr_b16 v[146:147], v208 offset:37888
    v_mfma_f32_16x16x32_bf16 v[232:235], v[128:131], v[236:239], v[232:235]
    v_mfma_f32_32x32x16_bf16 v[80:95], v[132:135], v[192:195], v[80:95]
    buffer_load_dwordx4 v218, s[8:11], s27 offen offset:2048 lds
    ds_read_b64_tr_b16 v[148:149], v209 offset:36864
    ds_read_b64_tr_b16 v[150:151], v209 offset:37888
    v_mfma_f32_32x32x16_bf16 v[96:111], v[136:139], v[192:195], v[96:111]
    ds_read_b64_tr_b16 v[152:153], v210 offset:36864
    ds_read_b64_tr_b16 v[154:155], v210 offset:37888
    ds_read_b64_tr_b16 v[156:157], v211 offset:36864
    ds_read_b64_tr_b16 v[158:159], v211 offset:37888
    v_mfma_f32_32x32x16_bf16 v[112:127], v[140:143], v[192:195], v[112:127]
    buffer_load_dwordx4 v219, s[8:11], s27 offen offset:3072 lds
    ds_read_b128 v[200:203], v214 offset:32768
    ds_read_b64_tr_b16 v[160:161], v208 offset:40960
    s_waitcnt lgkmcnt(2)
    s_nop 0
    v_mfma_f32_32x32x16_bf16 v[64:79], v[144:147], v[196:199], v[64:79]
    ds_read_b64_tr_b16 v[162:163], v208 offset:41984
    ds_read_b64_tr_b16 v[164:165], v209 offset:40960
    s_add_u32 m0, s29, 83968
    ds_read_b64_tr_b16 v[166:167], v209 offset:41984
    ds_read_b64_tr_b16 v[168:169], v210 offset:40960
    s_add_u32 s27, s27, 128
    v_mfma_f32_16x16x32_bf16 v[232:235], v[144:147], v[236:239], v[232:235]
    ds_read_b64_tr_b16 v[170:171], v210 offset:41984
    ds_read_b64_tr_b16 v[172:173], v211 offset:40960
    v_mfma_f32_32x32x16_bf16 v[80:95], v[148:151], v[196:199], v[80:95]
    ds_read_b64_tr_b16 v[174:175], v211 offset:41984
    buffer_load_dwordx4 v220, s[16:19], s28 offen offset:0 lds
    ds_read_b128 v[204:207], v215 offset:32768
    v_mfma_f32_32x32x16_bf16 v[96:111], v[152:155], v[196:199], v[96:111]
    ds_read_b64_tr_b16 v[176:177], v208 offset:45056
    buffer_load_dwordx4 v221, s[16:19], s28 offen offset:1024 lds
    ds_read_b64_tr_b16 v[178:179], v208 offset:46080
    v_mfma_f32_32x32x16_bf16 v[112:127], v[156:159], v[196:199], v[112:127]
    s_waitcnt lgkmcnt(3)
    s_nop 0
    v_mfma_f32_32x32x16_bf16 v[64:79], v[160:163], v[200:203], v[64:79]
    ds_read_b64_tr_b16 v[180:181], v209 offset:45056
    ds_read_b64_tr_b16 v[182:183], v209 offset:46080
    ds_read_b64_tr_b16 v[184:185], v210 offset:45056
    ds_read_b64_tr_b16 v[186:187], v210 offset:46080
    ds_read_b64_tr_b16 v[188:189], v211 offset:45056
    ds_read_b64_tr_b16 v[190:191], v211 offset:46080
    v_mfma_f32_16x16x32_bf16 v[232:235], v[160:163], v[236:239], v[232:235]
    v_mfma_f32_32x32x16_bf16 v[80:95], v[164:167], v[200:203], v[80:95]
    buffer_load_dwordx4 v222, s[16:19], s28 offen offset:2048 lds
    v_mfma_f32_32x32x16_bf16 v[96:111], v[168:171], v[200:203], v[96:111]
    buffer_load_dwordx4 v223, s[16:19], s28 offen offset:3072 lds
    s_add_u32 s28, s28, 221184
    v_mfma_f32_32x32x16_bf16 v[112:127], v[172:175], v[200:203], v[112:127]
    s_waitcnt vmcnt(16) lgkmcnt(0)
    s_barrier
    v_mfma_f32_32x32x16_bf16 v[64:79], v[176:179], v[204:207], v[64:79]
    ds_read_b128 v[192:195], v244 offset:32768
    ds_read_b64_tr_b16 v[128:129], v240 offset:32768
    ds_read_b64_tr_b16 v[130:131], v240 offset:33792
    ds_read_b64_tr_b16 v[132:133], v241 offset:32768
    ds_read_b64_tr_b16 v[134:135], v241 offset:33792
    ds_read_b64_tr_b16 v[136:137], v242 offset:32768
    v_mfma_f32_16x16x32_bf16 v[232:235], v[176:179], v[236:239], v[232:235]
    ds_read_b64_tr_b16 v[138:139], v242 offset:33792
    ds_read_b64_tr_b16 v[140:141], v243 offset:32768
    v_mfma_f32_32x32x16_bf16 v[80:95], v[180:183], v[204:207], v[80:95]
    ds_read_b64_tr_b16 v[142:143], v243 offset:33792
    s_add_u32 m0, s29, 100352
    s_nop 0
    v_mfma_f32_32x32x16_bf16 v[96:111], v[184:187], v[204:207], v[96:111]
    buffer_load_dwordx4 v216, s[8:11], s27 offen offset:0 lds
    v_mfma_f32_32x32x16_bf16 v[112:127], v[188:191], v[204:207], v[112:127]
    buffer_load_dwordx4 v217, s[8:11], s27 offen offset:1024 lds
    s_waitcnt lgkmcnt(0)
    v_mfma_f32_32x32x16_bf16 v[64:79], v[128:131], v[192:195], v[64:79]
    ds_read_b128 v[196:199], v245 offset:32768
    ds_read_b64_tr_b16 v[144:145], v240 offset:36864
    ds_read_b64_tr_b16 v[146:147], v240 offset:37888
    v_mfma_f32_16x16x32_bf16 v[232:235], v[128:131], v[236:239], v[232:235]
    v_mfma_f32_32x32x16_bf16 v[80:95], v[132:135], v[192:195], v[80:95]
    buffer_load_dwordx4 v218, s[8:11], s27 offen offset:2048 lds
    ds_read_b64_tr_b16 v[148:149], v241 offset:36864
    ds_read_b64_tr_b16 v[150:151], v241 offset:37888
    v_mfma_f32_32x32x16_bf16 v[96:111], v[136:139], v[192:195], v[96:111]
    ds_read_b64_tr_b16 v[152:153], v242 offset:36864
    ds_read_b64_tr_b16 v[154:155], v242 offset:37888
    ds_read_b64_tr_b16 v[156:157], v243 offset:36864
    ds_read_b64_tr_b16 v[158:159], v243 offset:37888
    v_mfma_f32_32x32x16_bf16 v[112:127], v[140:143], v[192:195], v[112:127]
    buffer_load_dwordx4 v219, s[8:11], s27 offen offset:3072 lds
    ds_read_b128 v[200:203], v246 offset:32768
    ds_read_b64_tr_b16 v[160:161], v240 offset:40960
    s_waitcnt lgkmcnt(2)
    s_nop 0
    v_mfma_f32_32x32x16_bf16 v[64:79], v[144:147], v[196:199], v[64:79]
    ds_read_b64_tr_b16 v[162:163], v240 offset:41984
    ds_read_b64_tr_b16 v[164:165], v241 offset:40960
    s_add_u32 m0, s29, 116736
    ds_read_b64_tr_b16 v[166:167], v241 offset:41984
    ds_read_b64_tr_b16 v[168:169], v242 offset:40960
    s_add_u32 s27, s27, 128
    v_mfma_f32_16x16x32_bf16 v[232:235], v[144:147], v[236:239], v[232:235]
    ds_read_b64_tr_b16 v[170:171], v242 offset:41984
    ds_read_b64_tr_b16 v[172:173], v243 offset:40960
    v_mfma_f32_32x32x16_bf16 v[80:95], v[148:151], v[196:199], v[80:95]
    ds_read_b64_tr_b16 v[174:175], v243 offset:41984
    buffer_load_dwordx4 v220, s[16:19], s28 offen offset:0 lds
    ds_read_b128 v[204:207], v247 offset:32768
    v_mfma_f32_32x32x16_bf16 v[96:111], v[152:155], v[196:199], v[96:111]
    ds_read_b64_tr_b16 v[176:177], v240 offset:45056
    buffer_load_dwordx4 v221, s[16:19], s28 offen offset:1024 lds
    ds_read_b64_tr_b16 v[178:179], v240 offset:46080
    v_mfma_f32_32x32x16_bf16 v[112:127], v[156:159], v[196:199], v[112:127]
    s_waitcnt lgkmcnt(3)
    s_nop 0
    v_mfma_f32_32x32x16_bf16 v[64:79], v[160:163], v[200:203], v[64:79]
    ds_read_b64_tr_b16 v[180:181], v241 offset:45056
    ds_read_b64_tr_b16 v[182:183], v241 offset:46080
    ds_read_b64_tr_b16 v[184:185], v242 offset:45056
    ds_read_b64_tr_b16 v[186:187], v242 offset:46080
    ds_read_b64_tr_b16 v[188:189], v243 offset:45056
    ds_read_b64_tr_b16 v[190:191], v243 offset:46080
    v_mfma_f32_16x16x32_bf16 v[232:235], v[160:163], v[236:239], v[232:235]
    v_mfma_f32_32x32x16_bf16 v[80:95], v[164:167], v[200:203], v[80:95]
    buffer_load_dwordx4 v222, s[16:19], s28 offen offset:2048 lds
    v_mfma_f32_32x32x16_bf16 v[96:111], v[168:171], v[200:203], v[96:111]
    buffer_load_dwordx4 v223, s[16:19], s28 offen offset:3072 lds
    s_add_u32 s28, s28, 221184
    v_mfma_f32_32x32x16_bf16 v[112:127], v[172:175], v[200:203], v[112:127]
    s_waitcnt vmcnt(16) lgkmcnt(0)
    s_barrier
    v_mfma_f32_32x32x16_bf16 v[64:79], v[176:179], v[204:207], v[64:79]
    ds_read_b128 v[192:195], v244 offset:0
    ds_read_b64_tr_b16 v[128:129], v240 offset:0
    ds_read_b64_tr_b16 v[130:131], v240 offset:1024
    ds_read_b64_tr_b16 v[132:133], v241 offset:0
    ds_read_b64_tr_b16 v[134:135], v241 offset:1024
    ds_read_b64_tr_b16 v[136:137], v242 offset:0
    v_mfma_f32_16x16x32_bf16 v[232:235], v[176:179], v[236:239], v[232:235]
    ds_read_b64_tr_b16 v[138:139], v242 offset:1024
    ds_read_b64_tr_b16 v[140:141], v243 offset:0
    v_mfma_f32_32x32x16_bf16 v[80:95], v[180:183], v[204:207], v[80:95]
    ds_read_b64_tr_b16 v[142:143], v243 offset:1024
    s_add_u32 m0, s29, 34816
    s_nop 0
    v_mfma_f32_32x32x16_bf16 v[96:111], v[184:187], v[204:207], v[96:111]
    buffer_load_dwordx4 v216, s[8:11], s27 offen offset:0 lds
    v_mfma_f32_32x32x16_bf16 v[112:127], v[188:191], v[204:207], v[112:127]
    buffer_load_dwordx4 v217, s[8:11], s27 offen offset:1024 lds
    s_waitcnt lgkmcnt(0)
    v_mfma_f32_32x32x16_bf16 v[64:79], v[128:131], v[192:195], v[64:79]
    ds_read_b128 v[196:199], v245 offset:0
    ds_read_b64_tr_b16 v[144:145], v240 offset:4096
    ds_read_b64_tr_b16 v[146:147], v240 offset:5120
    v_mfma_f32_16x16x32_bf16 v[232:235], v[128:131], v[236:239], v[232:235]
    v_mfma_f32_32x32x16_bf16 v[80:95], v[132:135], v[192:195], v[80:95]
    buffer_load_dwordx4 v218, s[8:11], s27 offen offset:2048 lds
    ds_read_b64_tr_b16 v[148:149], v241 offset:4096
    ds_read_b64_tr_b16 v[150:151], v241 offset:5120
    v_mfma_f32_32x32x16_bf16 v[96:111], v[136:139], v[192:195], v[96:111]
    ds_read_b64_tr_b16 v[152:153], v242 offset:4096
    ds_read_b64_tr_b16 v[154:155], v242 offset:5120
    ds_read_b64_tr_b16 v[156:157], v243 offset:4096
    ds_read_b64_tr_b16 v[158:159], v243 offset:5120
    v_mfma_f32_32x32x16_bf16 v[112:127], v[140:143], v[192:195], v[112:127]
    buffer_load_dwordx4 v219, s[8:11], s27 offen offset:3072 lds
    ds_read_b128 v[200:203], v246 offset:0
    ds_read_b64_tr_b16 v[160:161], v240 offset:8192
    s_waitcnt lgkmcnt(2)
    s_nop 0
    v_mfma_f32_32x32x16_bf16 v[64:79], v[144:147], v[196:199], v[64:79]
    ds_read_b64_tr_b16 v[162:163], v240 offset:9216
    ds_read_b64_tr_b16 v[164:165], v241 offset:8192
    s_add_u32 m0, s29, 51200
    ds_read_b64_tr_b16 v[166:167], v241 offset:9216
    ds_read_b64_tr_b16 v[168:169], v242 offset:8192
    s_add_u32 s27, s27, 128
    v_mfma_f32_16x16x32_bf16 v[232:235], v[144:147], v[236:239], v[232:235]
    ds_read_b64_tr_b16 v[170:171], v242 offset:9216
    ds_read_b64_tr_b16 v[172:173], v243 offset:8192
    v_mfma_f32_32x32x16_bf16 v[80:95], v[148:151], v[196:199], v[80:95]
    ds_read_b64_tr_b16 v[174:175], v243 offset:9216
    buffer_load_dwordx4 v220, s[16:19], s28 offen offset:0 lds
    ds_read_b128 v[204:207], v247 offset:0
    v_mfma_f32_32x32x16_bf16 v[96:111], v[152:155], v[196:199], v[96:111]
    ds_read_b64_tr_b16 v[176:177], v240 offset:12288
    buffer_load_dwordx4 v221, s[16:19], s28 offen offset:1024 lds
    ds_read_b64_tr_b16 v[178:179], v240 offset:13312
    v_mfma_f32_32x32x16_bf16 v[112:127], v[156:159], v[196:199], v[112:127]
    s_waitcnt lgkmcnt(3)
    s_nop 0
    v_mfma_f32_32x32x16_bf16 v[64:79], v[160:163], v[200:203], v[64:79]
    ds_read_b64_tr_b16 v[180:181], v241 offset:12288
    ds_read_b64_tr_b16 v[182:183], v241 offset:13312
    ds_read_b64_tr_b16 v[184:185], v242 offset:12288
    ds_read_b64_tr_b16 v[186:187], v242 offset:13312
    ds_read_b64_tr_b16 v[188:189], v243 offset:12288
    ds_read_b64_tr_b16 v[190:191], v243 offset:13312
    v_mfma_f32_16x16x32_bf16 v[232:235], v[160:163], v[236:239], v[232:235]
    v_mfma_f32_32x32x16_bf16 v[80:95], v[164:167], v[200:203], v[80:95]
    buffer_load_dwordx4 v222, s[16:19], s28 offen offset:2048 lds
    v_mfma_f32_32x32x16_bf16 v[96:111], v[168:171], v[200:203], v[96:111]
    buffer_load_dwordx4 v223, s[16:19], s28 offen offset:3072 lds
    s_add_u32 s28, s28, 221184
    v_mfma_f32_32x32x16_bf16 v[112:127], v[172:175], v[200:203], v[112:127]
    s_waitcnt vmcnt(16) lgkmcnt(0)
    s_barrier
    v_mfma_f32_32x32x16_bf16 v[64:79], v[176:179], v[204:207], v[64:79]
    ds_read_b128 v[192:195], v212 offset:0
    ds_read_b64_tr_b16 v[128:129], v208 offset:0
    ds_read_b64_tr_b16 v[130:131], v208 offset:1024
    ds_read_b64_tr_b16 v[132:133], v209 offset:0
    ds_read_b64_tr_b16 v[134:135], v209 offset:1024
    ds_read_b64_tr_b16 v[136:137], v210 offset:0
    v_mfma_f32_16x16x32_bf16 v[232:235], v[176:179], v[236:239], v[232:235]
    ds_read_b64_tr_b16 v[138:139], v210 offset:1024
    ds_read_b64_tr_b16 v[140:141], v211 offset:0
    v_mfma_f32_32x32x16_bf16 v[80:95], v[180:183], v[204:207], v[80:95]
    ds_read_b64_tr_b16 v[142:143], v211 offset:1024
    s_add_u32 m0, s29, 2048
    s_nop 0
    v_mfma_f32_32x32x16_bf16 v[96:111], v[184:187], v[204:207], v[96:111]
    buffer_load_dwordx4 v216, s[8:11], s27 offen offset:0 lds
    v_mfma_f32_32x32x16_bf16 v[112:127], v[188:191], v[204:207], v[112:127]
    buffer_load_dwordx4 v217, s[8:11], s27 offen offset:1024 lds
    s_waitcnt lgkmcnt(0)
    v_mfma_f32_32x32x16_bf16 v[64:79], v[128:131], v[192:195], v[64:79]
    ds_read_b128 v[196:199], v213 offset:0
    ds_read_b64_tr_b16 v[144:145], v208 offset:4096
    ds_read_b64_tr_b16 v[146:147], v208 offset:5120
    v_mfma_f32_16x16x32_bf16 v[232:235], v[128:131], v[236:239], v[232:235]
    v_mfma_f32_32x32x16_bf16 v[80:95], v[132:135], v[192:195], v[80:95]
    buffer_load_dwordx4 v218, s[8:11], s27 offen offset:2048 lds
    ds_read_b64_tr_b16 v[148:149], v209 offset:4096
    ds_read_b64_tr_b16 v[150:151], v209 offset:5120
    v_mfma_f32_32x32x16_bf16 v[96:111], v[136:139], v[192:195], v[96:111]
    ds_read_b64_tr_b16 v[152:153], v210 offset:4096
    ds_read_b64_tr_b16 v[154:155], v210 offset:5120
    ds_read_b64_tr_b16 v[156:157], v211 offset:4096
    ds_read_b64_tr_b16 v[158:159], v211 offset:5120
    v_mfma_f32_32x32x16_bf16 v[112:127], v[140:143], v[192:195], v[112:127]
    buffer_load_dwordx4 v219, s[8:11], s27 offen offset:3072 lds
    ds_read_b128 v[200:203], v214 offset:0
    ds_read_b64_tr_b16 v[160:161], v208 offset:8192
    s_waitcnt lgkmcnt(2)
    s_nop 0
    v_mfma_f32_32x32x16_bf16 v[64:79], v[144:147], v[196:199], v[64:79]
    ds_read_b64_tr_b16 v[162:163], v208 offset:9216
    ds_read_b64_tr_b16 v[164:165], v209 offset:8192
    s_add_u32 m0, s29, 18432
    ds_read_b64_tr_b16 v[166:167], v209 offset:9216
    ds_read_b64_tr_b16 v[168:169], v210 offset:8192
    s_add_u32 s27, s27, 128
    v_mfma_f32_16x16x32_bf16 v[232:235], v[144:147], v[236:239], v[232:235]
    ds_read_b64_tr_b16 v[170:171], v210 offset:9216
    ds_read_b64_tr_b16 v[172:173], v211 offset:8192
    v_mfma_f32_32x32x16_bf16 v[80:95], v[148:151], v[196:199], v[80:95]
    ds_read_b64_tr_b16 v[174:175], v211 offset:9216
    buffer_load_dwordx4 v220, s[16:19], s28 offen offset:0 lds
    ds_read_b128 v[204:207], v215 offset:0
    v_mfma_f32_32x32x16_bf16 v[96:111], v[152:155], v[196:199], v[96:111]
    ds_read_b64_tr_b16 v[176:177], v208 offset:12288
    buffer_load_dwordx4 v221, s[16:19], s28 offen offset:1024 lds
    ds_read_b64_tr_b16 v[178:179], v208 offset:13312
    v_mfma_f32_32x32x16_bf16 v[112:127], v[156:159], v[196:199], v[112:127]
    s_waitcnt lgkmcnt(3)
    s_nop 0
    v_mfma_f32_32x32x16_bf16 v[64:79], v[160:163], v[200:203], v[64:79]
    ds_read_b64_tr_b16 v[180:181], v209 offset:12288
    ds_read_b64_tr_b16 v[182:183], v209 offset:13312
    ds_read_b64_tr_b16 v[184:185], v210 offset:12288
    ds_read_b64_tr_b16 v[186:187], v210 offset:13312
    ds_read_b64_tr_b16 v[188:189], v211 offset:12288
    ds_read_b64_tr_b16 v[190:191], v211 offset:13312
    v_mfma_f32_16x16x32_bf16 v[232:235], v[160:163], v[236:239], v[232:235]
    v_mfma_f32_32x32x16_bf16 v[80:95], v[164:167], v[200:203], v[80:95]
    buffer_load_dwordx4 v222, s[16:19], s28 offen offset:2048 lds
    v_mfma_f32_32x32x16_bf16 v[96:111], v[168:171], v[200:203], v[96:111]
    buffer_load_dwordx4 v223, s[16:19], s28 offen offset:3072 lds
    s_add_u32 s28, s28, 221184
    v_mfma_f32_32x32x16_bf16 v[112:127], v[172:175], v[200:203], v[112:127]
    s_waitcnt vmcnt(16) lgkmcnt(0)
    s_barrier
    v_mfma_f32_32x32x16_bf16 v[64:79], v[176:179], v[204:207], v[64:79]
    ds_read_b128 v[192:195], v212 offset:32768
    ds_read_b64_tr_b16 v[128:129], v208 offset:32768
    ds_read_b64_tr_b16 v[130:131], v208 offset:33792
    ds_read_b64_tr_b16 v[132:133], v209 offset:32768
    ds_read_b64_tr_b16 v[134:135], v209 offset:33792
    ds_read_b64_tr_b16 v[136:137], v210 offset:32768
    v_mfma_f32_16x16x32_bf16 v[232:235], v[176:179], v[236:239], v[232:235]
    ds_read_b64_tr_b16 v[138:139], v210 offset:33792
    ds_read_b64_tr_b16 v[140:141], v211 offset:32768
    v_mfma_f32_32x32x16_bf16 v[80:95], v[180:183], v[204:207], v[80:95]
    ds_read_b64_tr_b16 v[142:143], v211 offset:33792
    s_add_u32 m0, s29, 67584
    s_nop 0
    v_mfma_f32_32x32x16_bf16 v[96:111], v[184:187], v[204:207], v[96:111]
    buffer_load_dwordx4 v216, s[8:11], s27 offen offset:0 lds
    v_mfma_f32_32x32x16_bf16 v[112:127], v[188:191], v[204:207], v[112:127]
    buffer_load_dwordx4 v217, s[8:11], s27 offen offset:1024 lds
    s_waitcnt lgkmcnt(0)
    v_mfma_f32_32x32x16_bf16 v[64:79], v[128:131], v[192:195], v[64:79]
    ds_read_b128 v[196:199], v213 offset:32768
    ds_read_b64_tr_b16 v[144:145], v208 offset:36864
    ds_read_b64_tr_b16 v[146:147], v208 offset:37888
    v_mfma_f32_16x16x32_bf16 v[232:235], v[128:131], v[236:239], v[232:235]
    v_mfma_f32_32x32x16_bf16 v[80:95], v[132:135], v[192:195], v[80:95]
    buffer_load_dwordx4 v218, s[8:11], s27 offen offset:2048 lds
    ds_read_b64_tr_b16 v[148:149], v209 offset:36864
    ds_read_b64_tr_b16 v[150:151], v209 offset:37888
    v_mfma_f32_32x32x16_bf16 v[96:111], v[136:139], v[192:195], v[96:111]
    ds_read_b64_tr_b16 v[152:153], v210 offset:36864
    ds_read_b64_tr_b16 v[154:155], v210 offset:37888
    ds_read_b64_tr_b16 v[156:157], v211 offset:36864
    ds_read_b64_tr_b16 v[158:159], v211 offset:37888
    v_mfma_f32_32x32x16_bf16 v[112:127], v[140:143], v[192:195], v[112:127]
    buffer_load_dwordx4 v219, s[8:11], s27 offen offset:3072 lds
    ds_read_b128 v[200:203], v214 offset:32768
    ds_read_b64_tr_b16 v[160:161], v208 offset:40960
    s_waitcnt lgkmcnt(2)
    s_nop 0
    v_mfma_f32_32x32x16_bf16 v[64:79], v[144:147], v[196:199], v[64:79]
    ds_read_b64_tr_b16 v[162:163], v208 offset:41984
    ds_read_b64_tr_b16 v[164:165], v209 offset:40960
    s_add_u32 m0, s29, 83968
    ds_read_b64_tr_b16 v[166:167], v209 offset:41984
    ds_read_b64_tr_b16 v[168:169], v210 offset:40960
    s_add_u32 s27, s27, 128
    v_mfma_f32_16x16x32_bf16 v[232:235], v[144:147], v[236:239], v[232:235]
    ds_read_b64_tr_b16 v[170:171], v210 offset:41984
    ds_read_b64_tr_b16 v[172:173], v211 offset:40960
    v_mfma_f32_32x32x16_bf16 v[80:95], v[148:151], v[196:199], v[80:95]
    ds_read_b64_tr_b16 v[174:175], v211 offset:41984
    buffer_load_dwordx4 v220, s[16:19], s28 offen offset:0 lds
    ds_read_b128 v[204:207], v215 offset:32768
    v_mfma_f32_32x32x16_bf16 v[96:111], v[152:155], v[196:199], v[96:111]
    ds_read_b64_tr_b16 v[176:177], v208 offset:45056
    buffer_load_dwordx4 v221, s[16:19], s28 offen offset:1024 lds
    ds_read_b64_tr_b16 v[178:179], v208 offset:46080
    v_mfma_f32_32x32x16_bf16 v[112:127], v[156:159], v[196:199], v[112:127]
    s_waitcnt lgkmcnt(3)
    s_nop 0
    v_mfma_f32_32x32x16_bf16 v[64:79], v[160:163], v[200:203], v[64:79]
    ds_read_b64_tr_b16 v[180:181], v209 offset:45056
    ds_read_b64_tr_b16 v[182:183], v209 offset:46080
    ds_read_b64_tr_b16 v[184:185], v210 offset:45056
    ds_read_b64_tr_b16 v[186:187], v210 offset:46080
    ds_read_b64_tr_b16 v[188:189], v211 offset:45056
    ds_read_b64_tr_b16 v[190:191], v211 offset:46080
    v_mfma_f32_16x16x32_bf16 v[232:235], v[160:163], v[236:239], v[232:235]
    v_mfma_f32_32x32x16_bf16 v[80:95], v[164:167], v[200:203], v[80:95]
    buffer_load_dwordx4 v222, s[16:19], s28 offen offset:2048 lds
    v_mfma_f32_32x32x16_bf16 v[96:111], v[168:171], v[200:203], v[96:111]
    buffer_load_dwordx4 v223, s[16:19], s28 offen offset:3072 lds
    s_add_u32 s28, s28, 221184
    v_mfma_f32_32x32x16_bf16 v[112:127], v[172:175], v[200:203], v[112:127]
    s_waitcnt vmcnt(16) lgkmcnt(0)
    s_barrier
    v_mfma_f32_32x32x16_bf16 v[64:79], v[176:179], v[204:207], v[64:79]
    ds_read_b128 v[192:195], v244 offset:32768
    ds_read_b64_tr_b16 v[128:129], v240 offset:32768
    ds_read_b64_tr_b16 v[130:131], v240 offset:33792
    ds_read_b64_tr_b16 v[132:133], v241 offset:32768
    ds_read_b64_tr_b16 v[134:135], v241 offset:33792
    ds_read_b64_tr_b16 v[136:137], v242 offset:32768
    v_mfma_f32_16x16x32_bf16 v[232:235], v[176:179], v[236:239], v[232:235]
    ds_read_b64_tr_b16 v[138:139], v242 offset:33792
    ds_read_b64_tr_b16 v[140:141], v243 offset:32768
    v_mfma_f32_32x32x16_bf16 v[80:95], v[180:183], v[204:207], v[80:95]
    ds_read_b64_tr_b16 v[142:143], v243 offset:33792
    s_add_u32 m0, s29, 100352
    s_nop 0
    v_mfma_f32_32x32x16_bf16 v[96:111], v[184:187], v[204:207], v[96:111]
    buffer_load_dwordx4 v216, s[8:11], s27 offen offset:0 lds
    v_mfma_f32_32x32x16_bf16 v[112:127], v[188:191], v[204:207], v[112:127]
    buffer_load_dwordx4 v217, s[8:11], s27 offen offset:1024 lds
    s_waitcnt lgkmcnt(0)
    v_mfma_f32_32x32x16_bf16 v[64:79], v[128:131], v[192:195], v[64:79]
    ds_read_b128 v[196:199], v245 offset:32768
    ds_read_b64_tr_b16 v[144:145], v240 offset:36864
    ds_read_b64_tr_b16 v[146:147], v240 offset:37888
    v_mfma_f32_16x16x32_bf16 v[232:235], v[128:131], v[236:239], v[232:235]
    v_mfma_f32_32x32x16_bf16 v[80:95], v[132:135], v[192:195], v[80:95]
    buffer_load_dwordx4 v218, s[8:11], s27 offen offset:2048 lds
    ds_read_b64_tr_b16 v[148:149], v241 offset:36864
    ds_read_b64_tr_b16 v[150:151], v241 offset:37888
    v_mfma_f32_32x32x16_bf16 v[96:111], v[136:139], v[192:195], v[96:111]
    ds_read_b64_tr_b16 v[152:153], v242 offset:36864
    ds_read_b64_tr_b16 v[154:155], v242 offset:37888
    ds_read_b64_tr_b16 v[156:157], v243 offset:36864
    ds_read_b64_tr_b16 v[158:159], v243 offset:37888
    v_mfma_f32_32x32x16_bf16 v[112:127], v[140:143], v[192:195], v[112:127]
    buffer_load_dwordx4 v219, s[8:11], s27 offen offset:3072 lds
    ds_read_b128 v[200:203], v246 offset:32768
    ds_read_b64_tr_b16 v[160:161], v240 offset:40960
    s_waitcnt lgkmcnt(2)
    s_nop 0
    v_mfma_f32_32x32x16_bf16 v[64:79], v[144:147], v[196:199], v[64:79]
    ds_read_b64_tr_b16 v[162:163], v240 offset:41984
    ds_read_b64_tr_b16 v[164:165], v241 offset:40960
    s_add_u32 m0, s29, 116736
    ds_read_b64_tr_b16 v[166:167], v241 offset:41984
    ds_read_b64_tr_b16 v[168:169], v242 offset:40960
    s_add_u32 s27, s27, 128
    v_mfma_f32_16x16x32_bf16 v[232:235], v[144:147], v[236:239], v[232:235]
    ds_read_b64_tr_b16 v[170:171], v242 offset:41984
    ds_read_b64_tr_b16 v[172:173], v243 offset:40960
    v_mfma_f32_32x32x16_bf16 v[80:95], v[148:151], v[196:199], v[80:95]
    ds_read_b64_tr_b16 v[174:175], v243 offset:41984
    buffer_load_dwordx4 v220, s[16:19], s28 offen offset:0 lds
    ds_read_b128 v[204:207], v247 offset:32768
    v_mfma_f32_32x32x16_bf16 v[96:111], v[152:155], v[196:199], v[96:111]
    ds_read_b64_tr_b16 v[176:177], v240 offset:45056
    buffer_load_dwordx4 v221, s[16:19], s28 offen offset:1024 lds
    ds_read_b64_tr_b16 v[178:179], v240 offset:46080
    v_mfma_f32_32x32x16_bf16 v[112:127], v[156:159], v[196:199], v[112:127]
    s_waitcnt lgkmcnt(3)
    s_nop 0
    v_mfma_f32_32x32x16_bf16 v[64:79], v[160:163], v[200:203], v[64:79]
    ds_read_b64_tr_b16 v[180:181], v241 offset:45056
    ds_read_b64_tr_b16 v[182:183], v241 offset:46080
    ds_read_b64_tr_b16 v[184:185], v242 offset:45056
    ds_read_b64_tr_b16 v[186:187], v242 offset:46080
    ds_read_b64_tr_b16 v[188:189], v243 offset:45056
    ds_read_b64_tr_b16 v[190:191], v243 offset:46080
    v_mfma_f32_16x16x32_bf16 v[232:235], v[160:163], v[236:239], v[232:235]
    v_mfma_f32_32x32x16_bf16 v[80:95], v[164:167], v[200:203], v[80:95]
    buffer_load_dwordx4 v222, s[16:19], s28 offen offset:2048 lds
    v_mfma_f32_32x32x16_bf16 v[96:111], v[168:171], v[200:203], v[96:111]
    buffer_load_dwordx4 v223, s[16:19], s28 offen offset:3072 lds
    s_add_u32 s28, s28, 221184
    v_mfma_f32_32x32x16_bf16 v[112:127], v[172:175], v[200:203], v[112:127]
    s_waitcnt vmcnt(16) lgkmcnt(0)
    s_barrier
    v_mfma_f32_32x32x16_bf16 v[64:79], v[176:179], v[204:207], v[64:79]
    ds_read_b128 v[192:195], v244 offset:0
    ds_read_b64_tr_b16 v[128:129], v240 offset:0
    ds_read_b64_tr_b16 v[130:131], v240 offset:1024
    ds_read_b64_tr_b16 v[132:133], v241 offset:0
    ds_read_b64_tr_b16 v[134:135], v241 offset:1024
    ds_read_b64_tr_b16 v[136:137], v242 offset:0
    v_mfma_f32_16x16x32_bf16 v[232:235], v[176:179], v[236:239], v[232:235]
    ds_read_b64_tr_b16 v[138:139], v242 offset:1024
    ds_read_b64_tr_b16 v[140:141], v243 offset:0
    v_mfma_f32_32x32x16_bf16 v[80:95], v[180:183], v[204:207], v[80:95]
    ds_read_b64_tr_b16 v[142:143], v243 offset:1024
    v_mfma_f32_32x32x16_bf16 v[96:111], v[184:187], v[204:207], v[96:111]
    v_mfma_f32_32x32x16_bf16 v[112:127], v[188:191], v[204:207], v[112:127]
    s_waitcnt lgkmcnt(0)
    s_nop 0
    v_mfma_f32_32x32x16_bf16 v[64:79], v[128:131], v[192:195], v[64:79]
    ds_read_b128 v[196:199], v245 offset:0
    ds_read_b64_tr_b16 v[144:145], v240 offset:4096
    ds_read_b64_tr_b16 v[146:147], v240 offset:5120
    ds_read_b64_tr_b16 v[148:149], v241 offset:4096
    ds_read_b64_tr_b16 v[150:151], v241 offset:5120
    ds_read_b64_tr_b16 v[152:153], v242 offset:4096
    v_mfma_f32_16x16x32_bf16 v[232:235], v[128:131], v[236:239], v[232:235]
    ds_read_b64_tr_b16 v[154:155], v242 offset:5120
    ds_read_b64_tr_b16 v[156:157], v243 offset:4096
    v_mfma_f32_32x32x16_bf16 v[80:95], v[132:135], v[192:195], v[80:95]
    ds_read_b64_tr_b16 v[158:159], v243 offset:5120
    ds_read_b128 v[200:203], v246 offset:0
    ds_read_b64_tr_b16 v[160:161], v240 offset:8192
    v_mfma_f32_32x32x16_bf16 v[96:111], v[136:139], v[192:195], v[96:111]
    v_mfma_f32_32x32x16_bf16 v[112:127], v[140:143], v[192:195], v[112:127]
    s_waitcnt lgkmcnt(2)
    v_mfma_f32_32x32x16_bf16 v[64:79], v[144:147], v[196:199], v[64:79]
    ds_read_b64_tr_b16 v[162:163], v240 offset:9216
    ds_read_b64_tr_b16 v[164:165], v241 offset:8192
    ds_read_b64_tr_b16 v[166:167], v241 offset:9216
    s_mov_b32 s20, s62
    s_mov_b32 s21, s63
    s_nop 0
    s_mov_b32 s22, 256
    s_mov_b32 s23, 0x00020000
    ds_read_b64_tr_b16 v[168:169], v242 offset:8192
    ds_read_b64_tr_b16 v[170:171], v242 offset:9216
    v_mfma_f32_16x16x32_bf16 v[232:235], v[144:147], v[236:239], v[232:235]
    ds_read_b64_tr_b16 v[172:173], v243 offset:8192
    ds_read_b64_tr_b16 v[174:175], v243 offset:9216
    v_mfma_f32_32x32x16_bf16 v[80:95], v[148:151], v[196:199], v[80:95]
    ds_read_b128 v[204:207], v247 offset:0
    buffer_load_dword v56, v37, s[20:23], 0 offen sc1
    ds_read_b64_tr_b16 v[176:177], v240 offset:12288
    v_mfma_f32_32x32x16_bf16 v[96:111], v[152:155], v[196:199], v[96:111]
    ds_read_b64_tr_b16 v[178:179], v240 offset:13312
    v_mfma_f32_32x32x16_bf16 v[112:127], v[156:159], v[196:199], v[112:127]
    s_waitcnt lgkmcnt(3)
    s_nop 0
    v_mfma_f32_32x32x16_bf16 v[64:79], v[160:163], v[200:203], v[64:79]
    ds_read_b64_tr_b16 v[180:181], v241 offset:12288
    ds_read_b64_tr_b16 v[182:183], v241 offset:13312
    ds_read_b64_tr_b16 v[184:185], v242 offset:12288
    ds_read_b64_tr_b16 v[186:187], v242 offset:13312
    ds_read_b64_tr_b16 v[188:189], v243 offset:12288
    ds_read_b64_tr_b16 v[190:191], v243 offset:13312
    v_mfma_f32_16x16x32_bf16 v[232:235], v[160:163], v[236:239], v[232:235]
    v_mfma_f32_32x32x16_bf16 v[80:95], v[164:167], v[200:203], v[80:95]
    v_mfma_f32_32x32x16_bf16 v[96:111], v[168:171], v[200:203], v[96:111]
    v_mfma_f32_32x32x16_bf16 v[112:127], v[172:175], v[200:203], v[112:127]
    s_waitcnt vmcnt(9) lgkmcnt(0)
    s_barrier
    v_mfma_f32_32x32x16_bf16 v[64:79], v[176:179], v[204:207], v[64:79]
    ds_read_b128 v[192:195], v212 offset:0
    ds_read_b64_tr_b16 v[128:129], v208 offset:0
    ds_read_b64_tr_b16 v[130:131], v208 offset:1024
    ds_read_b64_tr_b16 v[132:133], v209 offset:0
    ds_read_b64_tr_b16 v[134:135], v209 offset:1024
    ds_read_b64_tr_b16 v[136:137], v210 offset:0
    v_mfma_f32_16x16x32_bf16 v[232:235], v[176:179], v[236:239], v[232:235]
    ds_read_b64_tr_b16 v[138:139], v210 offset:1024
    ds_read_b64_tr_b16 v[140:141], v211 offset:0
    v_mfma_f32_32x32x16_bf16 v[80:95], v[180:183], v[204:207], v[80:95]
    ds_read_b64_tr_b16 v[142:143], v211 offset:1024
    v_mfma_f32_32x32x16_bf16 v[96:111], v[184:187], v[204:207], v[96:111]
    v_mfma_f32_32x32x16_bf16 v[112:127], v[188:191], v[204:207], v[112:127]
    s_waitcnt lgkmcnt(0)
    s_nop 0
    v_mfma_f32_32x32x16_bf16 v[64:79], v[128:131], v[192:195], v[64:79]
    ds_read_b128 v[196:199], v213 offset:0
    ds_read_b64_tr_b16 v[144:145], v208 offset:4096
    ds_read_b64_tr_b16 v[146:147], v208 offset:5120
    ds_read_b64_tr_b16 v[148:149], v209 offset:4096
    ds_read_b64_tr_b16 v[150:151], v209 offset:5120
    ds_read_b64_tr_b16 v[152:153], v210 offset:4096
    v_mfma_f32_16x16x32_bf16 v[232:235], v[128:131], v[236:239], v[232:235]
    ds_read_b64_tr_b16 v[154:155], v210 offset:5120
    ds_read_b64_tr_b16 v[156:157], v211 offset:4096
    v_mfma_f32_32x32x16_bf16 v[80:95], v[132:135], v[192:195], v[80:95]
    ds_read_b64_tr_b16 v[158:159], v211 offset:5120
    ds_read_b128 v[200:203], v214 offset:0
    ds_read_b64_tr_b16 v[160:161], v208 offset:8192
    v_mfma_f32_32x32x16_bf16 v[96:111], v[136:139], v[192:195], v[96:111]
    v_mfma_f32_32x32x16_bf16 v[112:127], v[140:143], v[192:195], v[112:127]
    s_waitcnt lgkmcnt(2)
    s_nop 0
    v_mfma_f32_32x32x16_bf16 v[64:79], v[144:147], v[196:199], v[64:79]
    ds_read_b64_tr_b16 v[162:163], v208 offset:9216
    ds_read_b64_tr_b16 v[164:165], v209 offset:8192
    ds_read_b64_tr_b16 v[166:167], v209 offset:9216
    ds_read_b64_tr_b16 v[168:169], v210 offset:8192
    ds_read_b64_tr_b16 v[170:171], v210 offset:9216
    ds_read_b64_tr_b16 v[172:173], v211 offset:8192
    v_mfma_f32_16x16x32_bf16 v[232:235], v[144:147], v[236:239], v[232:235]
    ds_read_b64_tr_b16 v[174:175], v211 offset:9216
    ds_read_b128 v[204:207], v215 offset:0
    v_mfma_f32_32x32x16_bf16 v[80:95], v[148:151], v[196:199], v[80:95]
    ds_read_b64_tr_b16 v[176:177], v208 offset:12288
    ds_read_b64_tr_b16 v[178:179], v208 offset:13312
    v_mfma_f32_32x32x16_bf16 v[96:111], v[152:155], v[196:199], v[96:111]
    v_mfma_f32_32x32x16_bf16 v[112:127], v[156:159], v[196:199], v[112:127]
    s_waitcnt vmcnt(63)
    v_lshlrev_b32 v229, 16, v229
    ds_write_b32 v228, v229
    s_waitcnt lgkmcnt(4)
    s_nop 0
    v_mfma_f32_32x32x16_bf16 v[64:79], v[160:163], v[200:203], v[64:79]
    ds_read_b64_tr_b16 v[180:181], v209 offset:12288
    ds_read_b64_tr_b16 v[182:183], v209 offset:13312
    ds_read_b64_tr_b16 v[184:185], v210 offset:12288
    ds_read_b64_tr_b16 v[186:187], v210 offset:13312
    ds_read_b64_tr_b16 v[188:189], v211 offset:12288
    ds_read_b64_tr_b16 v[190:191], v211 offset:13312
    v_mfma_f32_16x16x32_bf16 v[232:235], v[160:163], v[236:239], v[232:235]
    v_mfma_f32_32x32x16_bf16 v[80:95], v[164:167], v[200:203], v[80:95]
    v_mfma_f32_32x32x16_bf16 v[96:111], v[168:171], v[200:203], v[96:111]
    v_mfma_f32_32x32x16_bf16 v[112:127], v[172:175], v[200:203], v[112:127]
    s_waitcnt vmcnt(1) lgkmcnt(0)
    s_mov_b32 s5, 0
    s_cmp_lg_u32 s3, 0
    s_cbranch_scc1 L_pok_31
    s_waitcnt vmcnt(0)
L_ptop_32:
    v_cmp_gt_u32 vcc, 0x80, v56
    s_and_b32 s6, vcc_lo, 3
    s_cbranch_scc0 L_pok_31
    s_add_u32 s5, s5, 1
    s_cmp_gt_u32 s5, 200000
    s_cbranch_scc1 L_pok_31
    s_sleep 8
L_pld_33:
    s_mov_b64 exec, 3
    buffer_load_dword v56, v37, s[20:23], 0 offen sc1
    s_mov_b64 exec, -1
    s_waitcnt vmcnt(0)
    s_branch L_ptop_32
L_pok_31:
    s_barrier
    s_nop 0
    v_mfma_f32_32x32x16_bf16 v[64:79], v[176:179], v[204:207], v[64:79]
    ds_read_b128 v[192:195], v212 offset:32768
    ds_read_b64_tr_b16 v[128:129], v208 offset:32768
    ds_read_b64_tr_b16 v[130:131], v208 offset:33792
    ds_read_b64_tr_b16 v[132:133], v209 offset:32768
    ds_read_b64_tr_b16 v[134:135], v209 offset:33792
    ds_read_b64_tr_b16 v[136:137], v210 offset:32768
    v_mfma_f32_16x16x32_bf16 v[232:235], v[176:179], v[236:239], v[232:235]
    ds_read_b64_tr_b16 v[138:139], v210 offset:33792
    ds_read_b64_tr_b16 v[140:141], v211 offset:32768
    v_mfma_f32_32x32x16_bf16 v[80:95], v[180:183], v[204:207], v[80:95]
    ds_read_b64_tr_b16 v[142:143], v211 offset:33792
    v_mfma_f32_32x32x16_bf16 v[96:111], v[184:187], v[204:207], v[96:111]
    v_mfma_f32_32x32x16_bf16 v[112:127], v[188:191], v[204:207], v[112:127]
    v_and_b32 v2, 31, v0
    v_lshlrev_b32_e64 v2, 4, v2
    s_lshl_b32 s4, s3, 5
    s_add_u32 s4, s4, s24
    s_lshl_b32 s4, s4, 4
    s_add_u32 s4, s4, 2621440
    buffer_load_dwordx2 v[226:227], v2, s[12:15], s4 offen sc1
    v_lshlrev_b32_e64 v252, 4, v0
    s_mul_i32 s4, s75, 5120
    s_mul_i32 s5, s3, 40960
    s_add_u32 s4, s4, s5
    s_add_u32 s77, s4, 5308416
    s_add_u32 s73, s77, 4096
    s_mov_b32 s44, 0
    s_sub_u32 s38, 13, s44
    s_cmp_lt_u32 s3, 2
    s_cselect_b32 s6, 0, 16777216
    s_add_u32 s39, s6, 163840
    s_sub_u32 s40, -2129920, s6
    s_add_u32 s41, s6, 4096
    s_sub_u32 s42, -53248, s6
    s_cmp_eq_u32 s38, 0
    s_cselect_b32 s31, s6, 0
    s_mul_i32 s4, s44, 163840
    s_add_u32 s4, s4, s31
    v_add_u32_e64 v253, s4, v252
    s_waitcnt lgkmcnt(0)
    v_mfma_f32_32x32x16_bf16 v[64:79], v[128:131], v[192:195], v[64:79]
    ds_read_b128 v[196:199], v213 offset:32768
    ds_read_b64_tr_b16 v[144:145], v208 offset:36864
    buffer_load_dwordx4 a[0:3], v253, s[12:15], s77 offen offset:0 sc1
    v_mfma_f32_16x16x32_bf16 v[232:235], v[128:131], v[236:239], v[232:235]
    ds_read_b64_tr_b16 v[146:147], v208 offset:37888
    ds_read_b64_tr_b16 v[148:149], v209 offset:36864
    v_mfma_f32_32x32x16_bf16 v[80:95], v[132:135], v[192:195], v[80:95]
    ds_read_b64_tr_b16 v[150:151], v209 offset:37888
    ds_read_b64_tr_b16 v[152:153], v210 offset:36864
    buffer_load_dwordx4 a[4:7], v253, s[12:15], s77 offen offset:1024 sc1
    v_mfma_f32_32x32x16_bf16 v[96:111], v[136:139], v[192:195], v[96:111]
    ds_read_b64_tr_b16 v[154:155], v210 offset:37888
    ds_read_b64_tr_b16 v[156:157], v211 offset:36864
    ds_read_b64_tr_b16 v[158:159], v211 offset:37888
    ds_read_b128 v[200:203], v214 offset:32768
    v_mfma_f32_32x32x16_bf16 v[112:127], v[140:143], v[192:195], v[112:127]
    buffer_load_dwordx4 a[8:11], v253, s[12:15], s77 offen offset:2048 sc1
    ds_read_b64_tr_b16 v[160:161], v208 offset:40960
    s_waitcnt lgkmcnt(2)
    s_nop 0
    v_mfma_f32_32x32x16_bf16 v[64:79], v[144:147], v[196:199], v[64:79]
    ds_read_b64_tr_b16 v[162:163], v208 offset:41984
    ds_read_b64_tr_b16 v[164:165], v209 offset:40960
    buffer_load_dwordx4 a[12:15], v253, s[12:15], s77 offen offset:3072 sc1
    v_mfma_f32_16x16x32_bf16 v[232:235], v[144:147], v[236:239], v[232:235]
    ds_read_b64_tr_b16 v[166:167], v209 offset:41984
    ds_read_b64_tr_b16 v[168:169], v210 offset:40960
    v_mfma_f32_32x32x16_bf16 v[80:95], v[148:151], v[196:199], v[80:95]
    buffer_load_dwordx4 a[16:19], v253, s[12:15], s73 offen offset:0 sc1
    ds_read_b64_tr_b16 v[170:171], v210 offset:41984
    ds_read_b64_tr_b16 v[172:173], v211 offset:40960
    v_mfma_f32_32x32x16_bf16 v[96:111], v[152:155], v[196:199], v[96:111]
    ds_read_b64_tr_b16 v[174:175], v211 offset:41984
    s_cmp_eq_u32 s38, 1
    s_cselect_b32 s43, s39, 163840
    s_cmp_eq_u32 s38, 0
    s_cselect_b32 s43, s40, s43
    v_add_u32 v253, s43, v253
    ds_read_b128 v[204:207], v215 offset:32768
    ds_read_b64_tr_b16 v[176:177], v208 offset:45056
    v_mfma_f32_32x32x16_bf16 v[112:127], v[156:159], v[196:199], v[112:127]
    buffer_load_dwordx4 a[20:23], v253, s[12:15], s77 offen offset:0 sc1
    ds_read_b64_tr_b16 v[178:179], v208 offset:46080
    s_waitcnt lgkmcnt(3)
    s_nop 0
    v_mfma_f32_32x32x16_bf16 v[64:79], v[160:163], v[200:203], v[64:79]
    ds_read_b64_tr_b16 v[180:181], v209 offset:45056
    ds_read_b64_tr_b16 v[182:183], v209 offset:46080
    ds_read_b64_tr_b16 v[184:185], v210 offset:45056
    ds_read_b64_tr_b16 v[186:187], v210 offset:46080
    ds_read_b64_tr_b16 v[188:189], v211 offset:45056
    ds_read_b64_tr_b16 v[190:191], v211 offset:46080
    v_mfma_f32_16x16x32_bf16 v[232:235], v[160:163], v[236:239], v[232:235]
    v_mfma_f32_32x32x16_bf16 v[80:95], v[164:167], v[200:203], v[80:95]
    buffer_load_dwordx4 a[24:27], v253, s[12:15], s77 offen offset:1024 sc1
    v_mfma_f32_32x32x16_bf16 v[96:111], v[168:171], v[200:203], v[96:111]
    buffer_load_dwordx4 a[28:31], v253, s[12:15], s77 offen offset:2048 sc1
    buffer_load_dwordx4 a[32:35], v253, s[12:15], s77 offen offset:3072 sc1
    v_mfma_f32_32x32x16_bf16 v[112:127], v[172:175], v[200:203], v[112:127]
    s_waitcnt lgkmcnt(0)
    v_mfma_f32_32x32x16_bf16 v[64:79], v[176:179], v[204:207], v[64:79]
    v_mfma_f32_16x16x32_bf16 v[232:235], v[176:179], v[236:239], v[232:235]
    v_and_b32 v2, 15, v0
    v_lshrrev_b32 v3, 4, v0
    v_lshlrev_b32 v3, 4, v3
    v_lshl_add_u32 v3, v2, 6, v3
    v_mfma_f32_32x32x16_bf16 v[80:95], v[180:183], v[204:207], v[80:95]
    s_lshl_b32 s4, s66, 7
    s_add_u32 s4, s4, 133120
    v_add_u32 v3, s4, v3
    v_cmp_gt_u32_e64 vcc, 2, v2
    v_mfma_f32_32x32x16_bf16 v[96:111], v[184:187], v[204:207], v[96:111]
    s_and_saveexec_b64 s[6:7], vcc
    ds_write_b128 v3, v[232:235]
    s_mov_b64 exec, s[6:7]
    v_mfma_f32_32x32x16_bf16 v[112:127], v[188:191], v[204:207], v[112:127]
    s_waitcnt lgkmcnt(0)
    s_barrier
    s_lshl_b32 s4, s66, 7
    s_add_u32 s4, s4, 133120
    v_add_u32 v6, s4, v60
    ds_read_b128 v[8:11], v6 offset:0
    ds_read_b128 v[24:27], v6 offset:512
    ds_read_b128 v[12:15], v6 offset:32
    ds_read_b128 v[28:31], v6 offset:544
    ds_read_b128 v[16:19], v6 offset:64
    ds_read_b128 v[32:35], v6 offset:576
    ds_read_b128 v[20:23], v6 offset:96
    ds_read_b128 v[36:39], v6 offset:608
    s_lshr_b32 s5, s24, 4
    s_lshl_b32 s6, s3, 1
    s_add_u32 s5, s5, s6
    s_mul_i32 s5, s5, 54
    s_add_u32 s5, s5, s25
    s_sub_u32 s5, s5, s32
    s_lshl_b32 s5, s5, 10
    s_add_u32 s33, s5, 7536640
    s_mov_b32 s34, 0xc0135761
    s_mov_b32 s35, 0xbdd2d3e8
    buffer_load_dwordx4 a[36:39], v253, s[12:15], s73 offen offset:0 sc1
    s_cmp_eq_u32 s38, 2
    s_cselect_b32 s43, s39, 163840
    s_cmp_eq_u32 s38, 1
    s_cselect_b32 s43, s40, s43
    v_add_u32_e64 v253, s43, v253
    s_waitcnt vmcnt(10)
    s_lshl_b32 s4, s67, 7
    s_add_u32 s4, s4, 133120
    v_add_u32_e64 v6, s4, v60
    ds_read_b128 v[192:195], v6 offset:0
    ds_read_b128 v[208:211], v6 offset:512
    ds_read_b128 v[196:199], v6 offset:32
    ds_read_b128 v[212:215], v6 offset:544
    ds_read_b128 v[200:203], v6 offset:64
    ds_read_b128 v[216:219], v6 offset:576
    ds_read_b128 v[204:207], v6 offset:96
    ds_read_b128 v[220:223], v6 offset:608
    s_waitcnt lgkmcnt(8)
    s_nop 0
    v_pk_fma_f32 v[8:9], v[8:9], v[226:227], v[24:25] op_sel:[0,1,0] op_sel_hi:[1,1,1]
    buffer_load_dwordx4 a[40:43], v253, s[12:15], s77 offen offset:0 sc1
    v_pk_fma_f32 v[10:11], v[10:11], v[226:227], v[26:27] op_sel:[0,1,0] op_sel_hi:[1,1,1]
    v_pk_fma_f32 v[12:13], v[12:13], v[226:227], v[28:29] op_sel:[0,1,0] op_sel_hi:[1,1,1]
    v_pk_fma_f32 v[14:15], v[14:15], v[226:227], v[30:31] op_sel:[0,1,0] op_sel_hi:[1,1,1]
    v_pk_fma_f32 v[16:17], v[16:17], v[226:227], v[32:33] op_sel:[0,1,0] op_sel_hi:[1,1,1]
    v_pk_fma_f32 v[18:19], v[18:19], v[226:227], v[34:35] op_sel:[0,1,0] op_sel_hi:[1,1,1]
    v_pk_fma_f32 v[20:21], v[20:21], v[226:227], v[36:37] op_sel:[0,1,0] op_sel_hi:[1,1,1]
    v_pk_fma_f32 v[22:23], v[22:23], v[226:227], v[38:39] op_sel:[0,1,0] op_sel_hi:[1,1,1]
    v_pk_fma_f32 v[128:129], v[64:65], v[226:227], v[8:9] op_sel:[0,0,0] op_sel_hi:[1,0,1]
    v_pk_fma_f32 v[130:131], v[66:67], v[226:227], v[10:11] op_sel:[0,0,0] op_sel_hi:[1,0,1]
    v_pk_fma_f32 v[132:133], v[68:69], v[226:227], v[12:13] op_sel:[0,0,0] op_sel_hi:[1,0,1]
    v_pk_fma_f32 v[134:135], v[70:71], v[226:227], v[14:15] op_sel:[0,0,0] op_sel_hi:[1,0,1]
    v_pk_fma_f32 v[136:137], v[72:73], v[226:227], v[16:17] op_sel:[0,0,0] op_sel_hi:[1,0,1]
    v_pk_fma_f32 v[138:139], v[74:75], v[226:227], v[18:19] op_sel:[0,0,0] op_sel_hi:[1,0,1]
    v_pk_fma_f32 v[140:141], v[76:77], v[226:227], v[20:21] op_sel:[0,0,0] op_sel_hi:[1,0,1]
    v_pk_fma_f32 v[142:143], v[78:79], v[226:227], v[22:23] op_sel:[0,0,0] op_sel_hi:[1,0,1]
    v_pk_mul_f32 v[144:145], v[128:129], v[128:129]
    v_pk_mul_f32 v[146:147], v[130:131], v[130:131]
    buffer_load_dwordx4 a[44:47], v253, s[12:15], s77 offen offset:1024 sc1
    v_pk_mul_f32 v[148:149], v[132:133], v[132:133]
    v_pk_mul_f32 v[150:151], v[134:135], v[134:135]
    v_pk_mul_f32 v[152:153], v[136:137], v[136:137]
    v_pk_mul_f32 v[154:155], v[138:139], v[138:139]
    v_pk_mul_f32 v[156:157], v[140:141], v[140:141]
    v_pk_mul_f32 v[158:159], v[142:143], v[142:143]
    v_pk_fma_f32 v[144:145], v[144:145], s[34:35], s[34:35] op_sel:[0,1,0] op_sel_hi:[1,1,0]
    v_pk_fma_f32 v[146:147], v[146:147], s[34:35], s[34:35] op_sel:[0,1,0] op_sel_hi:[1,1,0]
    v_pk_fma_f32 v[148:149], v[148:149], s[34:35], s[34:35] op_sel:[0,1,0] op_sel_hi:[1,1,0]
    v_pk_fma_f32 v[150:151], v[150:151], s[34:35], s[34:35] op_sel:[0,1,0] op_sel_hi:[1,1,0]
    v_pk_fma_f32 v[152:153], v[152:153], s[34:35], s[34:35] op_sel:[0,1,0] op_sel_hi:[1,1,0]
    v_pk_fma_f32 v[154:155], v[154:155], s[34:35], s[34:35] op_sel:[0,1,0] op_sel_hi:[1,1,0]
    v_pk_fma_f32 v[156:157], v[156:157], s[34:35], s[34:35] op_sel:[0,1,0] op_sel_hi:[1,1,0]
    v_pk_fma_f32 v[158:159], v[158:159], s[34:35], s[34:35] op_sel:[0,1,0] op_sel_hi:[1,1,0]
    v_pk_mul_f32 v[144:145], v[144:145], v[128:129]
    v_pk_mul_f32 v[146:147], v[146:147], v[130:131]
    v_pk_mul_f32 v[148:149], v[148:149], v[132:133]
    v_pk_mul_f32 v[150:151], v[150:151], v[134:135]
    buffer_load_dwordx4 a[48:51], v253, s[12:15], s77 offen offset:2048 sc1
    v_pk_mul_f32 v[152:153], v[152:153], v[136:137]
    v_pk_mul_f32 v[154:155], v[154:155], v[138:139]
    v_pk_mul_f32 v[156:157], v[156:157], v[140:141]
    v_pk_mul_f32 v[158:159], v[158:159], v[142:143]
    v_exp_f32 v144, v144
    v_exp_f32 v145, v145
    v_exp_f32 v146, v146
    v_exp_f32 v147, v147
    v_exp_f32 v148, v148
    v_exp_f32 v149, v149
    v_exp_f32_e64 v150, v150
    buffer_load_dwordx4 a[52:55], v253, s[12:15], s77 offen offset:3072 sc1
    v_exp_f32 v151, v151
    v_exp_f32 v152, v152
    v_exp_f32 v153, v153
    v_exp_f32 v154, v154
    v_exp_f32 v155, v155
    v_exp_f32 v156, v156
    v_exp_f32 v157, v157
    v_exp_f32 v158, v158
    v_exp_f32_e64 v159, v159
    v_pk_add_f32 v[144:145], v[144:145], 1.0 op_sel_hi:[1,0]
    v_pk_add_f32 v[146:147], v[146:147], 1.0 op_sel_hi:[1,0]
    v_pk_add_f32 v[148:149], v[148:149], 1.0 op_sel_hi:[1,0]
    v_pk_add_f32 v[150:151], v[150:151], 1.0 op_sel_hi:[1,0]
    v_pk_add_f32 v[152:153], v[152:153], 1.0 op_sel_hi:[1,0]
    v_pk_add_f32 v[154:155], v[154:155], 1.0 op_sel_hi:[1,0]
    v_pk_add_f32 v[156:157], v[156:157], 1.0 op_sel_hi:[1,0]
    v_pk_add_f32 v[158:159], v[158:159], 1.0 op_sel_hi:[1,0]
    v_rcp_f32 v144, v144
    v_rcp_f32 v145, v145
    v_rcp_f32 v146, v146
    v_rcp_f32 v147, v147
    v_rcp_f32 v148, v148
    v_rcp_f32 v149, v149
    v_rcp_f32 v150, v150
    v_rcp_f32 v151, v151
    v_rcp_f32 v152, v152
    v_rcp_f32 v153, v153
    v_rcp_f32 v154, v154
    v_rcp_f32 v155, v155
    v_rcp_f32 v156, v156
    v_rcp_f32 v157, v157
    v_rcp_f32 v158, v158
    v_rcp_f32 v159, v159
    v_pk_mul_f32 v[144:145], v[144:145], v[128:129]
    v_pk_mul_f32 v[146:147], v[146:147], v[130:131]
    v_pk_mul_f32 v[148:149], v[148:149], v[132:133]
    v_pk_mul_f32 v[150:151], v[150:151], v[134:135]
    v_pk_mul_f32 v[152:153], v[152:153], v[136:137]
    v_pk_mul_f32 v[154:155], v[154:155], v[138:139]
    v_pk_mul_f32 v[156:157], v[156:157], v[140:141]
    v_pk_mul_f32 v[158:159], v[158:159], v[142:143]
    v_cvt_pk_bf16_f32 v160, v144, v145
    v_cvt_pk_bf16_f32 v161, v146, v147
    v_cvt_pk_bf16_f32 v162, v148, v149
    v_cvt_pk_bf16_f32 v163, v150, v151
    v_cvt_pk_bf16_f32 v164, v152, v153
    v_cvt_pk_bf16_f32 v165, v154, v155
    v_cvt_pk_bf16_f32 v166, v156, v157
    v_cvt_pk_bf16_f32 v167, v158, v159
    s_lshl_b32 s4, s66, 10
    s_add_u32 s4, s4, s33
    buffer_store_dwordx4 v[160:163], v59, s[12:15], s4 offen sc1
    buffer_store_dwordx4 v[164:167], v59, s[12:15], s4 offen offset:512 sc1
    s_lshl_b32 s4, s68, 7
    s_add_u32 s4, s4, 133120
    v_add_u32 v6, s4, v60
    ds_read_b128 v[8:11], v6 offset:0
    ds_read_b128 v[24:27], v6 offset:512
    ds_read_b128 v[12:15], v6 offset:32
    ds_read_b128 v[28:31], v6 offset:544
    ds_read_b128 v[16:19], v6 offset:64
    ds_read_b128 v[32:35], v6 offset:576
    ds_read_b128 v[20:23], v6 offset:96
    ds_read_b128 v[36:39], v6 offset:608
    s_waitcnt lgkmcnt(8)
    s_nop 0
    v_pk_fma_f32 v[192:193], v[192:193], v[226:227], v[208:209] op_sel:[0,1,0] op_sel_hi:[1,1,1]
    v_pk_fma_f32 v[194:195], v[194:195], v[226:227], v[210:211] op_sel:[0,1,0] op_sel_hi:[1,1,1]
    v_pk_fma_f32 v[196:197], v[196:197], v[226:227], v[212:213] op_sel:[0,1,0] op_sel_hi:[1,1,1]
    v_pk_fma_f32 v[198:199], v[198:199], v[226:227], v[214:215] op_sel:[0,1,0] op_sel_hi:[1,1,1]
    v_pk_fma_f32 v[200:201], v[200:201], v[226:227], v[216:217] op_sel:[0,1,0] op_sel_hi:[1,1,1]
    v_pk_fma_f32 v[202:203], v[202:203], v[226:227], v[218:219] op_sel:[0,1,0] op_sel_hi:[1,1,1]
    v_pk_fma_f32 v[204:205], v[204:205], v[226:227], v[220:221] op_sel:[0,1,0] op_sel_hi:[1,1,1]
    v_pk_fma_f32 v[206:207], v[206:207], v[226:227], v[222:223] op_sel:[0,1,0] op_sel_hi:[1,1,1]
    v_pk_fma_f32 v[128:129], v[80:81], v[226:227], v[192:193] op_sel:[0,0,0] op_sel_hi:[1,0,1]
    v_pk_fma_f32 v[130:131], v[82:83], v[226:227], v[194:195] op_sel:[0,0,0] op_sel_hi:[1,0,1]
    v_pk_fma_f32 v[132:133], v[84:85], v[226:227], v[196:197] op_sel:[0,0,0] op_sel_hi:[1,0,1]
    v_pk_fma_f32 v[134:135], v[86:87], v[226:227], v[198:199] op_sel:[0,0,0] op_sel_hi:[1,0,1]
    v_pk_fma_f32 v[136:137], v[88:89], v[226:227], v[200:201] op_sel:[0,0,0] op_sel_hi:[1,0,1]
    v_pk_fma_f32 v[138:139], v[90:91], v[226:227], v[202:203] op_sel:[0,0,0] op_sel_hi:[1,0,1]
    v_pk_fma_f32 v[140:141], v[92:93], v[226:227], v[204:205] op_sel:[0,0,0] op_sel_hi:[1,0,1]
    v_pk_fma_f32 v[142:143], v[94:95], v[226:227], v[206:207] op_sel:[0,0,0] op_sel_hi:[1,0,1]
    v_pk_mul_f32 v[144:145], v[128:129], v[128:129]
    v_pk_mul_f32 v[146:147], v[130:131], v[130:131]
    v_pk_mul_f32 v[148:149], v[132:133], v[132:133]
    v_pk_mul_f32 v[150:151], v[134:135], v[134:135]
    v_pk_mul_f32 v[152:153], v[136:137], v[136:137]
    v_pk_mul_f32 v[154:155], v[138:139], v[138:139]
    v_pk_mul_f32 v[156:157], v[140:141], v[140:141]
    v_pk_mul_f32 v[158:159], v[142:143], v[142:143]
    v_pk_fma_f32 v[144:145], v[144:145], s[34:35], s[34:35] op_sel:[0,1,0] op_sel_hi:[1,1,0]
    v_pk_fma_f32 v[146:147], v[146:147], s[34:35], s[34:35] op_sel:[0,1,0] op_sel_hi:[1,1,0]
    v_pk_fma_f32 v[148:149], v[148:149], s[34:35], s[34:35] op_sel:[0,1,0] op_sel_hi:[1,1,0]
    v_pk_fma_f32 v[150:151], v[150:151], s[34:35], s[34:35] op_sel:[0,1,0] op_sel_hi:[1,1,0]
    v_pk_fma_f32 v[152:153], v[152:153], s[34:35], s[34:35] op_sel:[0,1,0] op_sel_hi:[1,1,0]
    v_pk_fma_f32 v[154:155], v[154:155], s[34:35], s[34:35] op_sel:[0,1,0] op_sel_hi:[1,1,0]
    v_pk_fma_f32 v[156:157], v[156:157], s[34:35], s[34:35] op_sel:[0,1,0] op_sel_hi:[1,1,0]
    v_pk_fma_f32 v[158:159], v[158:159], s[34:35], s[34:35] op_sel:[0,1,0] op_sel_hi:[1,1,0]
    v_pk_mul_f32 v[144:145], v[144:145], v[128:129]
    v_pk_mul_f32 v[146:147], v[146:147], v[130:131]
    v_pk_mul_f32 v[148:149], v[148:149], v[132:133]
    v_pk_mul_f32 v[150:151], v[150:151], v[134:135]
    v_pk_mul_f32 v[152:153], v[152:153], v[136:137]
    v_pk_mul_f32 v[154:155], v[154:155], v[138:139]
    v_pk_mul_f32 v[156:157], v[156:157], v[140:141]
    v_pk_mul_f32 v[158:159], v[158:159], v[142:143]
    v_exp_f32 v144, v144
    v_exp_f32 v145, v145
    v_exp_f32 v146, v146
    v_exp_f32 v147, v147
    v_exp_f32 v148, v148
    v_exp_f32 v149, v149
    v_exp_f32 v150, v150
    v_exp_f32 v151, v151
    v_exp_f32 v152, v152
    v_exp_f32 v153, v153
    v_exp_f32 v154, v154
    v_exp_f32 v155, v155
    v_exp_f32 v156, v156
    v_exp_f32 v157, v157
    v_exp_f32 v158, v158
    v_exp_f32 v159, v159
    v_pk_add_f32 v[144:145], v[144:145], 1.0 op_sel_hi:[1,0]
    v_pk_add_f32 v[146:147], v[146:147], 1.0 op_sel_hi:[1,0]
    v_pk_add_f32 v[148:149], v[148:149], 1.0 op_sel_hi:[1,0]
    v_pk_add_f32 v[150:151], v[150:151], 1.0 op_sel_hi:[1,0]
    v_pk_add_f32 v[152:153], v[152:153], 1.0 op_sel_hi:[1,0]
    v_pk_add_f32 v[154:155], v[154:155], 1.0 op_sel_hi:[1,0]
    v_pk_add_f32 v[156:157], v[156:157], 1.0 op_sel_hi:[1,0]
    v_pk_add_f32 v[158:159], v[158:159], 1.0 op_sel_hi:[1,0]
    v_rcp_f32 v144, v144
    v_rcp_f32 v145, v145
    v_rcp_f32 v146, v146
    v_rcp_f32 v147, v147
    v_rcp_f32 v148, v148
    v_rcp_f32 v149, v149
    v_rcp_f32 v150, v150
    v_rcp_f32 v151, v151
    v_rcp_f32 v152, v152
    v_rcp_f32 v153, v153
    v_rcp_f32 v154, v154
    v_rcp_f32 v155, v155
    v_rcp_f32 v156, v156
    v_rcp_f32 v157, v157
    v_rcp_f32 v158, v158
    v_rcp_f32 v159, v159
    v_pk_mul_f32 v[144:145], v[144:145], v[128:129]
    v_pk_mul_f32 v[146:147], v[146:147], v[130:131]
    v_pk_mul_f32 v[148:149], v[148:149], v[132:133]
    v_pk_mul_f32 v[150:151], v[150:151], v[134:135]
    v_pk_mul_f32 v[152:153], v[152:153], v[136:137]
    v_pk_mul_f32 v[154:155], v[154:155], v[138:139]
    v_pk_mul_f32 v[156:157], v[156:157], v[140:141]
    v_pk_mul_f32 v[158:159], v[158:159], v[142:143]
    v_cvt_pk_bf16_f32 v168, v144, v145
    v_cvt_pk_bf16_f32 v169, v146, v147
    v_cvt_pk_bf16_f32 v170, v148, v149
    v_cvt_pk_bf16_f32 v171, v150, v151
    v_cvt_pk_bf16_f32 v172, v152, v153
    v_cvt_pk_bf16_f32 v173, v154, v155
    v_cvt_pk_bf16_f32 v174, v156, v157
    v_cvt_pk_bf16_f32 v175, v158, v159
    s_lshl_b32 s4, s67, 10
    s_add_u32 s4, s4, s33
    buffer_store_dwordx4 v[168:171], v59, s[12:15], s4 offen sc1
    buffer_store_dwordx4 v[172:175], v59, s[12:15], s4 offen offset:512 sc1
    s_lshl_b32 s4, s69, 7
    s_add_u32 s4, s4, 133120
    v_add_u32 v6, s4, v60
    ds_read_b128 v[192:195], v6 offset:0
    ds_read_b128 v[208:211], v6 offset:512
    ds_read_b128 v[196:199], v6 offset:32
    ds_read_b128 v[212:215], v6 offset:544
    ds_read_b128 v[200:203], v6 offset:64
    ds_read_b128 v[216:219], v6 offset:576
    ds_read_b128 v[204:207], v6 offset:96
    ds_read_b128 v[220:223], v6 offset:608
    s_waitcnt lgkmcnt(8)
    s_nop 0
    v_pk_fma_f32 v[8:9], v[8:9], v[226:227], v[24:25] op_sel:[0,1,0] op_sel_hi:[1,1,1]
    v_pk_fma_f32 v[10:11], v[10:11], v[226:227], v[26:27] op_sel:[0,1,0] op_sel_hi:[1,1,1]
    v_pk_fma_f32 v[12:13], v[12:13], v[226:227], v[28:29] op_sel:[0,1,0] op_sel_hi:[1,1,1]
    v_pk_fma_f32 v[14:15], v[14:15], v[226:227], v[30:31] op_sel:[0,1,0] op_sel_hi:[1,1,1]
    v_pk_fma_f32 v[16:17], v[16:17], v[226:227], v[32:33] op_sel:[0,1,0] op_sel_hi:[1,1,1]
    v_pk_fma_f32 v[18:19], v[18:19], v[226:227], v[34:35] op_sel:[0,1,0] op_sel_hi:[1,1,1]
    v_pk_fma_f32 v[20:21], v[20:21], v[226:227], v[36:37] op_sel:[0,1,0] op_sel_hi:[1,1,1]
    v_pk_fma_f32 v[22:23], v[22:23], v[226:227], v[38:39] op_sel:[0,1,0] op_sel_hi:[1,1,1]
    v_pk_fma_f32 v[128:129], v[96:97], v[226:227], v[8:9] op_sel:[0,0,0] op_sel_hi:[1,0,1]
    v_pk_fma_f32 v[130:131], v[98:99], v[226:227], v[10:11] op_sel:[0,0,0] op_sel_hi:[1,0,1]
    v_pk_fma_f32 v[132:133], v[100:101], v[226:227], v[12:13] op_sel:[0,0,0] op_sel_hi:[1,0,1]
    v_pk_fma_f32 v[134:135], v[102:103], v[226:227], v[14:15] op_sel:[0,0,0] op_sel_hi:[1,0,1]
    v_pk_fma_f32 v[136:137], v[104:105], v[226:227], v[16:17] op_sel:[0,0,0] op_sel_hi:[1,0,1]
    v_pk_fma_f32 v[138:139], v[106:107], v[226:227], v[18:19] op_sel:[0,0,0] op_sel_hi:[1,0,1]
    v_pk_fma_f32 v[140:141], v[108:109], v[226:227], v[20:21] op_sel:[0,0,0] op_sel_hi:[1,0,1]
    v_pk_fma_f32 v[142:143], v[110:111], v[226:227], v[22:23] op_sel:[0,0,0] op_sel_hi:[1,0,1]
    v_pk_mul_f32 v[144:145], v[128:129], v[128:129]
    v_pk_mul_f32 v[146:147], v[130:131], v[130:131]
    v_pk_mul_f32 v[148:149], v[132:133], v[132:133]
    v_pk_mul_f32 v[150:151], v[134:135], v[134:135]
    v_pk_mul_f32 v[152:153], v[136:137], v[136:137]
    v_pk_mul_f32 v[154:155], v[138:139], v[138:139]
    v_pk_mul_f32 v[156:157], v[140:141], v[140:141]
    v_pk_mul_f32 v[158:159], v[142:143], v[142:143]
    v_pk_fma_f32 v[144:145], v[144:145], s[34:35], s[34:35] op_sel:[0,1,0] op_sel_hi:[1,1,0]
    v_pk_fma_f32 v[146:147], v[146:147], s[34:35], s[34:35] op_sel:[0,1,0] op_sel_hi:[1,1,0]
    v_pk_fma_f32 v[148:149], v[148:149], s[34:35], s[34:35] op_sel:[0,1,0] op_sel_hi:[1,1,0]
    v_pk_fma_f32 v[150:151], v[150:151], s[34:35], s[34:35] op_sel:[0,1,0] op_sel_hi:[1,1,0]
    v_pk_fma_f32 v[152:153], v[152:153], s[34:35], s[34:35] op_sel:[0,1,0] op_sel_hi:[1,1,0]
    v_pk_fma_f32 v[154:155], v[154:155], s[34:35], s[34:35] op_sel:[0,1,0] op_sel_hi:[1,1,0]
    v_pk_fma_f32 v[156:157], v[156:157], s[34:35], s[34:35] op_sel:[0,1,0] op_sel_hi:[1,1,0]
    v_pk_fma_f32 v[158:159], v[158:159], s[34:35], s[34:35] op_sel:[0,1,0] op_sel_hi:[1,1,0]
    v_pk_mul_f32 v[144:145], v[144:145], v[128:129]
    v_pk_mul_f32 v[146:147], v[146:147], v[130:131]
    v_pk_mul_f32 v[148:149], v[148:149], v[132:133]
    v_pk_mul_f32 v[150:151], v[150:151], v[134:135]
    v_pk_mul_f32 v[152:153], v[152:153], v[136:137]
    v_pk_mul_f32 v[154:155], v[154:155], v[138:139]
    v_pk_mul_f32 v[156:157], v[156:157], v[140:141]
    v_pk_mul_f32 v[158:159], v[158:159], v[142:143]
    v_exp_f32 v144, v144
    v_exp_f32 v145, v145
    v_exp_f32 v146, v146
    v_exp_f32 v147, v147
    v_exp_f32 v148, v148
    v_exp_f32 v149, v149
    v_exp_f32 v150, v150
    v_exp_f32 v151, v151
    v_exp_f32 v152, v152
    v_exp_f32 v153, v153
    v_exp_f32 v154, v154
    v_exp_f32 v155, v155
    v_exp_f32 v156, v156
    v_exp_f32 v157, v157
    v_exp_f32 v158, v158
    v_exp_f32 v159, v159
    v_pk_add_f32 v[144:145], v[144:145], 1.0 op_sel_hi:[1,0]
    v_pk_add_f32 v[146:147], v[146:147], 1.0 op_sel_hi:[1,0]
    v_pk_add_f32 v[148:149], v[148:149], 1.0 op_sel_hi:[1,0]
    v_pk_add_f32 v[150:151], v[150:151], 1.0 op_sel_hi:[1,0]
    v_pk_add_f32 v[152:153], v[152:153], 1.0 op_sel_hi:[1,0]
    v_pk_add_f32 v[154:155], v[154:155], 1.0 op_sel_hi:[1,0]
    v_pk_add_f32 v[156:157], v[156:157], 1.0 op_sel_hi:[1,0]
    v_pk_add_f32 v[158:159], v[158:159], 1.0 op_sel_hi:[1,0]
    v_rcp_f32 v144, v144
    v_rcp_f32 v145, v145
    v_rcp_f32 v146, v146
    v_rcp_f32 v147, v147
    v_rcp_f32 v148, v148
    v_rcp_f32 v149, v149
    v_rcp_f32 v150, v150
    v_rcp_f32 v151, v151
    v_rcp_f32 v152, v152
    v_rcp_f32 v153, v153
    v_rcp_f32 v154, v154
    v_rcp_f32 v155, v155
    v_rcp_f32 v156, v156
    v_rcp_f32 v157, v157
    v_rcp_f32 v158, v158
    v_rcp_f32 v159, v159
    v_pk_mul_f32 v[144:145], v[144:145], v[128:129]
    v_pk_mul_f32 v[146:147], v[146:147], v[130:131]
    v_pk_mul_f32 v[148:149], v[148:149], v[132:133]
    v_pk_mul_f32 v[150:151], v[150:151], v[134:135]
    v_pk_mul_f32 v[152:153], v[152:153], v[136:137]
    v_pk_mul_f32 v[154:155], v[154:155], v[138:139]
    v_pk_mul_f32 v[156:157], v[156:157], v[140:141]
    v_pk_mul_f32 v[158:159], v[158:159], v[142:143]
    v_cvt_pk_bf16_f32 v160, v144, v145
    v_cvt_pk_bf16_f32 v161, v146, v147
    v_cvt_pk_bf16_f32 v162, v148, v149
    v_cvt_pk_bf16_f32 v163, v150, v151
    v_cvt_pk_bf16_f32 v164, v152, v153
    v_cvt_pk_bf16_f32 v165, v154, v155
    v_cvt_pk_bf16_f32 v166, v156, v157
    v_cvt_pk_bf16_f32 v167, v158, v159
    s_lshl_b32 s4, s68, 10
    s_add_u32 s4, s4, s33
    buffer_store_dwordx4 v[160:163], v59, s[12:15], s4 offen sc1
    buffer_store_dwordx4 v[164:167], v59, s[12:15], s4 offen offset:512 sc1
    s_waitcnt lgkmcnt(0)
    s_nop 0
    v_pk_fma_f32 v[192:193], v[192:193], v[226:227], v[208:209] op_sel:[0,1,0] op_sel_hi:[1,1,1]
    v_pk_fma_f32 v[194:195], v[194:195], v[226:227], v[210:211] op_sel:[0,1,0] op_sel_hi:[1,1,1]
    v_pk_fma_f32 v[196:197], v[196:197], v[226:227], v[212:213] op_sel:[0,1,0] op_sel_hi:[1,1,1]
    v_pk_fma_f32 v[198:199], v[198:199], v[226:227], v[214:215] op_sel:[0,1,0] op_sel_hi:[1,1,1]
    v_pk_fma_f32 v[200:201], v[200:201], v[226:227], v[216:217] op_sel:[0,1,0] op_sel_hi:[1,1,1]
    v_pk_fma_f32 v[202:203], v[202:203], v[226:227], v[218:219] op_sel:[0,1,0] op_sel_hi:[1,1,1]
    v_pk_fma_f32 v[204:205], v[204:205], v[226:227], v[220:221] op_sel:[0,1,0] op_sel_hi:[1,1,1]
    v_pk_fma_f32 v[206:207], v[206:207], v[226:227], v[222:223] op_sel:[0,1,0] op_sel_hi:[1,1,1]
    v_pk_fma_f32 v[128:129], v[112:113], v[226:227], v[192:193] op_sel:[0,0,0] op_sel_hi:[1,0,1]
    v_pk_fma_f32 v[130:131], v[114:115], v[226:227], v[194:195] op_sel:[0,0,0] op_sel_hi:[1,0,1]
    v_pk_fma_f32 v[132:133], v[116:117], v[226:227], v[196:197] op_sel:[0,0,0] op_sel_hi:[1,0,1]
    v_pk_fma_f32 v[134:135], v[118:119], v[226:227], v[198:199] op_sel:[0,0,0] op_sel_hi:[1,0,1]
    v_pk_fma_f32 v[136:137], v[120:121], v[226:227], v[200:201] op_sel:[0,0,0] op_sel_hi:[1,0,1]
    v_pk_fma_f32 v[138:139], v[122:123], v[226:227], v[202:203] op_sel:[0,0,0] op_sel_hi:[1,0,1]
    v_pk_fma_f32 v[140:141], v[124:125], v[226:227], v[204:205] op_sel:[0,0,0] op_sel_hi:[1,0,1]
    v_pk_fma_f32 v[142:143], v[126:127], v[226:227], v[206:207] op_sel:[0,0,0] op_sel_hi:[1,0,1]
    v_pk_mul_f32 v[144:145], v[128:129], v[128:129]
    v_pk_mul_f32 v[146:147], v[130:131], v[130:131]
    v_pk_mul_f32 v[148:149], v[132:133], v[132:133]
    v_pk_mul_f32 v[150:151], v[134:135], v[134:135]
    v_pk_mul_f32 v[152:153], v[136:137], v[136:137]
    v_pk_mul_f32 v[154:155], v[138:139], v[138:139]
    v_pk_mul_f32 v[156:157], v[140:141], v[140:141]
    v_pk_mul_f32 v[158:159], v[142:143], v[142:143]
    v_pk_fma_f32 v[144:145], v[144:145], s[34:35], s[34:35] op_sel:[0,1,0] op_sel_hi:[1,1,0]
    v_pk_fma_f32 v[146:147], v[146:147], s[34:35], s[34:35] op_sel:[0,1,0] op_sel_hi:[1,1,0]
    v_pk_fma_f32 v[148:149], v[148:149], s[34:35], s[34:35] op_sel:[0,1,0] op_sel_hi:[1,1,0]
    v_pk_fma_f32 v[150:151], v[150:151], s[34:35], s[34:35] op_sel:[0,1,0] op_sel_hi:[1,1,0]
    v_pk_fma_f32 v[152:153], v[152:153], s[34:35], s[34:35] op_sel:[0,1,0] op_sel_hi:[1,1,0]
    v_pk_fma_f32 v[154:155], v[154:155], s[34:35], s[34:35] op_sel:[0,1,0] op_sel_hi:[1,1,0]
    v_pk_fma_f32 v[156:157], v[156:157], s[34:35], s[34:35] op_sel:[0,1,0] op_sel_hi:[1,1,0]
    v_pk_fma_f32 v[158:159], v[158:159], s[34:35], s[34:35] op_sel:[0,1,0] op_sel_hi:[1,1,0]
    v_pk_mul_f32 v[144:145], v[144:145], v[128:129]
    v_pk_mul_f32 v[146:147], v[146:147], v[130:131]
    v_pk_mul_f32 v[148:149], v[148:149], v[132:133]
    v_pk_mul_f32 v[150:151], v[150:151], v[134:135]
    v_pk_mul_f32 v[152:153], v[152:153], v[136:137]
    v_pk_mul_f32 v[154:155], v[154:155], v[138:139]
    v_pk_mul_f32 v[156:157], v[156:157], v[140:141]
    v_pk_mul_f32 v[158:159], v[158:159], v[142:143]
    v_exp_f32 v144, v144
    v_exp_f32 v145, v145
    v_exp_f32 v146, v146
    v_exp_f32 v147, v147
    v_exp_f32 v148, v148
    v_exp_f32 v149, v149
    v_exp_f32 v150, v150
    v_exp_f32 v151, v151
    v_exp_f32 v152, v152
    v_exp_f32 v153, v153
    v_exp_f32 v154, v154
    v_exp_f32 v155, v155
    v_exp_f32 v156, v156
    v_exp_f32 v157, v157
    v_exp_f32 v158, v158
    v_exp_f32 v159, v159
    v_pk_add_f32 v[144:145], v[144:145], 1.0 op_sel_hi:[1,0]
    v_pk_add_f32 v[146:147], v[146:147], 1.0 op_sel_hi:[1,0]
    v_pk_add_f32 v[148:149], v[148:149], 1.0 op_sel_hi:[1,0]
    v_pk_add_f32 v[150:151], v[150:151], 1.0 op_sel_hi:[1,0]
    v_pk_add_f32 v[152:153], v[152:153], 1.0 op_sel_hi:[1,0]
    v_pk_add_f32 v[154:155], v[154:155], 1.0 op_sel_hi:[1,0]
    v_pk_add_f32 v[156:157], v[156:157], 1.0 op_sel_hi:[1,0]
    v_pk_add_f32 v[158:159], v[158:159], 1.0 op_sel_hi:[1,0]
    v_rcp_f32 v144, v144
    v_rcp_f32 v145, v145
    v_rcp_f32 v146, v146
    v_rcp_f32 v147, v147
    v_rcp_f32 v148, v148
    v_rcp_f32 v149, v149
    v_rcp_f32 v150, v150
    v_rcp_f32 v151, v151
    v_rcp_f32 v152, v152
    v_rcp_f32 v153, v153
    v_rcp_f32 v154, v154
    v_rcp_f32 v155, v155
    v_rcp_f32 v156, v156
    v_rcp_f32 v157, v157
    v_rcp_f32 v158, v158
    v_rcp_f32 v159, v159
    v_pk_mul_f32 v[144:145], v[144:145], v[128:129]
    v_pk_mul_f32 v[146:147], v[146:147], v[130:131]
    v_pk_mul_f32 v[148:149], v[148:149], v[132:133]
    v_pk_mul_f32 v[150:151], v[150:151], v[134:135]
    v_pk_mul_f32 v[152:153], v[152:153], v[136:137]
    v_pk_mul_f32 v[154:155], v[154:155], v[138:139]
    v_pk_mul_f32 v[156:157], v[156:157], v[140:141]
    v_pk_mul_f32 v[158:159], v[158:159], v[142:143]
    v_cvt_pk_bf16_f32 v168, v144, v145
    v_cvt_pk_bf16_f32 v169, v146, v147
    v_cvt_pk_bf16_f32 v170, v148, v149
    v_cvt_pk_bf16_f32 v171, v150, v151
    v_cvt_pk_bf16_f32 v172, v152, v153
    v_cvt_pk_bf16_f32 v173, v154, v155
    v_cvt_pk_bf16_f32 v174, v156, v157
    v_cvt_pk_bf16_f32 v175, v158, v159
    s_lshl_b32 s4, s69, 10
    s_add_u32 s4, s4, s33
    buffer_store_dwordx4 v[168:171], v59, s[12:15], s4 offen sc1
    buffer_store_dwordx4 v[172:175], v59, s[12:15], s4 offen offset:512 sc1
    s_waitcnt vmcnt(0)
    s_barrier
    s_cmp_lg_u32 s3, 0
    s_cbranch_scc1 L_pub_34
    s_mov_b64 exec, 1
    s_lshl_b64 exec, exec, 36
    s_mov_b32 s4, 14876672
    v_add_u32_e64 v2, 1, v255
    buffer_store_dword v2, v254, s[12:15], s4 offen sc1
    s_mov_b64 exec, -1
L_pub_34:
    buffer_load_dwordx4 a[56:59], v253, s[12:15], s73 offen offset:0 sc1
    s_cmp_eq_u32 s38, 3
    s_cselect_b32 s43, s39, 163840
    s_cmp_eq_u32 s38, 2
    s_cselect_b32 s43, s40, s43
    v_add_u32_e64 v253, s43, v253
    buffer_load_dwordx4 a[60:63], v253, s[12:15], s77 offen offset:0 sc1
    buffer_load_dwordx4 a[64:67], v253, s[12:15], s77 offen offset:1024 sc1
    buffer_load_dwordx4 a[68:71], v253, s[12:15], s77 offen offset:2048 sc1
    buffer_load_dwordx4 a[72:75], v253, s[12:15], s77 offen offset:3072 sc1
    buffer_load_dwordx4 a[76:79], v253, s[12:15], s73 offen offset:0 sc1
    s_cmp_eq_u32 s38, 4
    s_cselect_b32 s43, s39, 163840
    s_cmp_eq_u32 s38, 3
    s_cselect_b32 s43, s40, s43
    v_add_u32 v253, s43, v253
    buffer_load_dwordx4 a[80:83], v253, s[12:15], s77 offen offset:0 sc1
    buffer_load_dwordx4 a[84:87], v253, s[12:15], s77 offen offset:1024 sc1
    buffer_load_dwordx4 a[88:91], v253, s[12:15], s77 offen offset:2048 sc1
    buffer_load_dwordx4 a[92:95], v253, s[12:15], s77 offen offset:3072 sc1
    buffer_load_dwordx4 a[96:99], v253, s[12:15], s73 offen offset:0 sc1
    s_cmp_eq_u32 s38, 5
    s_cselect_b32 s43, s39, 163840
    s_cmp_eq_u32 s38, 4
    s_cselect_b32 s43, s40, s43
    v_add_u32 v253, s43, v253
    buffer_load_dwordx4 a[100:103], v253, s[12:15], s77 offen offset:0 sc1
    buffer_load_dwordx4 a[104:107], v253, s[12:15], s77 offen offset:1024 sc1
    buffer_load_dwordx4 a[108:111], v253, s[12:15], s77 offen offset:2048 sc1
    buffer_load_dwordx4 a[112:115], v253, s[12:15], s77 offen offset:3072 sc1
    buffer_load_dwordx4 a[116:119], v253, s[12:15], s73 offen offset:0 sc1
    s_cmp_eq_u32 s38, 6
    s_cselect_b32 s43, s39, 163840
    s_cmp_eq_u32 s38, 5
    s_cselect_b32 s43, s40, s43
    v_add_u32 v253, s43, v253
    buffer_load_dwordx4 a[120:123], v253, s[12:15], s77 offen offset:0 sc1
    buffer_load_dwordx4 a[124:127], v253, s[12:15], s77 offen offset:1024 sc1
    buffer_load_dwordx4 a[128:131], v253, s[12:15], s77 offen offset:2048 sc1
    buffer_load_dwordx4 a[132:135], v253, s[12:15], s77 offen offset:3072 sc1
    buffer_load_dwordx4 a[136:139], v253, s[12:15], s73 offen offset:0 sc1
    s_cmp_eq_u32 s38, 7
    s_cselect_b32 s43, s39, 163840
    s_cmp_eq_u32 s38, 6
    s_cselect_b32 s43, s40, s43
    v_add_u32 v253, s43, v253
    buffer_load_dwordx4 a[140:143], v253, s[12:15], s77 offen offset:0 sc1
    buffer_load_dwordx4 a[144:147], v253, s[12:15], s77 offen offset:1024 sc1
    buffer_load_dwordx4 a[148:151], v253, s[12:15], s77 offen offset:2048 sc1
    buffer_load_dwordx4 a[152:155], v253, s[12:15], s77 offen offset:3072 sc1
    buffer_load_dwordx4 a[156:159], v253, s[12:15], s73 offen offset:0 sc1
    s_cmp_eq_u32 s38, 8
    s_cselect_b32 s43, s39, 163840
    s_cmp_eq_u32 s38, 7
    s_cselect_b32 s43, s40, s43
    v_add_u32 v253, s43, v253
    s_add_u32 s4, s3, 0
    s_and_b32 s4, s4, 3
    s_mul_i32 s4, s4, 55296
    v_add_u32_e64 v248, s4, v252
    s_add_u32 s4, s3, 1
    s_and_b32 s4, s4, 3
    s_mul_i32 s4, s4, 55296
    v_add_u32_e64 v249, s4, v252
    s_add_u32 s4, s3, 2
    s_and_b32 s4, s4, 3
    s_mul_i32 s4, s4, 55296
    v_add_u32_e64 v250, s4, v252
    s_add_u32 s4, s3, 3
    s_and_b32 s4, s4, 3
    s_mul_i32 s4, s4, 55296
    v_add_u32_e64 v251, s4, v252
    s_mul_i32 s4, s74, 216
    s_add_u32 s4, s4, s3
    s_lshl_b32 s4, s4, 10
    s_add_u32 s76, s4, 7536640
    s_lshl_b32 s4, s44, 12
    s_add_u32 s4, s4, s31
    s_add_u32 s76, s76, s4
    s_mov_b32 s5, 0
    s_cmp_lg_u32 s3, 0
    s_cbranch_scc1 L_pok_35
    s_branch L_pld_37
L_ptop_36:
    v_cmp_eq_u32_e64 vcc, v56, v255
    s_lshr_b64 s[6:7], vcc, 20
    s_and_b32 s6, s6, 0xffff
    s_cbranch_scc0 L_pok_35
    s_add_u32 s5, s5, 1
    s_cmp_gt_u32 s5, 200000
    s_cbranch_scc1 L_pok_35
    s_sleep 8
L_pld_37:
    s_mov_b64 exec, 0xffff
    s_lshl_b64 exec, exec, 20
    s_mov_b32 s4, 14876672
    buffer_load_dword v56, v254, s[12:15], s4 offen sc1
    s_mov_b64 exec, -1
    s_waitcnt vmcnt(0)
    s_branch L_ptop_36
L_pok_35:
    s_barrier
    buffer_load_dwordx4 v[8:11], v248, s[12:15], s76 offen sc1
    buffer_load_dwordx4 v[12:15], v249, s[12:15], s76 offen sc1
    buffer_load_dwordx4 v[16:19], v250, s[12:15], s76 offen sc1
    buffer_load_dwordx4 v[20:23], v251, s[12:15], s76 offen sc1
    s_cmp_eq_u32 s38, 1
    s_cselect_b32 s43, s41, 4096
    s_cmp_eq_u32 s38, 0
    s_cselect_b32 s43, s42, s43
    s_add_u32 s76, s76, s43
    buffer_load_dwordx4 v[24:27], v248, s[12:15], s76 offen sc1
    buffer_load_dwordx4 v[28:31], v249, s[12:15], s76 offen sc1
    buffer_load_dwordx4 v[32:35], v250, s[12:15], s76 offen sc1
    buffer_load_dwordx4 v[36:39], v251, s[12:15], s76 offen sc1
    s_cmp_eq_u32 s38, 2
    s_cselect_b32 s43, s41, 4096
    s_cmp_eq_u32 s38, 1
    s_cselect_b32 s43, s42, s43
    s_add_u32 s76, s76, s43
    buffer_load_dwordx4 v[40:43], v248, s[12:15], s76 offen sc1
    buffer_load_dwordx4 v[44:47], v249, s[12:15], s76 offen sc1
    buffer_load_dwordx4 v[48:51], v250, s[12:15], s76 offen sc1
    buffer_load_dwordx4 v[52:55], v251, s[12:15], s76 offen sc1
    s_cmp_eq_u32 s38, 3
    s_cselect_b32 s43, s41, 4096
    s_cmp_eq_u32 s38, 2
    s_cselect_b32 s43, s42, s43
    s_add_u32 s76, s76, s43
    s_waitcnt vmcnt(8)
    v_mfma_f32_16x16x32_bf16 v[64:67], a[0:3], v[8:11], 0
    v_mfma_f32_16x16x32_bf16 v[68:71], a[4:7], v[8:11], 0
    buffer_load_dwordx4 v[144:147], v248, s[12:15], s76 offen sc1
    v_mfma_f32_16x16x32_bf16 v[72:75], a[8:11], v[8:11], 0
    buffer_load_dwordx4 v[148:151], v249, s[12:15], s76 offen sc1
    v_mfma_f32_16x16x32_bf16 v[76:79], a[12:15], v[8:11], 0
    v_mfma_f32_16x16x32_bf16 v[80:83], a[16:19], v[8:11], 0
    buffer_load_dwordx4 v[152:155], v250, s[12:15], s76 offen sc1
    v_mfma_f32_16x16x32_bf16 v[84:87], a[0:3], v[12:15], 0
    buffer_load_dwordx4 v[156:159], v251, s[12:15], s76 offen sc1
    v_mfma_f32_16x16x32_bf16 v[88:91], a[4:7], v[12:15], 0
    v_mfma_f32_16x16x32_bf16 v[92:95], a[8:11], v[12:15], 0
    s_cmp_eq_u32 s38, 4
    s_cselect_b32 s43, s41, 4096
    s_cmp_eq_u32 s38, 3
    s_cselect_b32 s43, s42, s43
    s_add_u32 s76, s76, s43
    v_mfma_f32_16x16x32_bf16 v[96:99], a[12:15], v[12:15], 0
    buffer_load_dwordx4 v[232:235], v248, s[12:15], s76 offen sc1
    v_mfma_f32_16x16x32_bf16 v[100:103], a[16:19], v[12:15], 0
    buffer_load_dwordx4 v[236:239], v249, s[12:15], s76 offen sc1
    v_mfma_f32_16x16x32_bf16 v[104:107], a[0:3], v[16:19], 0
    v_mfma_f32_16x16x32_bf16 v[108:111], a[4:7], v[16:19], 0
    buffer_load_dwordx4 v[240:243], v250, s[12:15], s76 offen sc1
    v_mfma_f32_16x16x32_bf16 v[112:115], a[8:11], v[16:19], 0
    buffer_load_dwordx4 v[244:247], v251, s[12:15], s76 offen sc1
    v_mfma_f32_16x16x32_bf16 v[116:119], a[12:15], v[16:19], 0
    v_mfma_f32_16x16x32_bf16 v[120:123], a[16:19], v[16:19], 0
    s_cmp_eq_u32 s38, 5
    s_cselect_b32 s43, s41, 4096
    s_cmp_eq_u32 s38, 4
    s_cselect_b32 s43, s42, s43
    s_add_u32 s76, s76, s43
    v_mfma_f32_16x16x32_bf16 v[124:127], a[0:3], v[20:23], 0
    buffer_load_dwordx4 a[160:163], v253, s[12:15], s77 offen offset:0 sc1
    v_mfma_f32_16x16x32_bf16 v[128:131], a[4:7], v[20:23], 0
    v_mfma_f32_16x16x32_bf16 v[132:135], a[8:11], v[20:23], 0
    buffer_load_dwordx4 a[164:167], v253, s[12:15], s77 offen offset:1024 sc1
    v_mfma_f32_16x16x32_bf16 v[136:139], a[12:15], v[20:23], 0
    buffer_load_dwordx4 a[168:171], v253, s[12:15], s77 offen offset:2048 sc1
    v_mfma_f32_16x16x32_bf16 v[140:143], a[16:19], v[20:23], 0
    buffer_load_dwordx4 a[172:175], v253, s[12:15], s77 offen offset:3072 sc1
    s_waitcnt vmcnt(16)
    s_nop 0
    v_mfma_f32_16x16x32_bf16 v[64:67], a[20:23], v[24:27], v[64:67]
    v_mfma_f32_16x16x32_bf16 v[68:71], a[24:27], v[24:27], v[68:71]
    buffer_load_dwordx4 v[160:163], v248, s[12:15], s76 offen sc1
    v_mfma_f32_16x16x32_bf16 v[72:75], a[28:31], v[24:27], v[72:75]
    buffer_load_dwordx4 v[164:167], v249, s[12:15], s76 offen sc1
    v_mfma_f32_16x16x32_bf16 v[76:79], a[32:35], v[24:27], v[76:79]
    buffer_load_dwordx4 v[168:171], v250, s[12:15], s76 offen sc1
    v_mfma_f32_16x16x32_bf16 v[80:83], a[36:39], v[24:27], v[80:83]
    v_mfma_f32_16x16x32_bf16 v[84:87], a[20:23], v[28:31], v[84:87]
    buffer_load_dwordx4 v[172:175], v251, s[12:15], s76 offen sc1
    v_mfma_f32_16x16x32_bf16 v[88:91], a[24:27], v[28:31], v[88:91]
    s_cmp_eq_u32 s38, 6
    s_cselect_b32 s43, s41, 4096
    s_cmp_eq_u32 s38, 5
    s_cselect_b32 s43, s42, s43
    s_add_u32 s76, s76, s43
    v_mfma_f32_16x16x32_bf16 v[92:95], a[28:31], v[28:31], v[92:95]
    buffer_load_dwordx4 v[176:179], v248, s[12:15], s76 offen sc1
    v_mfma_f32_16x16x32_bf16 v[96:99], a[32:35], v[28:31], v[96:99]
    v_mfma_f32_16x16x32_bf16 v[100:103], a[36:39], v[28:31], v[100:103]
    buffer_load_dwordx4 v[180:183], v249, s[12:15], s76 offen sc1
    v_mfma_f32_16x16x32_bf16 v[104:107], a[20:23], v[32:35], v[104:107]
    buffer_load_dwordx4 v[184:187], v250, s[12:15], s76 offen sc1
    v_mfma_f32_16x16x32_bf16 v[108:111], a[24:27], v[32:35], v[108:111]
    buffer_load_dwordx4 v[188:191], v251, s[12:15], s76 offen sc1
    v_mfma_f32_16x16x32_bf16 v[112:115], a[28:31], v[32:35], v[112:115]
    v_mfma_f32_16x16x32_bf16 v[116:119], a[32:35], v[32:35], v[116:119]
    s_cmp_eq_u32 s38, 7
    s_cselect_b32 s43, s41, 4096
    s_cmp_eq_u32 s38, 6
    s_cselect_b32 s43, s42, s43
    s_add_u32 s76, s76, s43
    v_mfma_f32_16x16x32_bf16 v[120:123], a[36:39], v[32:35], v[120:123]
    buffer_load_dwordx4 a[176:179], v253, s[12:15], s73 offen offset:0 sc1
    v_mfma_f32_16x16x32_bf16 v[124:127], a[20:23], v[36:39], v[124:127]
    s_cmp_eq_u32 s38, 9
    s_cselect_b32 s43, s39, 163840
    s_cmp_eq_u32 s38, 8
    s_cselect_b32 s43, s40, s43
    v_add_u32 v253, s43, v253
    v_mfma_f32_16x16x32_bf16 v[128:131], a[24:27], v[36:39], v[128:131]
    v_mfma_f32_16x16x32_bf16 v[132:135], a[28:31], v[36:39], v[132:135]
    buffer_load_dwordx4 a[180:183], v253, s[12:15], s77 offen offset:0 sc1
    v_mfma_f32_16x16x32_bf16 v[136:139], a[32:35], v[36:39], v[136:139]
    buffer_load_dwordx4 a[184:187], v253, s[12:15], s77 offen offset:1024 sc1
    v_mfma_f32_16x16x32_bf16 v[140:143], a[36:39], v[36:39], v[140:143]
    buffer_load_dwordx4 a[188:191], v253, s[12:15], s77 offen offset:2048 sc1
    s_waitcnt vmcnt(24)
    s_nop 0
    v_mfma_f32_16x16x32_bf16 v[64:67], a[40:43], v[40:43], v[64:67]
    v_mfma_f32_16x16x32_bf16 v[68:71], a[44:47], v[40:43], v[68:71]
    buffer_load_dwordx4 v[192:195], v248, s[12:15], s76 offen sc1
    v_mfma_f32_16x16x32_bf16 v[72:75], a[48:51], v[40:43], v[72:75]
    buffer_load_dwordx4 v[196:199], v249, s[12:15], s76 offen sc1
    v_mfma_f32_16x16x32_bf16 v[76:79], a[52:55], v[40:43], v[76:79]
    buffer_load_dwordx4 v[200:203], v250, s[12:15], s76 offen sc1
    v_mfma_f32_16x16x32_bf16 v[80:83], a[56:59], v[40:43], v[80:83]
    v_mfma_f32_16x16x32_bf16 v[84:87], a[40:43], v[44:47], v[84:87]
    buffer_load_dwordx4 v[204:207], v251, s[12:15], s76 offen sc1
    v_mfma_f32_16x16x32_bf16 v[88:91], a[44:47], v[44:47], v[88:91]
    s_cmp_eq_u32 s38, 8
    s_cselect_b32 s43, s41, 4096
    s_cmp_eq_u32 s38, 7
    s_cselect_b32 s43, s42, s43
    s_add_u32 s76, s76, s43
    v_mfma_f32_16x16x32_bf16 v[92:95], a[48:51], v[44:47], v[92:95]
    buffer_load_dwordx4 a[0:3], v248, s[12:15], s76 offen sc1
    v_mfma_f32_16x16x32_bf16 v[96:99], a[52:55], v[44:47], v[96:99]
    v_mfma_f32_16x16x32_bf16 v[100:103], a[56:59], v[44:47], v[100:103]
    buffer_load_dwordx4 a[4:7], v249, s[12:15], s76 offen sc1
    v_mfma_f32_16x16x32_bf16 v[104:107], a[40:43], v[48:51], v[104:107]
    buffer_load_dwordx4 a[8:11], v250, s[12:15], s76 offen sc1
    v_mfma_f32_16x16x32_bf16 v[108:111], a[44:47], v[48:51], v[108:111]
    buffer_load_dwordx4 a[12:15], v251, s[12:15], s76 offen sc1
    v_mfma_f32_16x16x32_bf16 v[112:115], a[48:51], v[48:51], v[112:115]
    v_mfma_f32_16x16x32_bf16 v[116:119], a[52:55], v[48:51], v[116:119]
    s_cmp_eq_u32 s38, 9
    s_cselect_b32 s43, s41, 4096
    s_cmp_eq_u32 s38, 8
    s_cselect_b32 s43, s42, s43
    s_add_u32 s76, s76, s43
    v_mfma_f32_16x16x32_bf16 v[120:123], a[56:59], v[48:51], v[120:123]
    buffer_load_dwordx4 a[192:195], v253, s[12:15], s77 offen offset:3072 sc1
    v_mfma_f32_16x16x32_bf16 v[124:127], a[40:43], v[52:55], v[124:127]
    buffer_load_dwordx4 a[196:199], v253, s[12:15], s73 offen offset:0 sc1
    v_mfma_f32_16x16x32_bf16 v[128:131], a[44:47], v[52:55], v[128:131]
    v_mfma_f32_16x16x32_bf16 v[132:135], a[48:51], v[52:55], v[132:135]
    s_cmp_eq_u32 s38, 10
    s_cselect_b32 s43, s39, 163840
    s_cmp_eq_u32 s38, 9
    s_cselect_b32 s43, s40, s43
    v_add_u32 v253, s43, v253
    v_mfma_f32_16x16x32_bf16 v[136:139], a[52:55], v[52:55], v[136:139]
    buffer_load_dwordx4 a[200:203], v253, s[12:15], s77 offen offset:0 sc1
    v_mfma_f32_16x16x32_bf16 v[140:143], a[56:59], v[52:55], v[140:143]
    buffer_load_dwordx4 a[204:207], v253, s[12:15], s77 offen offset:1024 sc1
    s_waitcnt vmcnt(32)
    v_mfma_f32_16x16x32_bf16 v[64:67], a[60:63], v[144:147], v[64:67]
    v_add_u32 v6, 0, v0
    v_mfma_f32_16x16x32_bf16 v[68:71], a[64:67], v[144:147], v[68:71]
    buffer_load_dwordx4 a[20:23], v248, s[12:15], s76 offen sc1
    v_mul_u32_u24 v7, 6554, v6
    v_mfma_f32_16x16x32_bf16 v[72:75], a[68:71], v[144:147], v[72:75]
    buffer_load_dwordx4 a[24:27], v249, s[12:15], s76 offen sc1
    v_lshrrev_b32_e64 v7, 16, v7
    v_mfma_f32_16x16x32_bf16 v[76:79], a[72:75], v[144:147], v[76:79]
    v_mul_u32_u24 v50, 1120, v7
    buffer_load_dwordx4 a[28:31], v250, s[12:15], s76 offen sc1
    v_mfma_f32_16x16x32_bf16 v[80:83], a[76:79], v[144:147], v[80:83]
    v_lshl_add_u32 v50, v6, 4, v50
    v_add_u32_e64 v6, 64, v0
    v_mfma_f32_16x16x32_bf16 v[84:87], a[60:63], v[148:151], v[84:87]
    buffer_load_dwordx4 a[32:35], v251, s[12:15], s76 offen sc1
    v_mul_u32_u24 v7, 6554, v6
    v_mfma_f32_16x16x32_bf16 v[88:91], a[64:67], v[148:151], v[88:91]
    s_cmp_eq_u32 s38, 10
    s_cselect_b32 s43, s41, 4096
    s_cmp_eq_u32 s38, 9
    s_cselect_b32 s43, s42, s43
    s_add_u32 s76, s76, s43
    v_lshrrev_b32_e64 v7, 16, v7
    v_mfma_f32_16x16x32_bf16 v[92:95], a[68:71], v[148:151], v[92:95]
    v_mul_u32_u24 v51, 1120, v7
    buffer_load_dwordx4 a[40:43], v248, s[12:15], s76 offen sc1
    v_mfma_f32_16x16x32_bf16 v[96:99], a[72:75], v[148:151], v[96:99]
    v_lshl_add_u32 v51, v6, 4, v51
    buffer_load_dwordx4 a[44:47], v249, s[12:15], s76 offen sc1
    v_mfma_f32_16x16x32_bf16 v[100:103], a[76:79], v[148:151], v[100:103]
    v_add_u32 v6, 128, v0
    v_mul_u32_u24 v7, 6554, v6
    v_mfma_f32_16x16x32_bf16 v[104:107], a[60:63], v[152:155], v[104:107]
    buffer_load_dwordx4 a[48:51], v250, s[12:15], s76 offen sc1
    v_mfma_f32_16x16x32_bf16 v[108:111], a[64:67], v[152:155], v[108:111]
    v_lshrrev_b32_e64 v7, 16, v7
    buffer_load_dwordx4 a[52:55], v251, s[12:15], s76 offen sc1
    v_mfma_f32_16x16x32_bf16 v[112:115], a[68:71], v[152:155], v[112:115]
    v_mul_u32_u24 v52, 1120, v7
    v_lshl_add_u32 v52, v6, 4, v52
    v_mfma_f32_16x16x32_bf16 v[116:119], a[72:75], v[152:155], v[116:119]
    s_cmp_eq_u32 s38, 11
    s_cselect_b32 s43, s41, 4096
    s_cmp_eq_u32 s38, 10
    s_cselect_b32 s43, s42, s43
    s_add_u32 s76, s76, s43
    v_cmp_gt_u32_e64 vcc, 32, v0
    v_mfma_f32_16x16x32_bf16 v[120:123], a[76:79], v[152:155], v[120:123]
    buffer_load_dwordx4 a[208:211], v253, s[12:15], s77 offen offset:2048 sc1
    v_mov_b32 v6, 16777216
    v_mfma_f32_16x16x32_bf16 v[124:127], a[60:63], v[156:159], v[124:127]
    s_lshl_b32 s30, s74, 2
    buffer_load_dwordx4 a[212:215], v253, s[12:15], s77 offen offset:3072 sc1
    v_mfma_f32_16x16x32_bf16 v[128:131], a[64:67], v[156:159], v[128:131]
    s_add_u32 s30, s30, s3
    buffer_load_dwordx4 a[216:219], v253, s[12:15], s73 offen offset:0 sc1
    v_mfma_f32_16x16x32_bf16 v[132:135], a[68:71], v[156:159], v[132:135]
    s_mul_i32 s32, s75, 160
    s_mul_i32 s35, s30, 20480
    v_mfma_f32_16x16x32_bf16 v[136:139], a[72:75], v[156:159], v[136:139]
    s_cmp_eq_u32 s38, 11
    s_cselect_b32 s43, s39, 163840
    s_cmp_eq_u32 s38, 10
    s_cselect_b32 s43, s40, s43
    v_add_u32_e64 v253, s43, v253
    s_add_u32 s35, s35, s32
    v_mfma_f32_16x16x32_bf16 v[140:143], a[76:79], v[156:159], v[140:143]
    buffer_load_dwordx4 a[220:223], v253, s[12:15], s77 offen offset:0 sc1
    v_cndmask_b32 v52, v6, v52, vcc
    s_waitcnt vmcnt(40)
    v_mfma_f32_16x16x32_bf16 v[64:67], a[80:83], v[232:235], v[64:67]
    buffer_load_dwordx4 a[60:63], v248, s[12:15], s76 offen sc1
    v_mfma_f32_16x16x32_bf16 v[68:71], a[84:87], v[232:235], v[68:71]
    buffer_load_dwordx4 a[64:67], v249, s[12:15], s76 offen sc1
    v_mfma_f32_16x16x32_bf16 v[72:75], a[88:91], v[232:235], v[72:75]
    buffer_load_dwordx4 a[68:71], v250, s[12:15], s76 offen sc1
    buffer_load_dwordx4 a[72:75], v251, s[12:15], s76 offen sc1
    v_mfma_f32_16x16x32_bf16 v[76:79], a[92:95], v[232:235], v[76:79]
    s_cmp_eq_u32 s38, 12
    s_cselect_b32 s43, s41, 4096
    s_cmp_eq_u32 s38, 11
    s_cselect_b32 s43, s42, s43
    s_add_u32 s76, s76, s43
    v_mfma_f32_16x16x32_bf16 v[80:83], a[96:99], v[232:235], v[80:83]
    buffer_load_dwordx4 a[224:227], v253, s[12:15], s77 offen offset:1024 sc1
    buffer_load_dwordx4 a[228:231], v253, s[12:15], s77 offen offset:2048 sc1
    v_mfma_f32_16x16x32_bf16 v[84:87], a[80:83], v[236:239], v[84:87]
    buffer_load_dwordx4 a[232:235], v253, s[12:15], s77 offen offset:3072 sc1
    v_mfma_f32_16x16x32_bf16 v[88:91], a[84:87], v[236:239], v[88:91]
    buffer_load_dwordx4 a[236:239], v253, s[12:15], s73 offen offset:0 sc1
    s_cmp_eq_u32 s38, 12
    s_cselect_b32 s43, s39, 163840
    s_cmp_eq_u32 s38, 11
    s_cselect_b32 s43, s40, s43
    v_add_u32 v253, s43, v253
    v_mfma_f32_16x16x32_bf16 v[92:95], a[88:91], v[236:239], v[92:95]
    buffer_load_dwordx4 v[8:11], v50, s[8:11], s35 offen
    v_mfma_f32_16x16x32_bf16 v[96:99], a[92:95], v[236:239], v[96:99]
    buffer_load_dwordx4 v[12:15], v51, s[8:11], s35 offen
    buffer_load_dwordx4 v[16:19], v52, s[8:11], s35 offen
    v_mfma_f32_16x16x32_bf16 v[100:103], a[96:99], v[236:239], v[100:103]
    v_lshlrev_b32_e64 v3, 2, v0
    v_mfma_f32_16x16x32_bf16 v[104:107], a[80:83], v[240:243], v[104:107]
    s_mov_b32 s20, s58
    v_mfma_f32_16x16x32_bf16 v[108:111], a[84:87], v[240:243], v[108:111]
    s_mov_b32 s21, s59
    s_mov_b32 s22, 1280
    v_mfma_f32_16x16x32_bf16 v[112:115], a[88:91], v[240:243], v[112:115]
    s_mov_b32 s23, 0x00020000
    v_mfma_f32_16x16x32_bf16 v[116:119], a[92:95], v[240:243], v[116:119]
    buffer_load_dword v20, v3, s[20:23], s32 offen
    s_mov_b32 s20, s48
    v_mfma_f32_16x16x32_bf16 v[120:123], a[96:99], v[240:243], v[120:123]
    s_mov_b32 s21, s49
    v_mfma_f32_16x16x32_bf16 v[124:127], a[80:83], v[244:247], v[124:127]
    s_mov_b32 s22, 1280
    s_mov_b32 s23, 0x00020000
    v_mfma_f32_16x16x32_bf16 v[128:131], a[84:87], v[244:247], v[128:131]
    buffer_load_dword v21, v3, s[20:23], s32 offen
    v_mfma_f32_16x16x32_bf16 v[132:135], a[88:91], v[244:247], v[132:135]
    v_and_b32 v2, 15, v0
    v_lshlrev_b32 v2, 4, v2
    v_mfma_f32_16x16x32_bf16 v[136:139], a[92:95], v[244:247], v[136:139]
    s_lshl_b32 s30, s30, 8
    v_mfma_f32_16x16x32_bf16 v[140:143], a[96:99], v[244:247], v[140:143]
    s_add_u32 s30, s30, 2621440
    buffer_load_dwordx2 v[38:39], v2, s[12:15], s30 offen offset:8 sc1
    s_waitcnt vmcnt(46)
    v_mfma_f32_16x16x32_bf16 v[64:67], a[100:103], v[160:163], v[64:67]
    s_mul_i32 s4, s3, 2560
    s_add_u32 s34, s4, 97280
    v_mfma_f32_16x16x32_bf16 v[68:71], a[104:107], v[160:163], v[68:71]
    v_add_u32_e64 v53, s34, v252
    buffer_load_dwordx4 a[80:83], v248, s[12:15], s76 offen sc1
    v_min_u32_e64 v2, 39, v0
    v_mfma_f32_16x16x32_bf16 v[72:75], a[108:111], v[160:163], v[72:75]
    v_lshlrev_b32_e64 v2, 3, v2
    v_add_u32 v2, 107520, v2
    v_mfma_f32_16x16x32_bf16 v[76:79], a[112:115], v[160:163], v[76:79]
    v_and_b32_e64 v4, 15, v0
    buffer_load_dwordx4 a[84:87], v249, s[12:15], s76 offen sc1
    v_mul_u32_u24 v4, 160, v4
    v_mfma_f32_16x16x32_bf16 v[80:83], a[116:119], v[160:163], v[80:83]
    v_lshrrev_b32_e64 v5, 4, v0
    v_lshl_add_u32 v4, v5, 3, v4
    v_mfma_f32_16x16x32_bf16 v[84:87], a[100:103], v[164:167], v[84:87]
    v_add_u32 v54, s34, v4
    v_lshlrev_b32 v5, 4, v5
    buffer_load_dwordx4 a[88:91], v250, s[12:15], s76 offen sc1
    v_mfma_f32_16x16x32_bf16 v[88:91], a[104:107], v[164:167], v[88:91]
    v_add_u32 v55, 107520, v5
    s_lshl_b32 s5, s3, 10
    v_mfma_f32_16x16x32_bf16 v[92:95], a[108:111], v[164:167], v[92:95]
    s_add_u32 s5, s5, 84992
    v_add_u32 v6, s5, v252
    buffer_load_dwordx4 a[92:95], v251, s[12:15], s76 offen sc1
    v_mfma_f32_16x16x32_bf16 v[96:99], a[112:115], v[164:167], v[96:99]
    s_add_u32 s4, s3, 1
    s_and_b32 s4, s4, 3
    v_mfma_f32_16x16x32_bf16 v[100:103], a[116:119], v[164:167], v[100:103]
    s_mul_i32 s4, s4, 15360
    s_add_u32 s4, s4, 0
    v_add_u32 v3, s4, v252
    v_mfma_f32_16x16x32_bf16 v[104:107], a[100:103], v[168:171], v[104:107]
    s_cmp_eq_u32 s38, 13
    s_cselect_b32 s43, s41, 4096
    s_cmp_eq_u32 s38, 12
    s_cselect_b32 s43, s42, s43
    s_add_u32 s76, s76, s43
    s_add_u32 s4, s3, 2
    v_mfma_f32_16x16x32_bf16 v[108:111], a[104:107], v[168:171], v[108:111]
    s_and_b32 s4, s4, 3
    s_mul_i32 s4, s4, 15360
    s_add_u32 s4, s4, 5120
    v_mfma_f32_16x16x32_bf16 v[112:115], a[108:111], v[168:171], v[112:115]
    v_add_u32_e64 v4, s4, v252
    buffer_load_dwordx4 a[240:243], v253, s[12:15], s77 offen offset:0 sc1
    v_mfma_f32_16x16x32_bf16 v[116:119], a[112:115], v[168:171], v[116:119]
    s_add_u32 s4, s3, 3
    s_and_b32 s4, s4, 3
    s_mul_i32 s4, s4, 15360
    v_mfma_f32_16x16x32_bf16 v[120:123], a[116:119], v[168:171], v[120:123]
    s_add_u32 s4, s4, 10240
    buffer_load_dwordx4 a[244:247], v253, s[12:15], s77 offen offset:1024 sc1
    v_mfma_f32_16x16x32_bf16 v[124:127], a[100:103], v[172:175], v[124:127]
    v_add_u32_e64 v5, s4, v252
    s_mul_i32 s4, s3, 15360
    s_add_u32 s4, s4, 0
    v_mfma_f32_16x16x32_bf16 v[128:131], a[104:107], v[172:175], v[128:131]
    v_add_u32 v48, s4, v252
    v_lshrrev_b32_e64 v49, 2, v0
    v_mfma_f32_16x16x32_bf16 v[132:135], a[108:111], v[172:175], v[132:135]
    buffer_load_dwordx4 a[248:251], v253, s[12:15], s77 offen offset:2048 sc1
    v_lshlrev_b32 v49, 7, v49
    v_and_b32 v7, 3, v0
    v_mfma_f32_16x16x32_bf16 v[136:139], a[112:115], v[172:175], v[136:139]
    v_lshl_add_u32 v49, v7, 3, v49
    s_lshl_b32 s4, s3, 5
    v_mfma_f32_16x16x32_bf16 v[140:143], a[116:119], v[172:175], v[140:143]
    buffer_load_dwordx4 a[252:255], v253, s[12:15], s77 offen offset:3072 sc1
    s_add_u32 s4, s4, 84992
    v_add_u32_e64 v49, s4, v49
    s_waitcnt vmcnt(50)
    v_mfma_f32_16x16x32_bf16 v[64:67], a[120:123], v[176:179], v[64:67]
    v_mfma_f32_16x16x32_bf16 v[68:71], a[124:127], v[176:179], v[68:71]
    buffer_load_dwordx4 a[100:103], v248, s[12:15], s76 offen sc1
    v_mfma_f32_16x16x32_bf16 v[72:75], a[128:131], v[176:179], v[72:75]
    v_mfma_f32_16x16x32_bf16 v[76:79], a[132:135], v[176:179], v[76:79]
    buffer_load_dwordx4 a[104:107], v249, s[12:15], s76 offen sc1
    v_mfma_f32_16x16x32_bf16 v[80:83], a[136:139], v[176:179], v[80:83]
    v_mfma_f32_16x16x32_bf16 v[84:87], a[120:123], v[180:183], v[84:87]
    buffer_load_dwordx4 a[108:111], v250, s[12:15], s76 offen sc1
    v_mfma_f32_16x16x32_bf16 v[88:91], a[124:127], v[180:183], v[88:91]
    v_mfma_f32_16x16x32_bf16 v[92:95], a[128:131], v[180:183], v[92:95]
    buffer_load_dwordx4 a[112:115], v251, s[12:15], s76 offen sc1
    v_mfma_f32_16x16x32_bf16 v[96:99], a[132:135], v[180:183], v[96:99]
    v_mfma_f32_16x16x32_bf16 v[100:103], a[136:139], v[180:183], v[100:103]
    buffer_load_dwordx4 a[16:19], v253, s[12:15], s73 offen offset:0 sc1
    v_mfma_f32_16x16x32_bf16 v[104:107], a[120:123], v[184:187], v[104:107]
    s_cmp_eq_u32 s38, 13
    s_cselect_b32 s43, s39, 163840
    s_cmp_eq_u32 s38, 12
    s_cselect_b32 s43, s40, s43
    v_add_u32 v253, s43, v253
    v_mfma_f32_16x16x32_bf16 v[108:111], a[124:127], v[184:187], v[108:111]
    v_mfma_f32_16x16x32_bf16 v[112:115], a[128:131], v[184:187], v[112:115]
    buffer_load_dwordx4 a[36:39], v253, s[12:15], s77 offen offset:0 sc1
    v_mfma_f32_16x16x32_bf16 v[116:119], a[132:135], v[184:187], v[116:119]
    v_mfma_f32_16x16x32_bf16 v[120:123], a[136:139], v[184:187], v[120:123]
    buffer_load_dwordx4 a[56:59], v253, s[12:15], s77 offen offset:1024 sc1
    v_mfma_f32_16x16x32_bf16 v[124:127], a[120:123], v[188:191], v[124:127]
    v_mfma_f32_16x16x32_bf16 v[128:131], a[124:127], v[188:191], v[128:131]
    buffer_load_dwordx4 a[76:79], v253, s[12:15], s77 offen offset:2048 sc1
    v_mfma_f32_16x16x32_bf16 v[132:135], a[128:131], v[188:191], v[132:135]
    v_mfma_f32_16x16x32_bf16 v[136:139], a[132:135], v[188:191], v[136:139]
    buffer_load_dwordx4 a[96:99], v253, s[12:15], s77 offen offset:3072 sc1
    v_mfma_f32_16x16x32_bf16 v[140:143], a[136:139], v[188:191], v[140:143]
    buffer_load_dwordx4 a[116:119], v253, s[12:15], s73 offen offset:0 sc1
    s_waitcnt vmcnt(18)
    s_waitcnt vmcnt(52)
    v_mfma_f32_16x16x32_bf16 v[64:67], a[140:143], v[192:195], v[64:67]
    v_mfma_f32_16x16x32_bf16 v[68:71], a[144:147], v[192:195], v[68:71]
    v_mfma_f32_16x16x32_bf16 v[72:75], a[148:151], v[192:195], v[72:75]
    v_cmp_gt_u32_e64 vcc, 40, v0
    v_mfma_f32_16x16x32_bf16 v[76:79], a[152:155], v[192:195], v[76:79]
    v_mfma_f32_16x16x32_bf16 v[80:83], a[156:159], v[192:195], v[80:83]
    v_lshlrev_b32_e64 v22, 16, v20
    v_mfma_f32_16x16x32_bf16 v[84:87], a[140:143], v[196:199], v[84:87]
    v_mfma_f32_16x16x32_bf16 v[88:91], a[144:147], v[196:199], v[88:91]
    v_and_b32 v23, 0xffff0000, v20
    v_mfma_f32_16x16x32_bf16 v[92:95], a[148:151], v[196:199], v[92:95]
    v_mfma_f32_16x16x32_bf16 v[96:99], a[152:155], v[196:199], v[96:99]
    v_lshlrev_b32_e64 v24, 16, v21
    v_mfma_f32_16x16x32_bf16 v[100:103], a[156:159], v[196:199], v[100:103]
    v_mfma_f32_16x16x32_bf16 v[104:107], a[140:143], v[200:203], v[104:107]
    v_mfma_f32_16x16x32_bf16 v[108:111], a[144:147], v[200:203], v[108:111]
    v_and_b32 v25, 0xffff0000, v21
    v_mfma_f32_16x16x32_bf16 v[112:115], a[148:151], v[200:203], v[112:115]
    v_mfma_f32_16x16x32_bf16 v[116:119], a[152:155], v[200:203], v[116:119]
    s_mov_b64 exec, vcc
    ds_write_b64 v2, v[22:23]
    ds_write_b64 v2, v[24:25] offset:320
    s_mov_b64 exec, -1
    v_mfma_f32_16x16x32_bf16 v[120:123], a[156:159], v[200:203], v[120:123]
    v_mfma_f32_16x16x32_bf16 v[124:127], a[140:143], v[204:207], v[124:127]
    ds_write_b128 v53, v[8:11]
    v_mfma_f32_16x16x32_bf16 v[128:131], a[144:147], v[204:207], v[128:131]
    v_mfma_f32_16x16x32_bf16 v[132:135], a[148:151], v[204:207], v[132:135]
    ds_write_b128 v53, v[12:15] offset:1024
    v_mfma_f32_16x16x32_bf16 v[136:139], a[152:155], v[204:207], v[136:139]
    v_mfma_f32_16x16x32_bf16 v[140:143], a[156:159], v[204:207], v[140:143]
    s_mov_b64 exec, 0xffffffff
    ds_write_b128 v53, v[16:19] offset:2048
    s_mov_b64 exec, -1
    s_waitcnt vmcnt(48)
    s_waitcnt vmcnt(59)
    s_nop 0
    v_mfma_f32_16x16x32_bf16 v[84:87], a[160:163], a[4:7], v[84:87]
    ds_read_b64 v[8:9], v54 offset:0
    ds_read_b64 v[10:11], v54 offset:32
    v_mfma_f32_16x16x32_bf16 v[88:91], a[164:167], a[4:7], v[88:91]
    ds_read_b64 v[12:13], v54 offset:64
    ds_read_b64 v[14:15], v54 offset:96
    v_mfma_f32_16x16x32_bf16 v[92:95], a[168:171], a[4:7], v[92:95]
    ds_read_b64 v[16:17], v54 offset:128
    ds_read_b128 v[160:163], v55 offset:0
    v_mfma_f32_16x16x32_bf16 v[96:99], a[172:175], a[4:7], v[96:99]
    ds_read_b128 v[180:183], v55 offset:320
    ds_read_b128 v[164:167], v55 offset:64
    v_mfma_f32_16x16x32_bf16 v[100:103], a[176:179], a[4:7], v[100:103]
    ds_read_b128 v[184:187], v55 offset:384
    ds_read_b128 v[168:171], v55 offset:128
    s_waitcnt vmcnt(40)
    s_waitcnt vmcnt(46)
    v_mfma_f32_16x16x32_bf16 v[84:87], a[180:183], a[24:27], v[84:87]
    ds_read_b128 v[188:191], v55 offset:448
    ds_read_b128 v[172:175], v55 offset:192
    v_mfma_f32_16x16x32_bf16 v[88:91], a[184:187], a[24:27], v[88:91]
    ds_read_b128 v[192:195], v55 offset:512
    ds_read_b128 v[176:179], v55 offset:256
    v_mfma_f32_16x16x32_bf16 v[92:95], a[188:191], a[24:27], v[92:95]
    ds_read_b128 v[196:199], v55 offset:576
    v_mfma_f32_16x16x32_bf16 v[96:99], a[192:195], a[24:27], v[96:99]
    v_mfma_f32_16x16x32_bf16 v[100:103], a[196:199], a[24:27], v[100:103]
    s_waitcnt vmcnt(36)
    s_waitcnt vmcnt(33)
    v_mfma_f32_16x16x32_bf16 v[84:87], a[200:203], a[44:47], v[84:87]
    v_mfma_f32_16x16x32_bf16 v[88:91], a[204:207], a[44:47], v[88:91]
    s_waitcnt lgkmcnt(0)
    v_lshlrev_b32 v204, 16, v8
    v_and_b32 v205, 0xffff0000, v8
    v_mfma_f32_16x16x32_bf16 v[92:95], a[208:211], a[44:47], v[92:95]
    v_fma_f32 v20, v204, v38, v39
    v_fma_f32 v21, v205, v38, v39
    v_mfma_f32_16x16x32_bf16 v[96:99], a[212:215], a[44:47], v[96:99]
    v_mul_f32 v20, v20, v180
    v_mul_f32 v21, v21, v181
    v_mfma_f32_16x16x32_bf16 v[100:103], a[216:219], a[44:47], v[100:103]
    v_lshlrev_b32_e64 v206, 16, v9
    v_and_b32 v207, 0xffff0000, v9
    s_waitcnt vmcnt(28)
    s_waitcnt vmcnt(24)
    v_mfma_f32_16x16x32_bf16 v[84:87], a[220:223], a[64:67], v[84:87]
    v_fma_f32 v22, v206, v38, v39
    v_fma_f32 v23, v207, v38, v39
    v_mfma_f32_16x16x32_bf16 v[88:91], a[224:227], a[64:67], v[88:91]
    v_mul_f32 v22, v22, v182
    v_mul_f32 v23, v23, v183
    v_mfma_f32_16x16x32_bf16 v[92:95], a[228:231], a[64:67], v[92:95]
    v_lshlrev_b32_e64 v208, 16, v10
    v_and_b32 v209, 0xffff0000, v10
    v_mfma_f32_16x16x32_bf16 v[96:99], a[232:235], a[64:67], v[96:99]
    v_fma_f32 v24, v208, v38, v39
    v_fma_f32 v25, v209, v38, v39
    v_mfma_f32_16x16x32_bf16 v[100:103], a[236:239], a[64:67], v[100:103]
    v_mul_f32 v24, v24, v184
    v_mul_f32 v25, v25, v185
    s_waitcnt vmcnt(14)
    s_waitcnt vmcnt(0)
    v_mfma_f32_16x16x32_bf16 v[84:87], a[240:243], a[84:87], v[84:87]
    v_lshlrev_b32_e64 v210, 16, v11
    v_and_b32 v211, 0xffff0000, v11
    v_mfma_f32_16x16x32_bf16 v[88:91], a[244:247], a[84:87], v[88:91]
    v_fma_f32 v26, v210, v38, v39
    v_fma_f32 v27, v211, v38, v39
    v_mfma_f32_16x16x32_bf16 v[92:95], a[248:251], a[84:87], v[92:95]
    v_mul_f32 v26, v26, v186
    v_mul_f32 v27, v27, v187
    v_mfma_f32_16x16x32_bf16 v[96:99], a[252:255], a[84:87], v[96:99]
    v_lshlrev_b32_e64 v212, 16, v12
    v_and_b32 v213, 0xffff0000, v12
    v_mfma_f32_16x16x32_bf16 v[100:103], a[16:19], a[84:87], v[100:103]
    v_fma_f32 v28, v212, v38, v39
    v_fma_f32 v29, v213, v38, v39
    s_waitcnt vmcnt(6)
    s_waitcnt vmcnt(0)
    v_mfma_f32_16x16x32_bf16 v[84:87], a[36:39], a[104:107], v[84:87]
    v_mul_f32 v28, v28, v188
    v_mul_f32 v29, v29, v189
    v_mfma_f32_16x16x32_bf16 v[88:91], a[56:59], a[104:107], v[88:91]
    v_lshlrev_b32_e64 v214, 16, v13
    v_and_b32 v215, 0xffff0000, v13
    v_mfma_f32_16x16x32_bf16 v[92:95], a[76:79], a[104:107], v[92:95]
    v_fma_f32 v30, v214, v38, v39
    v_fma_f32 v31, v215, v38, v39
    v_mfma_f32_16x16x32_bf16 v[96:99], a[96:99], a[104:107], v[96:99]
    v_mul_f32 v30, v30, v190
    v_mul_f32 v31, v31, v191
    v_mfma_f32_16x16x32_bf16 v[100:103], a[116:119], a[104:107], v[100:103]
    v_mfma_f32_16x16x32_bf16 v[104:107], a[160:163], a[8:11], v[104:107]
    v_lshlrev_b32_e64 v216, 16, v14
    v_and_b32 v217, 0xffff0000, v14
    v_mfma_f32_16x16x32_bf16 v[108:111], a[164:167], a[8:11], v[108:111]
    v_fma_f32 v32, v216, v38, v39
    v_fma_f32 v33, v217, v38, v39
    v_mfma_f32_16x16x32_bf16 v[112:115], a[168:171], a[8:11], v[112:115]
    v_mul_f32 v32, v32, v192
    v_mul_f32 v33, v33, v193
    v_mfma_f32_16x16x32_bf16 v[116:119], a[172:175], a[8:11], v[116:119]
    v_lshlrev_b32_e64 v218, 16, v15
    v_and_b32 v219, 0xffff0000, v15
    v_mfma_f32_16x16x32_bf16 v[120:123], a[176:179], a[8:11], v[120:123]
    v_fma_f32 v34, v218, v38, v39
    v_fma_f32 v35, v219, v38, v39
    v_mfma_f32_16x16x32_bf16 v[104:107], a[180:183], a[28:31], v[104:107]
    ds_write_b128 v3, v[84:87] offset:0
    v_mfma_f32_16x16x32_bf16 v[108:111], a[184:187], a[28:31], v[108:111]
    v_mfma_f32_16x16x32_bf16 v[112:115], a[188:191], a[28:31], v[112:115]
    v_mul_f32 v34, v34, v194
    v_mul_f32 v35, v35, v195
    v_mfma_f32_16x16x32_bf16 v[116:119], a[192:195], a[28:31], v[116:119]
    v_mfma_f32_16x16x32_bf16 v[120:123], a[196:199], a[28:31], v[120:123]
    v_lshlrev_b32_e64 v220, 16, v16
    v_and_b32 v221, 0xffff0000, v16
    v_mfma_f32_16x16x32_bf16 v[104:107], a[200:203], a[48:51], v[104:107]
    ds_write_b128 v3, v[88:91] offset:1024
    v_mfma_f32_16x16x32_bf16 v[108:111], a[204:207], a[48:51], v[108:111]
    v_fma_f32 v36, v220, v38, v39
    v_fma_f32 v37, v221, v38, v39
    v_mfma_f32_16x16x32_bf16 v[112:115], a[208:211], a[48:51], v[112:115]
    v_mfma_f32_16x16x32_bf16 v[116:119], a[212:215], a[48:51], v[116:119]
    v_mul_f32 v36, v36, v196
    v_mul_f32 v37, v37, v197
    v_mfma_f32_16x16x32_bf16 v[120:123], a[216:219], a[48:51], v[120:123]
    v_mfma_f32_16x16x32_bf16 v[104:107], a[220:223], a[68:71], v[104:107]
    ds_write_b128 v3, v[92:95] offset:2048
    v_lshlrev_b32_e64 v222, 16, v17
    v_and_b32 v223, 0xffff0000, v17
    v_mfma_f32_16x16x32_bf16 v[108:111], a[224:227], a[68:71], v[108:111]
    v_mfma_f32_16x16x32_bf16 v[112:115], a[228:231], a[68:71], v[112:115]
    v_fma_f32 v40, v222, v38, v39
    v_fma_f32 v41, v223, v38, v39
    v_mfma_f32_16x16x32_bf16 v[116:119], a[232:235], a[68:71], v[116:119]
    v_mfma_f32_16x16x32_bf16 v[120:123], a[236:239], a[68:71], v[120:123]
    v_mul_f32 v40, v40, v198
    v_mul_f32 v41, v41, v199
    v_mfma_f32_16x16x32_bf16 v[104:107], a[240:243], a[88:91], v[104:107]
    ds_write_b128 v3, v[96:99] offset:3072
    v_mfma_f32_16x16x32_bf16 v[108:111], a[244:247], a[88:91], v[108:111]
    v_mfma_f32_16x16x32_bf16 v[112:115], a[248:251], a[88:91], v[112:115]
    v_mfma_f32_16x16x32_bf16 v[116:119], a[252:255], a[88:91], v[116:119]
    v_mfma_f32_16x16x32_bf16 v[120:123], a[16:19], a[88:91], v[120:123]
    v_mfma_f32_16x16x32_bf16 v[104:107], a[36:39], a[108:111], v[104:107]
    ds_write_b128 v3, v[100:103] offset:4096
    v_mfma_f32_16x16x32_bf16 v[108:111], a[56:59], a[108:111], v[108:111]
    v_mfma_f32_16x16x32_bf16 v[112:115], a[76:79], a[108:111], v[112:115]
    v_mfma_f32_16x16x32_bf16 v[116:119], a[96:99], a[108:111], v[116:119]
    v_mfma_f32_16x16x32_bf16 v[120:123], a[116:119], a[108:111], v[120:123]
    s_waitcnt lgkmcnt(0)
    s_mov_b32 s5, 0
    s_cmp_lg_u32 s3, 0
    s_cbranch_scc1 L_pok_38
    s_branch L_pld_40
L_ptop_39:
    v_cmp_eq_u32 vcc, v56, v255
    s_and_b32 s6, vcc_lo, 0xfffff
    s_cbranch_scc0 L_pok_38
    s_add_u32 s5, s5, 1
    s_cmp_gt_u32 s5, 200000
    s_cbranch_scc1 L_pok_38
    s_sleep 8
L_pld_40:
    s_mov_b64 exec, 0xfffff
    s_mov_b32 s4, 14876672
    buffer_load_dword v56, v254, s[12:15], s4 offen sc1
    s_mov_b64 exec, -1
    s_waitcnt vmcnt(0)
    s_branch L_ptop_39
L_pok_38:
    s_barrier
    v_mfma_f32_16x16x32_bf16 v[124:127], a[160:163], a[12:15], v[124:127]
    ds_read_b128 v[84:87], v48 offset:0
    v_lshrrev_b32 v2, 3, v0
    v_lshlrev_b32 v2, 12, v2
    v_mfma_f32_16x16x32_bf16 v[128:131], a[164:167], a[12:15], v[128:131]
    ds_read_b128 v[88:91], v48 offset:1024
    v_and_b32_e64 v7, 7, v0
    v_lshl_add_u32 v2, v7, 4, v2
    v_mfma_f32_16x16x32_bf16 v[132:135], a[168:171], a[12:15], v[132:135]
    ds_read_b128 v[92:95], v48 offset:2048
    s_mul_i32 s4, s75, 80
    s_lshl_b32 s5, s3, 3
    v_mfma_f32_16x16x32_bf16 v[136:139], a[172:175], a[12:15], v[136:139]
    ds_read_b128 v[96:99], v48 offset:3072
    s_add_u32 s4, s4, s5
    s_lshl_b32 s4, s4, 12
    v_mfma_f32_16x16x32_bf16 v[140:143], a[176:179], a[12:15], v[140:143]
    ds_read_b128 v[100:103], v48 offset:4096
    s_lshl_b32 s5, s74, 7
    s_add_u32 s4, s4, s5
    s_nop 0
    v_mfma_f32_16x16x32_bf16 v[124:127], a[180:183], a[32:35], v[124:127]
    s_add_u32 s4, s4, 2686976
    buffer_load_dwordx4 v[144:147], v2, s[12:15], s4 offen sc1
    v_mfma_f32_16x16x32_bf16 v[128:131], a[184:187], a[32:35], v[128:131]
    s_add_u32 s4, s4, 131072
    buffer_load_dwordx4 v[148:151], v2, s[12:15], s4 offen sc1
    v_mfma_f32_16x16x32_bf16 v[132:135], a[188:191], a[32:35], v[132:135]
    s_add_u32 s4, s4, 131072
    s_cmp_lt_u32 s3, 2
    s_nop 0
    v_mfma_f32_16x16x32_bf16 v[136:139], a[192:195], a[32:35], v[136:139]
    s_cselect_b32 s4, s4, 16777216
    buffer_load_dwordx4 v[152:155], v2, s[12:15], s4 offen sc1
    v_mfma_f32_16x16x32_bf16 v[140:143], a[196:199], a[32:35], v[140:143]
    ds_write_b128 v4, v[104:107] offset:0
    v_mfma_f32_16x16x32_bf16 v[124:127], a[200:203], a[52:55], v[124:127]
    v_mfma_f32_16x16x32_bf16 v[128:131], a[204:207], a[52:55], v[128:131]
    s_waitcnt lgkmcnt(1)
    v_add_f32 v160, v160, v84
    v_add_f32_e64 v161, v161, v85
    v_mfma_f32_16x16x32_bf16 v[132:135], a[208:211], a[52:55], v[132:135]
    v_add_f32 v170, v170, v94
    v_add_f32 v171, v171, v95
    v_mfma_f32_16x16x32_bf16 v[136:139], a[212:215], a[52:55], v[136:139]
    ds_write_b128 v4, v[108:111] offset:1024
    v_mfma_f32_16x16x32_bf16 v[140:143], a[216:219], a[52:55], v[140:143]
    v_mfma_f32_16x16x32_bf16 v[124:127], a[220:223], a[72:75], v[124:127]
    v_add_f32 v162, v162, v86
    v_add_f32 v163, v163, v87
    v_mfma_f32_16x16x32_bf16 v[128:131], a[224:227], a[72:75], v[128:131]
    v_add_f32 v172, v172, v96
    v_add_f32 v173, v173, v97
    v_mfma_f32_16x16x32_bf16 v[132:135], a[228:231], a[72:75], v[132:135]
    ds_write_b128 v4, v[112:115] offset:2048
    v_mfma_f32_16x16x32_bf16 v[136:139], a[232:235], a[72:75], v[136:139]
    v_mfma_f32_16x16x32_bf16 v[140:143], a[236:239], a[72:75], v[140:143]
    v_add_f32 v164, v164, v88
    v_add_f32 v165, v165, v89
    v_mfma_f32_16x16x32_bf16 v[124:127], a[240:243], a[92:95], v[124:127]
    v_add_f32 v174, v174, v98
    v_add_f32 v175, v175, v99
    v_mfma_f32_16x16x32_bf16 v[128:131], a[244:247], a[92:95], v[128:131]
    ds_write_b128 v4, v[116:119] offset:3072
    v_mfma_f32_16x16x32_bf16 v[132:135], a[248:251], a[92:95], v[132:135]
    v_mfma_f32_16x16x32_bf16 v[136:139], a[252:255], a[92:95], v[136:139]
    v_add_f32 v166, v166, v90
    v_add_f32 v167, v167, v91
    v_mfma_f32_16x16x32_bf16 v[140:143], a[16:19], a[92:95], v[140:143]
    v_add_f32 v176, v176, v100
    v_add_f32 v177, v177, v101
    v_mfma_f32_16x16x32_bf16 v[124:127], a[36:39], a[112:115], v[124:127]
    ds_write_b128 v4, v[120:123] offset:4096
    v_mfma_f32_16x16x32_bf16 v[128:131], a[56:59], a[112:115], v[128:131]
    v_mfma_f32_16x16x32_bf16 v[132:135], a[76:79], a[112:115], v[132:135]
    v_add_f32 v168, v168, v92
    v_add_f32 v169, v169, v93
    v_mfma_f32_16x16x32_bf16 v[136:139], a[96:99], a[112:115], v[136:139]
    v_add_f32 v178, v178, v102
    v_add_f32 v179, v179, v103
    v_mfma_f32_16x16x32_bf16 v[140:143], a[116:119], a[112:115], v[140:143]
    s_waitcnt lgkmcnt(0)
    s_barrier
    v_mfma_f32_16x16x32_bf16 v[64:67], a[160:163], a[0:3], v[64:67]
    ds_read_b128 v[104:107], v48 offset:5120
    ds_read_b128 v[108:111], v48 offset:6144
    v_mfma_f32_16x16x32_bf16 v[68:71], a[164:167], a[0:3], v[68:71]
    ds_read_b128 v[112:115], v48 offset:7168
    ds_read_b128 v[116:119], v48 offset:8192
    v_mfma_f32_16x16x32_bf16 v[72:75], a[168:171], a[0:3], v[72:75]
    ds_read_b128 v[120:123], v48 offset:9216
    v_mfma_f32_16x16x32_bf16 v[76:79], a[172:175], a[0:3], v[76:79]
    ds_write_b128 v5, v[124:127] offset:0
    v_mfma_f32_16x16x32_bf16 v[80:83], a[176:179], a[0:3], v[80:83]
    v_mfma_f32_16x16x32_bf16 v[64:67], a[180:183], a[20:23], v[64:67]
    v_mfma_f32_16x16x32_bf16 v[68:71], a[184:187], a[20:23], v[68:71]
    ds_write_b128 v5, v[128:131] offset:1024
    v_mfma_f32_16x16x32_bf16 v[72:75], a[188:191], a[20:23], v[72:75]
    s_waitcnt lgkmcnt(2)
    v_add_f32 v160, v160, v104
    v_add_f32_e64 v161, v161, v105
    v_mfma_f32_16x16x32_bf16 v[76:79], a[192:195], a[20:23], v[76:79]
    v_add_f32 v168, v168, v112
    v_add_f32 v169, v169, v113
    v_mfma_f32_16x16x32_bf16 v[80:83], a[196:199], a[20:23], v[80:83]
    ds_write_b128 v5, v[132:135] offset:2048
    v_mfma_f32_16x16x32_bf16 v[64:67], a[200:203], a[40:43], v[64:67]
    v_add_f32 v162, v162, v106
    v_add_f32 v163, v163, v107
    v_mfma_f32_16x16x32_bf16 v[68:71], a[204:207], a[40:43], v[68:71]
    v_add_f32 v170, v170, v114
    v_add_f32 v171, v171, v115
    v_mfma_f32_16x16x32_bf16 v[72:75], a[208:211], a[40:43], v[72:75]
    ds_write_b128 v5, v[136:139] offset:3072
    v_mfma_f32_16x16x32_bf16 v[76:79], a[212:215], a[40:43], v[76:79]
    v_add_f32 v164, v164, v108
    v_add_f32 v165, v165, v109
    v_mfma_f32_16x16x32_bf16 v[80:83], a[216:219], a[40:43], v[80:83]
    v_add_f32 v172, v172, v116
    v_add_f32 v173, v173, v117
    v_mfma_f32_16x16x32_bf16 v[64:67], a[220:223], a[60:63], v[64:67]
    ds_write_b128 v5, v[140:143] offset:4096
    v_mfma_f32_16x16x32_bf16 v[68:71], a[224:227], a[60:63], v[68:71]
    v_add_f32 v166, v166, v110
    v_add_f32 v167, v167, v111
    v_mfma_f32_16x16x32_bf16 v[72:75], a[228:231], a[60:63], v[72:75]
    v_add_f32 v174, v174, v118
    v_add_f32 v175, v175, v119
    v_mfma_f32_16x16x32_bf16 v[76:79], a[232:235], a[60:63], v[76:79]
    s_waitcnt vmcnt(0)
    ds_write_b128 v6, v[144:147] offset:0
    v_mfma_f32_16x16x32_bf16 v[80:83], a[236:239], a[60:63], v[80:83]
    v_add_f32 v176, v176, v120
    v_add_f32_e64 v177, v177, v121
    v_mfma_f32_16x16x32_bf16 v[64:67], a[240:243], a[80:83], v[64:67]
    v_add_f32 v178, v178, v122
    v_add_f32 v179, v179, v123
    v_mfma_f32_16x16x32_bf16 v[68:71], a[244:247], a[80:83], v[68:71]
    ds_write_b128 v6, v[148:151] offset:4096
    v_mfma_f32_16x16x32_bf16 v[72:75], a[248:251], a[80:83], v[72:75]
    v_mfma_f32_16x16x32_bf16 v[76:79], a[252:255], a[80:83], v[76:79]
    v_mfma_f32_16x16x32_bf16 v[80:83], a[16:19], a[80:83], v[80:83]
    ds_write_b128 v6, v[152:155] offset:8192
    v_mfma_f32_16x16x32_bf16 v[64:67], a[36:39], a[100:103], v[64:67]
    v_mfma_f32_16x16x32_bf16 v[68:71], a[56:59], a[100:103], v[68:71]
    v_mfma_f32_16x16x32_bf16 v[72:75], a[76:79], a[100:103], v[72:75]
    v_mfma_f32_16x16x32_bf16 v[76:79], a[96:99], a[100:103], v[76:79]
    s_waitcnt lgkmcnt(0)
    s_barrier
    v_mfma_f32_16x16x32_bf16 v[80:83], a[116:119], a[100:103], v[80:83]
    ds_read_b128 v[124:127], v48 offset:10240
    ds_read_b128 v[128:131], v48 offset:11264
    ds_read_b128 v[132:135], v48 offset:12288
    ds_read_b128 v[136:139], v48 offset:13312
    ds_read_b128 v[140:143], v48 offset:14336
    ds_read_b64_tr_b16 v[8:9], v49 offset:0
    ds_read_b64_tr_b16 v[10:11], v49 offset:2048
    ds_read_b64_tr_b16 v[12:13], v49 offset:4096
    ds_read_b64_tr_b16 v[14:15], v49 offset:6144
    ds_read_b64_tr_b16 v[16:17], v49 offset:8192
    s_mov_b32 s6, 0xbfb8aa3b
    s_mov_b32 s7, 0xbfb8aa3b
    v_pk_add_f32 v[64:65], v[64:65], v[160:161]
    v_pk_add_f32 v[66:67], v[66:67], v[162:163]
    v_pk_add_f32 v[68:69], v[68:69], v[164:165]
    v_pk_add_f32 v[70:71], v[70:71], v[166:167]
    v_pk_add_f32 v[72:73], v[72:73], v[168:169]
    v_pk_add_f32 v[74:75], v[74:75], v[170:171]
    v_pk_add_f32 v[76:77], v[76:77], v[172:173]
    v_pk_add_f32 v[78:79], v[78:79], v[174:175]
    v_pk_add_f32 v[80:81], v[80:81], v[176:177]
    v_pk_add_f32 v[82:83], v[82:83], v[178:179]
    s_waitcnt lgkmcnt(5)
    s_nop 0
    v_pk_add_f32 v[64:65], v[64:65], v[124:125]
    v_pk_add_f32 v[66:67], v[66:67], v[126:127]
    v_pk_add_f32 v[68:69], v[68:69], v[128:129]
    v_pk_add_f32 v[70:71], v[70:71], v[130:131]
    v_pk_add_f32 v[72:73], v[72:73], v[132:133]
    v_pk_add_f32 v[74:75], v[74:75], v[134:135]
    v_pk_add_f32 v[76:77], v[76:77], v[136:137]
    v_pk_add_f32 v[78:79], v[78:79], v[138:139]
    v_pk_add_f32 v[80:81], v[80:81], v[140:141]
    v_pk_add_f32 v[82:83], v[82:83], v[142:143]
    s_waitcnt lgkmcnt(0)
    v_lshlrev_b32 v84, 16, v8
    v_and_b32 v85, 0xffff0000, v8
    v_pk_add_f32 v[20:21], v[20:21], v[84:85]
    v_lshlrev_b32_e64 v84, 16, v9
    v_and_b32 v85, 0xffff0000, v9
    v_pk_add_f32 v[22:23], v[22:23], v[84:85]
    v_lshlrev_b32_e64 v84, 16, v10
    v_and_b32 v85, 0xffff0000, v10
    v_pk_add_f32 v[24:25], v[24:25], v[84:85]
    v_lshlrev_b32_e64 v84, 16, v11
    v_and_b32 v85, 0xffff0000, v11
    v_pk_add_f32 v[26:27], v[26:27], v[84:85]
    v_lshlrev_b32_e64 v84, 16, v12
    v_and_b32 v85, 0xffff0000, v12
    v_pk_add_f32 v[28:29], v[28:29], v[84:85]
    v_lshlrev_b32_e64 v84, 16, v13
    v_and_b32 v85, 0xffff0000, v13
    v_pk_add_f32 v[30:31], v[30:31], v[84:85]
    v_lshlrev_b32_e64 v84, 16, v14
    v_and_b32 v85, 0xffff0000, v14
    v_pk_add_f32 v[32:33], v[32:33], v[84:85]
    v_lshlrev_b32_e64 v84, 16, v15
    v_and_b32 v85, 0xffff0000, v15
    v_pk_add_f32 v[34:35], v[34:35], v[84:85]
    v_lshlrev_b32_e64 v84, 16, v16
    v_and_b32 v85, 0xffff0000, v16
    v_pk_add_f32 v[36:37], v[36:37], v[84:85]
    v_lshlrev_b32_e64 v84, 16, v17
    v_and_b32 v85, 0xffff0000, v17
    v_pk_add_f32 v[40:41], v[40:41], v[84:85]
    v_pk_mul_f32 v[84:85], v[64:65], s[6:7]
    v_pk_mul_f32 v[86:87], v[66:67], s[6:7]
    v_pk_mul_f32 v[88:89], v[68:69], s[6:7]
    v_pk_mul_f32 v[90:91], v[70:71], s[6:7]
    v_pk_mul_f32 v[92:93], v[72:73], s[6:7]
    v_pk_mul_f32 v[94:95], v[74:75], s[6:7]
    v_pk_mul_f32 v[96:97], v[76:77], s[6:7]
    v_pk_mul_f32 v[98:99], v[78:79], s[6:7]
    v_pk_mul_f32 v[100:101], v[80:81], s[6:7]
    v_pk_mul_f32 v[102:103], v[82:83], s[6:7]
    v_exp_f32 v84, v84
    v_exp_f32 v85, v85
    v_exp_f32 v86, v86
    v_exp_f32 v87, v87
    v_exp_f32 v88, v88
    v_exp_f32 v89, v89
    v_exp_f32 v90, v90
    v_exp_f32 v91, v91
    v_exp_f32 v92, v92
    v_exp_f32 v93, v93
    v_exp_f32 v94, v94
    v_exp_f32 v95, v95
    v_exp_f32 v96, v96
    v_exp_f32 v97, v97
    v_exp_f32 v98, v98
    v_exp_f32 v99, v99
    v_exp_f32 v100, v100
    v_exp_f32 v101, v101
    v_exp_f32 v102, v102
    v_exp_f32 v103, v103
    v_pk_add_f32 v[84:85], v[84:85], 1.0 op_sel_hi:[1,0]
    v_pk_add_f32 v[86:87], v[86:87], 1.0 op_sel_hi:[1,0]
    v_pk_add_f32 v[88:89], v[88:89], 1.0 op_sel_hi:[1,0]
    v_pk_add_f32 v[90:91], v[90:91], 1.0 op_sel_hi:[1,0]
    v_pk_add_f32 v[92:93], v[92:93], 1.0 op_sel_hi:[1,0]
    v_pk_add_f32 v[94:95], v[94:95], 1.0 op_sel_hi:[1,0]
    v_pk_add_f32 v[96:97], v[96:97], 1.0 op_sel_hi:[1,0]
    v_pk_add_f32 v[98:99], v[98:99], 1.0 op_sel_hi:[1,0]
    v_pk_add_f32 v[100:101], v[100:101], 1.0 op_sel_hi:[1,0]
    v_pk_add_f32 v[102:103], v[102:103], 1.0 op_sel_hi:[1,0]
    v_rcp_f32 v84, v84
    v_rcp_f32 v85, v85
    v_rcp_f32 v86, v86
    v_rcp_f32 v87, v87
    v_rcp_f32 v88, v88
    v_rcp_f32 v89, v89
    v_rcp_f32 v90, v90
    v_rcp_f32 v91, v91
    v_rcp_f32 v92, v92
    v_rcp_f32 v93, v93
    v_rcp_f32 v94, v94
    v_rcp_f32 v95, v95
    v_rcp_f32 v96, v96
    v_rcp_f32 v97, v97
    v_rcp_f32 v98, v98
    v_rcp_f32 v99, v99
    v_rcp_f32 v100, v100
    v_rcp_f32 v101, v101
    v_rcp_f32 v102, v102
    v_rcp_f32 v103, v103
    v_pk_mul_f32 v[20:21], v[20:21], v[64:65]
    v_pk_mul_f32 v[22:23], v[22:23], v[66:67]
    v_pk_mul_f32 v[24:25], v[24:25], v[68:69]
    v_pk_mul_f32 v[26:27], v[26:27], v[70:71]
    v_pk_mul_f32 v[28:29], v[28:29], v[72:73]
    v_pk_mul_f32 v[30:31], v[30:31], v[74:75]
    v_pk_mul_f32 v[32:33], v[32:33], v[76:77]
    v_pk_mul_f32 v[34:35], v[34:35], v[78:79]
    v_pk_mul_f32 v[36:37], v[36:37], v[80:81]
    v_pk_mul_f32 v[40:41], v[40:41], v[82:83]
    v_pk_fma_f32 v[20:21], v[20:21], v[84:85], v[204:205]
    v_cvt_pk_bf16_f32 v8, v20, v21
    v_pk_fma_f32 v[22:23], v[22:23], v[86:87], v[206:207]
    v_cvt_pk_bf16_f32 v9, v22, v23
    v_pk_fma_f32 v[24:25], v[24:25], v[88:89], v[208:209]
    v_cvt_pk_bf16_f32 v10, v24, v25
    v_pk_fma_f32 v[26:27], v[26:27], v[90:91], v[210:211]
    v_cvt_pk_bf16_f32 v11, v26, v27
    v_pk_fma_f32 v[28:29], v[28:29], v[92:93], v[212:213]
    v_cvt_pk_bf16_f32 v12, v28, v29
    v_pk_fma_f32 v[30:31], v[30:31], v[94:95], v[214:215]
    v_cvt_pk_bf16_f32 v13, v30, v31
    v_pk_fma_f32 v[32:33], v[32:33], v[96:97], v[216:217]
    v_cvt_pk_bf16_f32 v14, v32, v33
    v_pk_fma_f32 v[34:35], v[34:35], v[98:99], v[218:219]
    v_cvt_pk_bf16_f32 v15, v34, v35
    v_pk_fma_f32 v[36:37], v[36:37], v[100:101], v[220:221]
    v_cvt_pk_bf16_f32 v16, v36, v37
    v_pk_fma_f32 v[40:41], v[40:41], v[102:103], v[222:223]
    v_cvt_pk_bf16_f32 v17, v40, v41
    ds_write_b64 v54, v[8:9] offset:0
    ds_write_b64 v54, v[10:11] offset:32
    ds_write_b64 v54, v[12:13] offset:64
    ds_write_b64 v54, v[14:15] offset:96
    ds_write_b64 v54, v[16:17] offset:128
    ds_read_b128 v[84:87], v53 offset:0
    ds_read_b128 v[88:91], v53 offset:1024
    ds_read_b128 v[92:95], v53 offset:2048
    s_mov_b32 s20, s60
    s_mov_b32 s21, s61
    s_mov_b32 s22, 2621440
    s_mov_b32 s23, 0x00020000
    s_waitcnt lgkmcnt(2)
    buffer_store_dwordx4 v[84:87], v50, s[20:23], s35 offen
    s_waitcnt lgkmcnt(1)
    buffer_store_dwordx4 v[88:91], v51, s[20:23], s35 offen
    s_waitcnt lgkmcnt(0)
    buffer_store_dwordx4 v[92:95], v52, s[20:23], s35 offen
    s_endpgm
L_narrow_27:
    s_mov_b32 s22, 163840
    s_mov_b32 s20, s38
    s_mov_b32 s21, s39
    buffer_load_dword v248, v251, s[20:23], 0 offen
    s_mov_b32 s20, s40
    s_mov_b32 s21, s41
    buffer_load_dword v249, v251, s[20:23], 0 offen
    s_mov_b32 s20, s42
    s_mov_b32 s21, s43
    buffer_load_dword v250, v251, s[20:23], 0 offen
    s_mov_b32 s20, s44
    s_mov_b32 s21, s45
    buffer_load_dword v251, v251, s[20:23], 0 offen
    s_mov_b32 s20, s46
    s_mov_b32 s21, s47
    s_mov_b32 s22, 1280
    s_lshl_b32 s4, s72, 1
    buffer_load_ushort v1, off, s[20:23], s4
    s_mul_i32 s5, s75, 20
    s_add_u32 s5, s5, 2048
    v_add_u32_e64 v2, s5, v0
    s_lshr_b32 s5, s74, 1
    s_lshl_b32 s5, s5, 4
    s_add_u32 s5, s5, 2284
    v_add_u32 v3, s5, v0
    v_cmp_le_u32 vcc, 20, v0
    s_add_u32 s5, s34, 2048
    s_add_u32 s30, s30, 2304
    v_cndmask_b32_e64 v2, v2, v3, vcc
    v_writelane_b32 v2, s30, 36
    v_writelane_b32 v2, s5, 37
    v_lshlrev_b32_e64 v254, 4, v2
    s_mov_b32 s4, 14876672
    s_mov_b32 exec_hi, 0x3f
    buffer_load_dword v255, v254, s[12:15], s4 offen sc1
    s_mov_b64 exec, -1
    s_and_b32 s4, s3, 1
    s_lshl_b32 s4, s4, 6
    v_add_u32_e64 v2, s4, v0
    s_and_b32 s4, s25, -2
    s_lshl_b32 s4, s4, 6
    v_lshl_add_u32 v229, v2, 1, s4
    v_lshlrev_b32_e64 v2, 2, v2
    v_add_u32 v228, 133632, v2
    s_mov_b32 s20, s54
    s_mov_b32 s21, s55
    s_mov_b32 s22, 3456
    s_mov_b32 s23, 0x00020000
    buffer_load_ushort v229, v229, s[20:23], 0 offen
    s_and_b32 s4, s2, 7
    s_mul_i32 s5, s4, 80
    s_sub_u32 s5, s72, s5
    s_lshl_b32 s6, s5, 6
    v_add_u32 v57, s6, v0
    v_lshlrev_b32 v57, 7, v57
    s_lshr_b32 s6, s4, 1
    s_mul_i32 s100, s6, 655360
    s_and_b32 s4, s4, 1
    s_mul_i32 s4, s4, 1664
    s_mul_i32 s5, s5, 27648
    s_add_u32 s99, s5, s4
    v_lshrrev_b32_e64 v2, 4, v0
    v_mul_u32_u24 v2, 3456, v2
    v_and_b32 v3, 15, v0
    v_min_u32 v3, 13, v3
    v_lshl_add_u32 v58, v3, 7, v2
    s_add_u32 s98, s99, 13824
    buffer_load_dword a243, v58, s[16:19], s99 offen
    buffer_load_dword a242, v57, s[8:11], s100 offen
    buffer_load_dword a243, v58, s[16:19], s98 offen
    v_lshrrev_b32 v2, 3, v0
    v_and_b32 v3, 7, v0
    v_lshrrev_b32 v4, 1, v2
    v_xor_b32 v3, v3, v4
    v_mul_u32_u24 v2, 1280, v2
    v_lshl_add_u32 v216, v3, 4, v2
    v_xor_b32_e64 v3, 4, v3
    v_lshl_add_u32 v217, v3, 4, v2
    v_add_u32 v217, 9216, v217
    v_add_u32 v218, 18432, v216
    v_add_u32 v219, 18432, v217
    v_lshrrev_b32 v2, 4, v0
    v_and_b32 v3, 15, v0
    v_lshlrev_b32 v4, 2, v2
    v_xor_b32 v3, v3, v4
    v_mul_u32_u24 v2, 3456, v2
    v_lshl_add_u32 v220, v3, 4, v2
    v_add_u32 v221, 12800, v220
    v_add_u32 v222, 25600, v220
    v_add_u32 v223, 38400, v220
    s_lshl_b32 s4, s3, 5
    s_add_u32 s4, s4, s24
    s_mul_i32 s27, s4, 1280
    s_and_b32 s4, s25, -2
    s_lshl_b32 s4, s4, 6
    s_mul_i32 s5, s3, 55296
    s_add_u32 s28, s4, s5
    s_lshl_b32 s29, s3, 12
    v_and_b32 v2, 31, v0
    v_lshlrev_b32 v3, 7, v2
    v_bfe_u32 v4, v0, 1, 3
    v_lshrrev_b32 v5, 5, v0
    v_xor_b32 v4, v4, v5
    v_lshl_add_u32 v3, v4, 4, v3
    v_add_u32_e64 v244, s29, v3
    v_add_u32 v244, 2048, v244
    v_xor_b32 v245, 32, v244
    v_xor_b32 v246, 64, v244
    v_xor_b32 v247, 96, v244
    v_bfe_u32 v2, v0, 2, 2
    v_lshl_add_u32 v3, v5, 3, v2
    v_lshlrev_b32_e64 v3, 8, v3
    v_bfe_u32 v4, v0, 4, 1
    v_lshl_add_u32 v3, v4, 5, v3
    v_and_b32_e64 v4, 3, v0
    v_lshl_add_u32 v3, v4, 3, v3
    v_add_u32 v3, 18432, v3
    s_add_u32 s4, s26, 3
    s_add_u32 s5, s3, 0
    s_sub_u32 s6, s5, s4
    s_cmp_ge_u32 s5, s4
    s_cselect_b32 s5, s6, s5
    s_sub_u32 s6, s5, s4
    s_cmp_ge_u32 s5, s4
    s_cselect_b32 s5, s6, s5
    s_add_u32 s66, s5, s32
    v_xor_b32 v4, s66, v2
    v_lshl_add_u32 v240, v4, 6, v3
    s_add_u32 s5, s3, 1
    s_sub_u32 s6, s5, s4
    s_cmp_ge_u32 s5, s4
    s_cselect_b32 s5, s6, s5
    s_sub_u32 s6, s5, s4
    s_cmp_ge_u32 s5, s4
    s_cselect_b32 s5, s6, s5
    s_add_u32 s67, s5, s32
    v_xor_b32_e64 v4, s67, v2
    v_lshl_add_u32 v241, v4, 6, v3
    s_add_u32 s5, s3, 2
    s_sub_u32 s6, s5, s4
    s_cmp_ge_u32 s5, s4
    s_cselect_b32 s5, s6, s5
    s_sub_u32 s6, s5, s4
    s_cmp_ge_u32 s5, s4
    s_cselect_b32 s5, s6, s5
    s_add_u32 s68, s5, s32
    v_xor_b32_e64 v4, s68, v2
    v_lshl_add_u32 v242, v4, 6, v3
    s_add_u32 s5, s3, 3
    s_sub_u32 s6, s5, s4
    s_cmp_ge_u32 s5, s4
    s_cselect_b32 s5, s6, s5
    s_sub_u32 s6, s5, s4
    s_cmp_ge_u32 s5, s4
    s_cselect_b32 s5, s6, s5
    s_add_u32 s69, s5, s32
    v_xor_b32_e64 v4, s69, v2
    v_lshl_add_u32 v243, v4, 6, v3
    v_add_u32 v208, 65536, v240
    v_add_u32 v209, 65536, v241
    v_add_u32 v210, 65536, v242
    v_add_u32 v211, 65536, v243
    v_add_u32 v212, 65536, v244
    v_add_u32 v213, 65536, v245
    v_add_u32 v214, 65536, v246
    v_add_u32 v215, 65536, v247
    v_lshrrev_b32 v4, 4, v0
    v_xor_b32 v4, v4, v0
    v_and_b32 v4, 1, v4
    v_subrev_u32 v4, 1, v4
    v_and_b32 v236, 0x3f803f80, v4
    v_and_b32 v237, 0x3f803f80, v4
    v_and_b32 v238, 0x3f803f80, v4
    v_and_b32 v239, 0x3f803f80, v4
    v_lshlrev_b32_e64 v60, 4, v5
    v_bfe_u32 v4, v0, 4, 1
    v_mul_u32_u24 v4, 55296, v4
    v_lshl_add_u32 v4, v5, 8, v4
    v_and_b32_e64 v5, 15, v0
    v_lshl_add_u32 v59, v5, 4, v4
    v_and_b32 v4, 1, v0
    v_lshlrev_b32 v37, 7, v4
    s_waitcnt vmcnt(5)
    v_lshlrev_b32 v1, 16, v1
    v_mul_f32 v1, 0x3fb8aa3b, v1
    v_exp_f32 v1, v1
    s_nop 0
    v_cvt_pk_bf16_f32 v1, v1, v1
    v_and_b32 v1, 0xffff0000, v1
    s_mul_i32 s97, s3, 8704
    s_mov_b32 m0, s97
    v_and_b32 v2, 31, v0
    v_mul_u32_u24 v2, 272, v2
    v_lshrrev_b32_e64 v3, 5, v0
    v_lshl_add_u32 v2, v3, 4, v2
    v_add_u32 v26, s97, v2
    v_add_f32 v25, v1, v1
    v_lshlrev_b32 v2, 16, v248
    v_lshlrev_b32 v3, 16, v249
    v_lshlrev_b32 v158, 16, v250
    v_lshlrev_b32 v159, 16, v251
    v_mul_f32 v2, 0x3fb8aa3b, v2
    v_exp_f32 v2, v2
    v_mul_f32 v5, v3, v1
    v_cvt_pk_bf16_f32 v2, v2, v2
    v_and_b32 v2, 0xffff0000, v2
    v_mul_f32_e64 v4, v2, v1
    v_mul_f32 v4, 0xbfb8aa3b, v4
    v_mul_f32 v5, 0x3e22f983, v5
    v_mul_f32 v158, v158, v25
    v_mul_f32 v159, v159, -v25
    v_exp_f32 v2, v4
    v_fract_f32 v3, v5
    v_cos_f32 v144, v3
    v_sin_f32_e64 v145, v3
    s_nop 0
    v_pk_mul_f32 v[144:145], v[144:145], v[2:3] op_sel_hi:[1,0]
    v_mul_f32 v2, 0x41000000, v4
    v_mul_f32 v3, 0x41000000, v5
    v_exp_f32 v2, v2
    v_fract_f32 v3, v3
    v_cos_f32 v150, v3
    v_sin_f32_e64 v151, v3
    s_nop 0
    v_pk_mul_f32 v[150:151], v[150:151], v[2:3] op_sel_hi:[1,0]
    v_mul_f32 v2, 0x43800000, v4
    v_mul_f32 v3, 0x43800000, v5
    v_exp_f32 v2, v2
    v_fract_f32 v3, v3
    v_cos_f32 v152, v3
    v_sin_f32_e64 v153, v3
    s_nop 0
    v_pk_mul_f32 v[152:153], v[152:153], v[2:3] op_sel_hi:[1,0]
    v_pk_mul_f32 v[166:167], v[144:145], v[144:145] op_sel:[0,0] op_sel_hi:[0,1]
    v_pk_fma_f32 v[146:147], v[144:145], v[144:145], v[166:167] op_sel:[1,1,0] op_sel_hi:[1,0,1] neg_lo:[0,1,0]
    v_pk_mul_f32 v[168:169], v[152:153], v[152:153] op_sel:[0,0] op_sel_hi:[0,1]
    v_pk_fma_f32 v[154:155], v[152:153], v[152:153], v[168:169] op_sel:[1,1,0] op_sel_hi:[1,0,1] neg_lo:[0,1,0]
    v_pk_mul_f32 v[166:167], v[146:147], v[146:147] op_sel:[0,0] op_sel_hi:[0,1]
    v_pk_fma_f32 v[148:149], v[146:147], v[146:147], v[166:167] op_sel:[1,1,0] op_sel_hi:[1,0,1] neg_lo:[0,1,0]
    v_pk_mul_f32 v[168:169], v[154:155], v[154:155] op_sel:[0,0] op_sel_hi:[0,1]
    v_pk_fma_f32 v[156:157], v[154:155], v[154:155], v[168:169] op_sel:[1,1,0] op_sel_hi:[1,0,1] neg_lo:[0,1,0]
    v_mov_b32 v128, 0x3f80
    v_cvt_pk_bf16_f32 v129, v150, v151
    v_pk_mul_f32 v[168:169], v[150:151], v[150:151] op_sel:[0,0] op_sel_hi:[0,1]
    v_pk_fma_f32 v[164:165], v[150:151], v[150:151], v[168:169] op_sel:[1,1,0] op_sel_hi:[1,0,1] neg_lo:[0,1,0]
    v_cvt_pk_bf16_f32 v130, v164, v165
    v_pk_mul_f32 v[168:169], v[164:165], v[150:151] op_sel:[0,0] op_sel_hi:[0,1]
    v_pk_fma_f32 v[164:165], v[164:165], v[150:151], v[168:169] op_sel:[1,1,0] op_sel_hi:[1,0,1] neg_lo:[0,1,0]
    v_cvt_pk_bf16_f32 v131, v164, v165
    v_pk_mul_f32 v[168:169], v[164:165], v[150:151] op_sel:[0,0] op_sel_hi:[0,1]
    v_pk_fma_f32 v[164:165], v[164:165], v[150:151], v[168:169] op_sel:[1,1,0] op_sel_hi:[1,0,1] neg_lo:[0,1,0]
    v_cvt_pk_bf16_f32 v132, v164, v165
    v_pk_mul_f32 v[168:169], v[164:165], v[150:151] op_sel:[0,0] op_sel_hi:[0,1]
    v_pk_fma_f32 v[164:165], v[164:165], v[150:151], v[168:169] op_sel:[1,1,0] op_sel_hi:[1,0,1] neg_lo:[0,1,0]
    v_cvt_pk_bf16_f32 v133, v164, v165
    v_pk_mul_f32 v[168:169], v[164:165], v[150:151] op_sel:[0,0] op_sel_hi:[0,1]
    v_pk_fma_f32 v[164:165], v[164:165], v[150:151], v[168:169] op_sel:[1,1,0] op_sel_hi:[1,0,1] neg_lo:[0,1,0]
    v_cvt_pk_bf16_f32 v134, v164, v165
    v_pk_mul_f32 v[168:169], v[164:165], v[150:151] op_sel:[0,0] op_sel_hi:[0,1]
    v_pk_fma_f32 v[164:165], v[164:165], v[150:151], v[168:169] op_sel:[1,1,0] op_sel_hi:[1,0,1] neg_lo:[0,1,0]
    v_cvt_pk_bf16_f32 v135, v164, v165
    ds_write_addtid_b32 v128 offset:0
    ds_write_addtid_b32 v129 offset:272
    ds_write_addtid_b32 v130 offset:544
    ds_write_addtid_b32 v131 offset:816
    ds_write_addtid_b32 v132 offset:1088
    ds_write_addtid_b32 v133 offset:1360
    ds_write_addtid_b32 v134 offset:1632
    ds_write_addtid_b32 v135 offset:1904
    v_pk_mul_f32 v[168:169], v[164:165], v[150:151] op_sel:[0,0] op_sel_hi:[0,1]
    v_pk_fma_f32 v[164:165], v[164:165], v[150:151], v[168:169] op_sel:[1,1,0] op_sel_hi:[1,0,1] neg_lo:[0,1,0]
    v_cvt_pk_bf16_f32 v136, v164, v165
    v_pk_mul_f32 v[168:169], v[164:165], v[150:151] op_sel:[0,0] op_sel_hi:[0,1]
    v_pk_fma_f32 v[164:165], v[164:165], v[150:151], v[168:169] op_sel:[1,1,0] op_sel_hi:[1,0,1] neg_lo:[0,1,0]
    v_cvt_pk_bf16_f32 v137, v164, v165
    v_pk_mul_f32 v[168:169], v[164:165], v[150:151] op_sel:[0,0] op_sel_hi:[0,1]
    v_pk_fma_f32 v[164:165], v[164:165], v[150:151], v[168:169] op_sel:[1,1,0] op_sel_hi:[1,0,1] neg_lo:[0,1,0]
    v_cvt_pk_bf16_f32 v138, v164, v165
    v_pk_mul_f32 v[168:169], v[164:165], v[150:151] op_sel:[0,0] op_sel_hi:[0,1]
    v_pk_fma_f32 v[164:165], v[164:165], v[150:151], v[168:169] op_sel:[1,1,0] op_sel_hi:[1,0,1] neg_lo:[0,1,0]
    v_cvt_pk_bf16_f32 v139, v164, v165
    v_pk_mul_f32 v[168:169], v[164:165], v[150:151] op_sel:[0,0] op_sel_hi:[0,1]
    v_pk_fma_f32 v[164:165], v[164:165], v[150:151], v[168:169] op_sel:[1,1,0] op_sel_hi:[1,0,1] neg_lo:[0,1,0]
    v_cvt_pk_bf16_f32 v140, v164, v165
    v_pk_mul_f32 v[168:169], v[164:165], v[150:151] op_sel:[0,0] op_sel_hi:[0,1]
    v_pk_fma_f32 v[164:165], v[164:165], v[150:151], v[168:169] op_sel:[1,1,0] op_sel_hi:[1,0,1] neg_lo:[0,1,0]
    v_cvt_pk_bf16_f32 v141, v164, v165
    v_pk_mul_f32 v[168:169], v[164:165], v[150:151] op_sel:[0,0] op_sel_hi:[0,1]
    v_pk_fma_f32 v[164:165], v[164:165], v[150:151], v[168:169] op_sel:[1,1,0] op_sel_hi:[1,0,1] neg_lo:[0,1,0]
    v_cvt_pk_bf16_f32 v142, v164, v165
    v_pk_mul_f32 v[168:169], v[164:165], v[150:151] op_sel:[0,0] op_sel_hi:[0,1]
    v_pk_fma_f32 v[164:165], v[164:165], v[150:151], v[168:169] op_sel:[1,1,0] op_sel_hi:[1,0,1] neg_lo:[0,1,0]
    v_cvt_pk_bf16_f32 v143, v164, v165
    ds_write_addtid_b32 v136 offset:2176
    ds_write_addtid_b32 v137 offset:2448
    ds_write_addtid_b32 v138 offset:2720
    ds_write_addtid_b32 v139 offset:2992
    ds_write_addtid_b32 v140 offset:3264
    ds_write_addtid_b32 v141 offset:3536
    ds_write_addtid_b32 v142 offset:3808
    ds_write_addtid_b32 v143 offset:4080
    v_pk_mul_f32 v[168:169], v[164:165], v[150:151] op_sel:[0,0] op_sel_hi:[0,1]
    v_pk_fma_f32 v[164:165], v[164:165], v[150:151], v[168:169] op_sel:[1,1,0] op_sel_hi:[1,0,1] neg_lo:[0,1,0]
    v_cvt_pk_bf16_f32 v128, v164, v165
    v_pk_mul_f32 v[168:169], v[164:165], v[150:151] op_sel:[0,0] op_sel_hi:[0,1]
    v_pk_fma_f32 v[164:165], v[164:165], v[150:151], v[168:169] op_sel:[1,1,0] op_sel_hi:[1,0,1] neg_lo:[0,1,0]
    v_cvt_pk_bf16_f32 v129, v164, v165
    v_pk_mul_f32 v[168:169], v[164:165], v[150:151] op_sel:[0,0] op_sel_hi:[0,1]
    v_pk_fma_f32 v[164:165], v[164:165], v[150:151], v[168:169] op_sel:[1,1,0] op_sel_hi:[1,0,1] neg_lo:[0,1,0]
    v_cvt_pk_bf16_f32 v130, v164, v165
    v_pk_mul_f32 v[168:169], v[164:165], v[150:151] op_sel:[0,0] op_sel_hi:[0,1]
    v_pk_fma_f32 v[164:165], v[164:165], v[150:151], v[168:169] op_sel:[1,1,0] op_sel_hi:[1,0,1] neg_lo:[0,1,0]
    v_cvt_pk_bf16_f32 v131, v164, v165
    v_pk_mul_f32 v[168:169], v[164:165], v[150:151] op_sel:[0,0] op_sel_hi:[0,1]
    v_pk_fma_f32 v[164:165], v[164:165], v[150:151], v[168:169] op_sel:[1,1,0] op_sel_hi:[1,0,1] neg_lo:[0,1,0]
    v_cvt_pk_bf16_f32 v132, v164, v165
    v_pk_mul_f32 v[168:169], v[164:165], v[150:151] op_sel:[0,0] op_sel_hi:[0,1]
    v_pk_fma_f32 v[164:165], v[164:165], v[150:151], v[168:169] op_sel:[1,1,0] op_sel_hi:[1,0,1] neg_lo:[0,1,0]
    v_cvt_pk_bf16_f32 v133, v164, v165
    v_pk_mul_f32 v[168:169], v[164:165], v[150:151] op_sel:[0,0] op_sel_hi:[0,1]
    v_pk_fma_f32 v[164:165], v[164:165], v[150:151], v[168:169] op_sel:[1,1,0] op_sel_hi:[1,0,1] neg_lo:[0,1,0]
    v_cvt_pk_bf16_f32 v134, v164, v165
    v_pk_mul_f32 v[168:169], v[164:165], v[150:151] op_sel:[0,0] op_sel_hi:[0,1]
    v_pk_fma_f32 v[164:165], v[164:165], v[150:151], v[168:169] op_sel:[1,1,0] op_sel_hi:[1,0,1] neg_lo:[0,1,0]
    v_cvt_pk_bf16_f32 v135, v164, v165
    ds_write_addtid_b32 v128 offset:4352
    ds_write_addtid_b32 v129 offset:4624
    ds_write_addtid_b32 v130 offset:4896
    ds_write_addtid_b32 v131 offset:5168
    ds_write_addtid_b32 v132 offset:5440
    ds_write_addtid_b32 v133 offset:5712
    ds_write_addtid_b32 v134 offset:5984
    ds_write_addtid_b32 v135 offset:6256
    v_pk_mul_f32 v[168:169], v[164:165], v[150:151] op_sel:[0,0] op_sel_hi:[0,1]
    v_pk_fma_f32 v[164:165], v[164:165], v[150:151], v[168:169] op_sel:[1,1,0] op_sel_hi:[1,0,1] neg_lo:[0,1,0]
    v_cvt_pk_bf16_f32 v136, v164, v165
    v_pk_mul_f32 v[168:169], v[164:165], v[150:151] op_sel:[0,0] op_sel_hi:[0,1]
    v_pk_fma_f32 v[164:165], v[164:165], v[150:151], v[168:169] op_sel:[1,1,0] op_sel_hi:[1,0,1] neg_lo:[0,1,0]
    v_cvt_pk_bf16_f32 v137, v164, v165
    v_pk_mul_f32 v[168:169], v[164:165], v[150:151] op_sel:[0,0] op_sel_hi:[0,1]
    v_pk_fma_f32 v[164:165], v[164:165], v[150:151], v[168:169] op_sel:[1,1,0] op_sel_hi:[1,0,1] neg_lo:[0,1,0]
    v_cvt_pk_bf16_f32 v138, v164, v165
    v_pk_mul_f32 v[168:169], v[164:165], v[150:151] op_sel:[0,0] op_sel_hi:[0,1]
    v_pk_fma_f32 v[164:165], v[164:165], v[150:151], v[168:169] op_sel:[1,1,0] op_sel_hi:[1,0,1] neg_lo:[0,1,0]
    v_cvt_pk_bf16_f32 v139, v164, v165
    v_pk_mul_f32 v[168:169], v[164:165], v[150:151] op_sel:[0,0] op_sel_hi:[0,1]
    v_pk_fma_f32 v[164:165], v[164:165], v[150:151], v[168:169] op_sel:[1,1,0] op_sel_hi:[1,0,1] neg_lo:[0,1,0]
    v_cvt_pk_bf16_f32 v140, v164, v165
    v_pk_mul_f32 v[168:169], v[164:165], v[150:151] op_sel:[0,0] op_sel_hi:[0,1]
    v_pk_fma_f32 v[164:165], v[164:165], v[150:151], v[168:169] op_sel:[1,1,0] op_sel_hi:[1,0,1] neg_lo:[0,1,0]
    v_cvt_pk_bf16_f32 v141, v164, v165
    v_pk_mul_f32 v[168:169], v[164:165], v[150:151] op_sel:[0,0] op_sel_hi:[0,1]
    v_pk_fma_f32 v[164:165], v[164:165], v[150:151], v[168:169] op_sel:[1,1,0] op_sel_hi:[1,0,1] neg_lo:[0,1,0]
    v_cvt_pk_bf16_f32 v142, v164, v165
    v_pk_mul_f32 v[168:169], v[164:165], v[150:151] op_sel:[0,0] op_sel_hi:[0,1]
    v_pk_fma_f32 v[164:165], v[164:165], v[150:151], v[168:169] op_sel:[1,1,0] op_sel_hi:[1,0,1] neg_lo:[0,1,0]
    v_cvt_pk_bf16_f32 v143, v164, v165
    ds_write_addtid_b32 v136 offset:6528
    ds_write_addtid_b32 v137 offset:6800
    ds_write_addtid_b32 v138 offset:7072
    ds_write_addtid_b32 v139 offset:7344
    ds_write_addtid_b32 v140 offset:7616
    ds_write_addtid_b32 v141 offset:7888
    ds_write_addtid_b32 v142 offset:8160
    ds_write_addtid_b32 v143 offset:8432
    ds_read_b128 v[68:71], v26 offset:0
    ds_read_b128 v[76:79], v26 offset:32
    ds_read_b128 v[84:87], v26 offset:64
    ds_read_b128 v[92:95], v26 offset:96
    ds_read_b128 v[100:103], v26 offset:128
    ds_read_b128 v[108:111], v26 offset:160
    ds_read_b128 v[116:119], v26 offset:192
    ds_read_b128 v[124:127], v26 offset:224
    v_cvt_pk_bf16_f32 v128, v158, v159
    v_pk_mul_f32 v[166:167], v[158:159], v[144:145] op_sel:[0,0] op_sel_hi:[0,1] neg_hi:[0,1]
    v_pk_fma_f32 v[160:161], v[158:159], v[144:145], v[166:167] op_sel:[1,1,0] op_sel_hi:[1,0,1]
    v_cvt_pk_bf16_f32 v129, v160, v161
    v_pk_mul_f32 v[166:167], v[160:161], v[144:145] op_sel:[0,0] op_sel_hi:[0,1] neg_hi:[0,1]
    v_pk_fma_f32 v[160:161], v[160:161], v[144:145], v[166:167] op_sel:[1,1,0] op_sel_hi:[1,0,1]
    v_cvt_pk_bf16_f32 v130, v160, v161
    v_pk_mul_f32 v[166:167], v[160:161], v[144:145] op_sel:[0,0] op_sel_hi:[0,1] neg_hi:[0,1]
    v_pk_fma_f32 v[160:161], v[160:161], v[144:145], v[166:167] op_sel:[1,1,0] op_sel_hi:[1,0,1]
    v_cvt_pk_bf16_f32 v131, v160, v161
    v_pk_mul_f32 v[166:167], v[160:161], v[144:145] op_sel:[0,0] op_sel_hi:[0,1] neg_hi:[0,1]
    v_pk_fma_f32 v[160:161], v[160:161], v[144:145], v[166:167] op_sel:[1,1,0] op_sel_hi:[1,0,1]
    v_cvt_pk_bf16_f32 v132, v160, v161
    v_pk_mul_f32 v[166:167], v[160:161], v[144:145] op_sel:[0,0] op_sel_hi:[0,1] neg_hi:[0,1]
    v_pk_fma_f32 v[160:161], v[160:161], v[144:145], v[166:167] op_sel:[1,1,0] op_sel_hi:[1,0,1]
    v_cvt_pk_bf16_f32 v133, v160, v161
    v_pk_mul_f32 v[166:167], v[160:161], v[144:145] op_sel:[0,0] op_sel_hi:[0,1] neg_hi:[0,1]
    v_pk_fma_f32 v[160:161], v[160:161], v[144:145], v[166:167] op_sel:[1,1,0] op_sel_hi:[1,0,1]
    v_cvt_pk_bf16_f32 v134, v160, v161
    v_pk_mul_f32 v[166:167], v[160:161], v[144:145] op_sel:[0,0] op_sel_hi:[0,1] neg_hi:[0,1]
    v_pk_fma_f32 v[160:161], v[160:161], v[144:145], v[166:167] op_sel:[1,1,0] op_sel_hi:[1,0,1]
    v_cvt_pk_bf16_f32 v135, v160, v161
    ds_write_addtid_b32 v128 offset:0
    ds_write_addtid_b32 v129 offset:272
    ds_write_addtid_b32 v130 offset:544
    ds_write_addtid_b32 v131 offset:816
    ds_write_addtid_b32 v132 offset:1088
    ds_write_addtid_b32 v133 offset:1360
    ds_write_addtid_b32 v134 offset:1632
    ds_write_addtid_b32 v135 offset:1904
    v_pk_mul_f32 v[166:167], v[158:159], v[152:153] op_sel:[0,0] op_sel_hi:[0,1] neg_hi:[0,1]
    v_pk_fma_f32 v[160:161], v[158:159], v[152:153], v[166:167] op_sel:[1,1,0] op_sel_hi:[1,0,1]
    v_cvt_pk_bf16_f32 v136, v160, v161
    v_pk_mul_f32 v[166:167], v[160:161], v[146:147] op_sel:[0,0] op_sel_hi:[0,1] neg_hi:[0,1]
    v_pk_fma_f32 v[160:161], v[160:161], v[146:147], v[166:167] op_sel:[1,1,0] op_sel_hi:[1,0,1]
    v_cvt_pk_bf16_f32 v137, v160, v161
    v_pk_mul_f32 v[166:167], v[160:161], v[146:147] op_sel:[0,0] op_sel_hi:[0,1] neg_hi:[0,1]
    v_pk_fma_f32 v[160:161], v[160:161], v[146:147], v[166:167] op_sel:[1,1,0] op_sel_hi:[1,0,1]
    v_cvt_pk_bf16_f32 v138, v160, v161
    v_pk_mul_f32 v[166:167], v[160:161], v[146:147] op_sel:[0,0] op_sel_hi:[0,1] neg_hi:[0,1]
    v_pk_fma_f32 v[160:161], v[160:161], v[146:147], v[166:167] op_sel:[1,1,0] op_sel_hi:[1,0,1]
    v_cvt_pk_bf16_f32 v139, v160, v161
    v_pk_mul_f32 v[166:167], v[160:161], v[146:147] op_sel:[0,0] op_sel_hi:[0,1] neg_hi:[0,1]
    v_pk_fma_f32 v[160:161], v[160:161], v[146:147], v[166:167] op_sel:[1,1,0] op_sel_hi:[1,0,1]
    v_cvt_pk_bf16_f32 v140, v160, v161
    v_pk_mul_f32 v[166:167], v[158:159], v[154:155] op_sel:[0,0] op_sel_hi:[0,1] neg_hi:[0,1]
    v_pk_fma_f32 v[162:163], v[158:159], v[154:155], v[166:167] op_sel:[1,1,0] op_sel_hi:[1,0,1]
    v_cvt_pk_bf16_f32 v141, v162, v163
    v_pk_mul_f32 v[166:167], v[162:163], v[148:149] op_sel:[0,0] op_sel_hi:[0,1] neg_hi:[0,1]
    v_pk_fma_f32 v[160:161], v[162:163], v[148:149], v[166:167] op_sel:[1,1,0] op_sel_hi:[1,0,1]
    v_cvt_pk_bf16_f32 v142, v160, v161
    v_pk_mul_f32 v[166:167], v[160:161], v[148:149] op_sel:[0,0] op_sel_hi:[0,1] neg_hi:[0,1]
    v_pk_fma_f32 v[160:161], v[160:161], v[148:149], v[166:167] op_sel:[1,1,0] op_sel_hi:[1,0,1]
    v_cvt_pk_bf16_f32 v143, v160, v161
    ds_write_addtid_b32 v136 offset:6528
    ds_write_addtid_b32 v137 offset:6800
    ds_write_addtid_b32 v138 offset:7072
    ds_write_addtid_b32 v138 offset:7616
    ds_write_addtid_b32 v139 offset:7888
    ds_write_addtid_b32 v140 offset:8160
    ds_write_addtid_b32 v141 offset:2176
    ds_write_addtid_b32 v142 offset:2448
    ds_write_addtid_b32 v143 offset:2720
    v_pk_mul_f32 v[166:167], v[162:163], v[152:153] op_sel:[0,0] op_sel_hi:[0,1] neg_hi:[0,1]
    v_pk_fma_f32 v[162:163], v[162:163], v[152:153], v[166:167] op_sel:[1,1,0] op_sel_hi:[1,0,1]
    v_cvt_pk_bf16_f32 v128, v162, v163
    v_pk_mul_f32 v[166:167], v[162:163], v[148:149] op_sel:[0,0] op_sel_hi:[0,1] neg_hi:[0,1]
    v_pk_fma_f32 v[160:161], v[162:163], v[148:149], v[166:167] op_sel:[1,1,0] op_sel_hi:[1,0,1]
    v_cvt_pk_bf16_f32 v129, v160, v161
    v_pk_mul_f32 v[166:167], v[160:161], v[148:149] op_sel:[0,0] op_sel_hi:[0,1] neg_hi:[0,1]
    v_pk_fma_f32 v[160:161], v[160:161], v[148:149], v[166:167] op_sel:[1,1,0] op_sel_hi:[1,0,1]
    v_cvt_pk_bf16_f32 v130, v160, v161
    v_pk_mul_f32 v[166:167], v[158:159], v[156:157] op_sel:[0,0] op_sel_hi:[0,1] neg_hi:[0,1]
    v_pk_fma_f32 v[162:163], v[158:159], v[156:157], v[166:167] op_sel:[1,1,0] op_sel_hi:[1,0,1]
    v_cvt_pk_bf16_f32 v131, v162, v163
    v_pk_mul_f32 v[166:167], v[162:163], v[150:151] op_sel:[0,0] op_sel_hi:[0,1] neg_hi:[0,1]
    v_pk_fma_f32 v[160:161], v[162:163], v[150:151], v[166:167] op_sel:[1,1,0] op_sel_hi:[1,0,1]
    v_cvt_pk_bf16_f32 v132, v160, v161
    v_pk_mul_f32 v[166:167], v[162:163], v[152:153] op_sel:[0,0] op_sel_hi:[0,1] neg_hi:[0,1]
    v_pk_fma_f32 v[162:163], v[162:163], v[152:153], v[166:167] op_sel:[1,1,0] op_sel_hi:[1,0,1]
    v_cvt_pk_bf16_f32 v133, v162, v163
    v_pk_mul_f32 v[166:167], v[162:163], v[150:151] op_sel:[0,0] op_sel_hi:[0,1] neg_hi:[0,1]
    v_pk_fma_f32 v[160:161], v[162:163], v[150:151], v[166:167] op_sel:[1,1,0] op_sel_hi:[1,0,1]
    v_cvt_pk_bf16_f32 v134, v160, v161
    v_pk_mul_f32 v[166:167], v[162:163], v[152:153] op_sel:[0,0] op_sel_hi:[0,1] neg_hi:[0,1]
    v_pk_fma_f32 v[162:163], v[162:163], v[152:153], v[166:167] op_sel:[1,1,0] op_sel_hi:[1,0,1]
    v_cvt_pk_bf16_f32 v135, v162, v163
    ds_write_addtid_b32 v128 offset:3264
    ds_write_addtid_b32 v129 offset:3536
    ds_write_addtid_b32 v130 offset:3808
    ds_write_addtid_b32 v131 offset:4352
    ds_write_addtid_b32 v132 offset:4624
    ds_write_addtid_b32 v133 offset:4896
    ds_write_addtid_b32 v134 offset:5168
    ds_write_addtid_b32 v135 offset:5440
    v_pk_mul_f32 v[166:167], v[162:163], v[150:151] op_sel:[0,0] op_sel_hi:[0,1] neg_hi:[0,1]
    v_pk_fma_f32 v[160:161], v[162:163], v[150:151], v[166:167] op_sel:[1,1,0] op_sel_hi:[1,0,1]
    v_cvt_pk_bf16_f32 v136, v160, v161
    v_pk_mul_f32 v[166:167], v[162:163], v[152:153] op_sel:[0,0] op_sel_hi:[0,1] neg_hi:[0,1]
    v_pk_fma_f32 v[162:163], v[162:163], v[152:153], v[166:167] op_sel:[1,1,0] op_sel_hi:[1,0,1]
    v_cvt_pk_bf16_f32 v137, v162, v163
    v_pk_mul_f32 v[166:167], v[162:163], v[150:151] op_sel:[0,0] op_sel_hi:[0,1] neg_hi:[0,1]
    v_pk_fma_f32 v[160:161], v[162:163], v[150:151], v[166:167] op_sel:[1,1,0] op_sel_hi:[1,0,1]
    v_cvt_pk_bf16_f32 v138, v160, v161
    ds_write_addtid_b32 v136 offset:5712
    ds_write_addtid_b32 v137 offset:5984
    ds_write_addtid_b32 v138 offset:6256
    ds_read_b128 v[64:67], v26 offset:0
    ds_read_b128 v[72:75], v26 offset:32
    ds_read_b128 v[80:83], v26 offset:64
    ds_read_b128 v[88:91], v26 offset:96
    ds_read_b128 v[96:99], v26 offset:128
    ds_read_b128 v[104:107], v26 offset:160
    ds_read_b128 v[112:115], v26 offset:192
    ds_read_b128 v[120:123], v26 offset:224
    s_waitcnt lgkmcnt(7)
    v_mfma_f32_32x32x16_bf16 v[40:55], v[64:67], v[68:71], 0
    s_waitcnt lgkmcnt(6)
    v_mfma_f32_32x32x16_bf16 v[40:55], v[72:75], v[76:79], v[40:55]
    s_waitcnt lgkmcnt(5)
    v_mfma_f32_32x32x16_bf16 v[40:55], v[80:83], v[84:87], v[40:55]
    s_waitcnt lgkmcnt(4)
    v_mfma_f32_32x32x16_bf16 v[40:55], v[88:91], v[92:95], v[40:55]
    s_waitcnt lgkmcnt(3)
    v_mfma_f32_32x32x16_bf16 v[40:55], v[96:99], v[100:103], v[40:55]
    s_waitcnt lgkmcnt(2)
    v_mfma_f32_32x32x16_bf16 v[40:55], v[104:107], v[108:111], v[40:55]
    s_waitcnt lgkmcnt(1)
    v_mfma_f32_32x32x16_bf16 v[40:55], v[112:115], v[116:119], v[40:55]
    s_waitcnt lgkmcnt(0)
    v_mfma_f32_32x32x16_bf16 v[40:55], v[120:123], v[124:127], v[40:55]
    s_waitcnt vmcnt(4)
    s_barrier
    s_cmp_lg_u32 s3, 0
    s_cbranch_scc1 L_apub_41
    s_mov_b32 s20, s62
    s_mov_b32 s21, s63
    s_mov_b32 s22, 256
    s_mov_b32 s23, 0x00020000
    s_and_b32 s4, s2, 1
    s_lshl_b32 s4, s4, 7
    s_mov_b64 exec, 1
    v_mov_b32 v2, 1
    buffer_atomic_add v2, off, s[20:23], s4 offset:0 sc1
    s_mov_b64 exec, -1
L_apub_41:
    s_mov_b32 m0, s97
    v_and_b32_e64 v2, 31, v0
    v_mul_u32_u24 v2, 272, v2
    v_lshrrev_b32_e64 v3, 5, v0
    v_lshl_add_u32 v2, v3, 4, v2
    v_add_u32 v26, s97, v2
    v_add_f32 v25, v1, v1
    v_and_b32 v2, 0xffff0000, v248
    v_and_b32 v3, 0xffff0000, v249
    v_and_b32 v158, 0xffff0000, v250
    v_and_b32 v159, 0xffff0000, v251
    v_mul_f32 v2, 0x3fb8aa3b, v2
    v_exp_f32 v2, v2
    v_mul_f32 v5, v3, v1
    v_cvt_pk_bf16_f32 v2, v2, v2
    v_and_b32 v2, 0xffff0000, v2
    v_mul_f32_e64 v4, v2, v1
    v_mul_f32 v4, 0xbfb8aa3b, v4
    v_mul_f32 v5, 0x3e22f983, v5
    v_mul_f32 v158, v158, v25
    v_mul_f32 v159, v159, -v25
    v_exp_f32 v2, v4
    v_fract_f32 v3, v5
    v_cos_f32 v144, v3
    v_sin_f32_e64 v145, v3
    s_nop 0
    v_pk_mul_f32 v[144:145], v[144:145], v[2:3] op_sel_hi:[1,0]
    v_mul_f32 v2, 0x41000000, v4
    v_mul_f32 v3, 0x41000000, v5
    v_exp_f32 v2, v2
    v_fract_f32 v3, v3
    v_cos_f32 v150, v3
    v_sin_f32_e64 v151, v3
    s_nop 0
    v_pk_mul_f32 v[150:151], v[150:151], v[2:3] op_sel_hi:[1,0]
    v_mul_f32 v2, 0x43800000, v4
    v_mul_f32 v3, 0x43800000, v5
    v_exp_f32 v2, v2
    v_fract_f32 v3, v3
    v_cos_f32 v152, v3
    v_sin_f32_e64 v153, v3
    s_nop 0
    v_pk_mul_f32 v[152:153], v[152:153], v[2:3] op_sel_hi:[1,0]
    v_pk_mul_f32 v[166:167], v[144:145], v[144:145] op_sel:[0,0] op_sel_hi:[0,1]
    v_pk_fma_f32 v[146:147], v[144:145], v[144:145], v[166:167] op_sel:[1,1,0] op_sel_hi:[1,0,1] neg_lo:[0,1,0]
    v_pk_mul_f32 v[168:169], v[152:153], v[152:153] op_sel:[0,0] op_sel_hi:[0,1]
    v_pk_fma_f32 v[154:155], v[152:153], v[152:153], v[168:169] op_sel:[1,1,0] op_sel_hi:[1,0,1] neg_lo:[0,1,0]
    v_pk_mul_f32 v[166:167], v[146:147], v[146:147] op_sel:[0,0] op_sel_hi:[0,1]
    v_pk_fma_f32 v[148:149], v[146:147], v[146:147], v[166:167] op_sel:[1,1,0] op_sel_hi:[1,0,1] neg_lo:[0,1,0]
    v_pk_mul_f32 v[168:169], v[154:155], v[154:155] op_sel:[0,0] op_sel_hi:[0,1]
    v_pk_fma_f32 v[156:157], v[154:155], v[154:155], v[168:169] op_sel:[1,1,0] op_sel_hi:[1,0,1] neg_lo:[0,1,0]
    v_mov_b32 v128, 0x3f80
    v_cvt_pk_bf16_f32 v129, v150, v151
    v_pk_mul_f32 v[168:169], v[150:151], v[150:151] op_sel:[0,0] op_sel_hi:[0,1]
    v_pk_fma_f32 v[164:165], v[150:151], v[150:151], v[168:169] op_sel:[1,1,0] op_sel_hi:[1,0,1] neg_lo:[0,1,0]
    v_cvt_pk_bf16_f32 v130, v164, v165
    v_pk_mul_f32 v[168:169], v[164:165], v[150:151] op_sel:[0,0] op_sel_hi:[0,1]
    v_pk_fma_f32 v[164:165], v[164:165], v[150:151], v[168:169] op_sel:[1,1,0] op_sel_hi:[1,0,1] neg_lo:[0,1,0]
    v_cvt_pk_bf16_f32 v131, v164, v165
    v_pk_mul_f32 v[168:169], v[164:165], v[150:151] op_sel:[0,0] op_sel_hi:[0,1]
    v_pk_fma_f32 v[164:165], v[164:165], v[150:151], v[168:169] op_sel:[1,1,0] op_sel_hi:[1,0,1] neg_lo:[0,1,0]
    v_cvt_pk_bf16_f32 v132, v164, v165
    v_pk_mul_f32 v[168:169], v[164:165], v[150:151] op_sel:[0,0] op_sel_hi:[0,1]
    v_pk_fma_f32 v[164:165], v[164:165], v[150:151], v[168:169] op_sel:[1,1,0] op_sel_hi:[1,0,1] neg_lo:[0,1,0]
    v_cvt_pk_bf16_f32 v133, v164, v165
    v_pk_mul_f32 v[168:169], v[164:165], v[150:151] op_sel:[0,0] op_sel_hi:[0,1]
    v_pk_fma_f32 v[164:165], v[164:165], v[150:151], v[168:169] op_sel:[1,1,0] op_sel_hi:[1,0,1] neg_lo:[0,1,0]
    v_cvt_pk_bf16_f32 v134, v164, v165
    v_pk_mul_f32 v[168:169], v[164:165], v[150:151] op_sel:[0,0] op_sel_hi:[0,1]
    v_pk_fma_f32 v[164:165], v[164:165], v[150:151], v[168:169] op_sel:[1,1,0] op_sel_hi:[1,0,1] neg_lo:[0,1,0]
    v_cvt_pk_bf16_f32 v135, v164, v165
    ds_write_addtid_b32 v128 offset:0
    ds_write_addtid_b32 v129 offset:272
    ds_write_addtid_b32 v130 offset:544
    ds_write_addtid_b32 v131 offset:816
    ds_write_addtid_b32 v132 offset:1088
    ds_write_addtid_b32 v133 offset:1360
    ds_write_addtid_b32 v134 offset:1632
    ds_write_addtid_b32 v135 offset:1904
    v_pk_mul_f32 v[168:169], v[164:165], v[150:151] op_sel:[0,0] op_sel_hi:[0,1]
    v_pk_fma_f32 v[164:165], v[164:165], v[150:151], v[168:169] op_sel:[1,1,0] op_sel_hi:[1,0,1] neg_lo:[0,1,0]
    v_cvt_pk_bf16_f32 v136, v164, v165
    v_pk_mul_f32 v[168:169], v[164:165], v[150:151] op_sel:[0,0] op_sel_hi:[0,1]
    v_pk_fma_f32 v[164:165], v[164:165], v[150:151], v[168:169] op_sel:[1,1,0] op_sel_hi:[1,0,1] neg_lo:[0,1,0]
    v_cvt_pk_bf16_f32 v137, v164, v165
    v_pk_mul_f32 v[168:169], v[164:165], v[150:151] op_sel:[0,0] op_sel_hi:[0,1]
    v_pk_fma_f32 v[164:165], v[164:165], v[150:151], v[168:169] op_sel:[1,1,0] op_sel_hi:[1,0,1] neg_lo:[0,1,0]
    v_cvt_pk_bf16_f32 v138, v164, v165
    v_pk_mul_f32 v[168:169], v[164:165], v[150:151] op_sel:[0,0] op_sel_hi:[0,1]
    v_pk_fma_f32 v[164:165], v[164:165], v[150:151], v[168:169] op_sel:[1,1,0] op_sel_hi:[1,0,1] neg_lo:[0,1,0]
    v_cvt_pk_bf16_f32 v139, v164, v165
    v_pk_mul_f32 v[168:169], v[164:165], v[150:151] op_sel:[0,0] op_sel_hi:[0,1]
    v_pk_fma_f32 v[164:165], v[164:165], v[150:151], v[168:169] op_sel:[1,1,0] op_sel_hi:[1,0,1] neg_lo:[0,1,0]
    v_cvt_pk_bf16_f32 v140, v164, v165
    v_pk_mul_f32 v[168:169], v[164:165], v[150:151] op_sel:[0,0] op_sel_hi:[0,1]
    v_pk_fma_f32 v[164:165], v[164:165], v[150:151], v[168:169] op_sel:[1,1,0] op_sel_hi:[1,0,1] neg_lo:[0,1,0]
    v_cvt_pk_bf16_f32 v141, v164, v165
    v_pk_mul_f32 v[168:169], v[164:165], v[150:151] op_sel:[0,0] op_sel_hi:[0,1]
    v_pk_fma_f32 v[164:165], v[164:165], v[150:151], v[168:169] op_sel:[1,1,0] op_sel_hi:[1,0,1] neg_lo:[0,1,0]
    v_cvt_pk_bf16_f32 v142, v164, v165
    v_pk_mul_f32 v[168:169], v[164:165], v[150:151] op_sel:[0,0] op_sel_hi:[0,1]
    v_pk_fma_f32 v[164:165], v[164:165], v[150:151], v[168:169] op_sel:[1,1,0] op_sel_hi:[1,0,1] neg_lo:[0,1,0]
    v_cvt_pk_bf16_f32 v143, v164, v165
    ds_write_addtid_b32 v136 offset:2176
    ds_write_addtid_b32 v137 offset:2448
    ds_write_addtid_b32 v138 offset:2720
    ds_write_addtid_b32 v139 offset:2992
    ds_write_addtid_b32 v140 offset:3264
    ds_write_addtid_b32 v141 offset:3536
    ds_write_addtid_b32 v142 offset:3808
    ds_write_addtid_b32 v143 offset:4080
    v_pk_mul_f32 v[168:169], v[164:165], v[150:151] op_sel:[0,0] op_sel_hi:[0,1]
    v_pk_fma_f32 v[164:165], v[164:165], v[150:151], v[168:169] op_sel:[1,1,0] op_sel_hi:[1,0,1] neg_lo:[0,1,0]
    v_cvt_pk_bf16_f32 v128, v164, v165
    v_pk_mul_f32 v[168:169], v[164:165], v[150:151] op_sel:[0,0] op_sel_hi:[0,1]
    v_pk_fma_f32 v[164:165], v[164:165], v[150:151], v[168:169] op_sel:[1,1,0] op_sel_hi:[1,0,1] neg_lo:[0,1,0]
    v_cvt_pk_bf16_f32 v129, v164, v165
    v_pk_mul_f32 v[168:169], v[164:165], v[150:151] op_sel:[0,0] op_sel_hi:[0,1]
    v_pk_fma_f32 v[164:165], v[164:165], v[150:151], v[168:169] op_sel:[1,1,0] op_sel_hi:[1,0,1] neg_lo:[0,1,0]
    v_cvt_pk_bf16_f32 v130, v164, v165
    v_pk_mul_f32 v[168:169], v[164:165], v[150:151] op_sel:[0,0] op_sel_hi:[0,1]
    v_pk_fma_f32 v[164:165], v[164:165], v[150:151], v[168:169] op_sel:[1,1,0] op_sel_hi:[1,0,1] neg_lo:[0,1,0]
    v_cvt_pk_bf16_f32 v131, v164, v165
    v_pk_mul_f32 v[168:169], v[164:165], v[150:151] op_sel:[0,0] op_sel_hi:[0,1]
    v_pk_fma_f32 v[164:165], v[164:165], v[150:151], v[168:169] op_sel:[1,1,0] op_sel_hi:[1,0,1] neg_lo:[0,1,0]
    v_cvt_pk_bf16_f32 v132, v164, v165
    v_pk_mul_f32 v[168:169], v[164:165], v[150:151] op_sel:[0,0] op_sel_hi:[0,1]
    v_pk_fma_f32 v[164:165], v[164:165], v[150:151], v[168:169] op_sel:[1,1,0] op_sel_hi:[1,0,1] neg_lo:[0,1,0]
    v_cvt_pk_bf16_f32 v133, v164, v165
    v_pk_mul_f32 v[168:169], v[164:165], v[150:151] op_sel:[0,0] op_sel_hi:[0,1]
    v_pk_fma_f32 v[164:165], v[164:165], v[150:151], v[168:169] op_sel:[1,1,0] op_sel_hi:[1,0,1] neg_lo:[0,1,0]
    v_cvt_pk_bf16_f32 v134, v164, v165
    v_pk_mul_f32 v[168:169], v[164:165], v[150:151] op_sel:[0,0] op_sel_hi:[0,1]
    v_pk_fma_f32 v[164:165], v[164:165], v[150:151], v[168:169] op_sel:[1,1,0] op_sel_hi:[1,0,1] neg_lo:[0,1,0]
    v_cvt_pk_bf16_f32 v135, v164, v165
    ds_write_addtid_b32 v128 offset:4352
    ds_write_addtid_b32 v129 offset:4624
    ds_write_addtid_b32 v130 offset:4896
    ds_write_addtid_b32 v131 offset:5168
    ds_write_addtid_b32 v132 offset:5440
    ds_write_addtid_b32 v133 offset:5712
    ds_write_addtid_b32 v134 offset:5984
    ds_write_addtid_b32 v135 offset:6256
    v_pk_mul_f32 v[168:169], v[164:165], v[150:151] op_sel:[0,0] op_sel_hi:[0,1]
    v_pk_fma_f32 v[164:165], v[164:165], v[150:151], v[168:169] op_sel:[1,1,0] op_sel_hi:[1,0,1] neg_lo:[0,1,0]
    v_cvt_pk_bf16_f32 v136, v164, v165
    v_pk_mul_f32 v[168:169], v[164:165], v[150:151] op_sel:[0,0] op_sel_hi:[0,1]
    v_pk_fma_f32 v[164:165], v[164:165], v[150:151], v[168:169] op_sel:[1,1,0] op_sel_hi:[1,0,1] neg_lo:[0,1,0]
    v_cvt_pk_bf16_f32 v137, v164, v165
    v_pk_mul_f32 v[168:169], v[164:165], v[150:151] op_sel:[0,0] op_sel_hi:[0,1]
    v_pk_fma_f32 v[164:165], v[164:165], v[150:151], v[168:169] op_sel:[1,1,0] op_sel_hi:[1,0,1] neg_lo:[0,1,0]
    v_cvt_pk_bf16_f32 v138, v164, v165
    v_pk_mul_f32 v[168:169], v[164:165], v[150:151] op_sel:[0,0] op_sel_hi:[0,1]
    v_pk_fma_f32 v[164:165], v[164:165], v[150:151], v[168:169] op_sel:[1,1,0] op_sel_hi:[1,0,1] neg_lo:[0,1,0]
    v_cvt_pk_bf16_f32 v139, v164, v165
    v_pk_mul_f32 v[168:169], v[164:165], v[150:151] op_sel:[0,0] op_sel_hi:[0,1]
    v_pk_fma_f32 v[164:165], v[164:165], v[150:151], v[168:169] op_sel:[1,1,0] op_sel_hi:[1,0,1] neg_lo:[0,1,0]
    v_cvt_pk_bf16_f32 v140, v164, v165
    v_pk_mul_f32 v[168:169], v[164:165], v[150:151] op_sel:[0,0] op_sel_hi:[0,1]
    v_pk_fma_f32 v[164:165], v[164:165], v[150:151], v[168:169] op_sel:[1,1,0] op_sel_hi:[1,0,1] neg_lo:[0,1,0]
    v_cvt_pk_bf16_f32 v141, v164, v165
    v_pk_mul_f32 v[168:169], v[164:165], v[150:151] op_sel:[0,0] op_sel_hi:[0,1]
    v_pk_fma_f32 v[164:165], v[164:165], v[150:151], v[168:169] op_sel:[1,1,0] op_sel_hi:[1,0,1] neg_lo:[0,1,0]
    v_cvt_pk_bf16_f32 v142, v164, v165
    v_pk_mul_f32 v[168:169], v[164:165], v[150:151] op_sel:[0,0] op_sel_hi:[0,1]
    v_pk_fma_f32 v[164:165], v[164:165], v[150:151], v[168:169] op_sel:[1,1,0] op_sel_hi:[1,0,1] neg_lo:[0,1,0]
    v_cvt_pk_bf16_f32 v143, v164, v165
    ds_write_addtid_b32 v136 offset:6528
    ds_write_addtid_b32 v137 offset:6800
    ds_write_addtid_b32 v138 offset:7072
    ds_write_addtid_b32 v139 offset:7344
    ds_write_addtid_b32 v140 offset:7616
    ds_write_addtid_b32 v141 offset:7888
    ds_write_addtid_b32 v142 offset:8160
    ds_write_addtid_b32 v143 offset:8432
    ds_read_b128 v[68:71], v26 offset:0
    ds_read_b128 v[76:79], v26 offset:32
    ds_read_b128 v[84:87], v26 offset:64
    ds_read_b128 v[92:95], v26 offset:96
    ds_read_b128 v[100:103], v26 offset:128
    ds_read_b128 v[108:111], v26 offset:160
    ds_read_b128 v[116:119], v26 offset:192
    ds_read_b128 v[124:127], v26 offset:224
    v_cvt_pk_bf16_f32 v128, v158, v159
    v_pk_mul_f32 v[166:167], v[158:159], v[144:145] op_sel:[0,0] op_sel_hi:[0,1] neg_hi:[0,1]
    v_pk_fma_f32 v[160:161], v[158:159], v[144:145], v[166:167] op_sel:[1,1,0] op_sel_hi:[1,0,1]
    v_cvt_pk_bf16_f32 v129, v160, v161
    v_pk_mul_f32 v[166:167], v[160:161], v[144:145] op_sel:[0,0] op_sel_hi:[0,1] neg_hi:[0,1]
    v_pk_fma_f32 v[160:161], v[160:161], v[144:145], v[166:167] op_sel:[1,1,0] op_sel_hi:[1,0,1]
    v_cvt_pk_bf16_f32 v130, v160, v161
    v_pk_mul_f32 v[166:167], v[160:161], v[144:145] op_sel:[0,0] op_sel_hi:[0,1] neg_hi:[0,1]
    v_pk_fma_f32 v[160:161], v[160:161], v[144:145], v[166:167] op_sel:[1,1,0] op_sel_hi:[1,0,1]
    v_cvt_pk_bf16_f32 v131, v160, v161
    v_pk_mul_f32 v[166:167], v[160:161], v[144:145] op_sel:[0,0] op_sel_hi:[0,1] neg_hi:[0,1]
    v_pk_fma_f32 v[160:161], v[160:161], v[144:145], v[166:167] op_sel:[1,1,0] op_sel_hi:[1,0,1]
    v_cvt_pk_bf16_f32 v132, v160, v161
    v_pk_mul_f32 v[166:167], v[160:161], v[144:145] op_sel:[0,0] op_sel_hi:[0,1] neg_hi:[0,1]
    v_pk_fma_f32 v[160:161], v[160:161], v[144:145], v[166:167] op_sel:[1,1,0] op_sel_hi:[1,0,1]
    v_cvt_pk_bf16_f32 v133, v160, v161
    v_pk_mul_f32 v[166:167], v[160:161], v[144:145] op_sel:[0,0] op_sel_hi:[0,1] neg_hi:[0,1]
    v_pk_fma_f32 v[160:161], v[160:161], v[144:145], v[166:167] op_sel:[1,1,0] op_sel_hi:[1,0,1]
    v_cvt_pk_bf16_f32 v134, v160, v161
    v_pk_mul_f32 v[166:167], v[160:161], v[144:145] op_sel:[0,0] op_sel_hi:[0,1] neg_hi:[0,1]
    v_pk_fma_f32 v[160:161], v[160:161], v[144:145], v[166:167] op_sel:[1,1,0] op_sel_hi:[1,0,1]
    v_cvt_pk_bf16_f32 v135, v160, v161
    ds_write_addtid_b32 v128 offset:0
    ds_write_addtid_b32 v129 offset:272
    ds_write_addtid_b32 v130 offset:544
    ds_write_addtid_b32 v131 offset:816
    ds_write_addtid_b32 v132 offset:1088
    ds_write_addtid_b32 v133 offset:1360
    ds_write_addtid_b32 v134 offset:1632
    ds_write_addtid_b32 v135 offset:1904
    v_pk_mul_f32 v[166:167], v[158:159], v[152:153] op_sel:[0,0] op_sel_hi:[0,1] neg_hi:[0,1]
    v_pk_fma_f32 v[160:161], v[158:159], v[152:153], v[166:167] op_sel:[1,1,0] op_sel_hi:[1,0,1]
    v_cvt_pk_bf16_f32 v136, v160, v161
    v_pk_mul_f32 v[166:167], v[160:161], v[146:147] op_sel:[0,0] op_sel_hi:[0,1] neg_hi:[0,1]
    v_pk_fma_f32 v[160:161], v[160:161], v[146:147], v[166:167] op_sel:[1,1,0] op_sel_hi:[1,0,1]
    v_cvt_pk_bf16_f32 v137, v160, v161
    v_pk_mul_f32 v[166:167], v[160:161], v[146:147] op_sel:[0,0] op_sel_hi:[0,1] neg_hi:[0,1]
    v_pk_fma_f32 v[160:161], v[160:161], v[146:147], v[166:167] op_sel:[1,1,0] op_sel_hi:[1,0,1]
    v_cvt_pk_bf16_f32 v138, v160, v161
    v_pk_mul_f32 v[166:167], v[160:161], v[146:147] op_sel:[0,0] op_sel_hi:[0,1] neg_hi:[0,1]
    v_pk_fma_f32 v[160:161], v[160:161], v[146:147], v[166:167] op_sel:[1,1,0] op_sel_hi:[1,0,1]
    v_cvt_pk_bf16_f32 v139, v160, v161
    v_pk_mul_f32 v[166:167], v[160:161], v[146:147] op_sel:[0,0] op_sel_hi:[0,1] neg_hi:[0,1]
    v_pk_fma_f32 v[160:161], v[160:161], v[146:147], v[166:167] op_sel:[1,1,0] op_sel_hi:[1,0,1]
    v_cvt_pk_bf16_f32 v140, v160, v161
    v_pk_mul_f32 v[166:167], v[158:159], v[154:155] op_sel:[0,0] op_sel_hi:[0,1] neg_hi:[0,1]
    v_pk_fma_f32 v[162:163], v[158:159], v[154:155], v[166:167] op_sel:[1,1,0] op_sel_hi:[1,0,1]
    v_cvt_pk_bf16_f32 v141, v162, v163
    v_pk_mul_f32 v[166:167], v[162:163], v[148:149] op_sel:[0,0] op_sel_hi:[0,1] neg_hi:[0,1]
    v_pk_fma_f32 v[160:161], v[162:163], v[148:149], v[166:167] op_sel:[1,1,0] op_sel_hi:[1,0,1]
    v_cvt_pk_bf16_f32 v142, v160, v161
    v_pk_mul_f32 v[166:167], v[160:161], v[148:149] op_sel:[0,0] op_sel_hi:[0,1] neg_hi:[0,1]
    v_pk_fma_f32 v[160:161], v[160:161], v[148:149], v[166:167] op_sel:[1,1,0] op_sel_hi:[1,0,1]
    v_cvt_pk_bf16_f32 v143, v160, v161
    ds_write_addtid_b32 v136 offset:6528
    ds_write_addtid_b32 v137 offset:6800
    ds_write_addtid_b32 v138 offset:7072
    ds_write_addtid_b32 v138 offset:7616
    ds_write_addtid_b32 v139 offset:7888
    ds_write_addtid_b32 v140 offset:8160
    ds_write_addtid_b32 v141 offset:2176
    ds_write_addtid_b32 v142 offset:2448
    ds_write_addtid_b32 v143 offset:2720
    v_pk_mul_f32 v[166:167], v[162:163], v[152:153] op_sel:[0,0] op_sel_hi:[0,1] neg_hi:[0,1]
    v_pk_fma_f32 v[162:163], v[162:163], v[152:153], v[166:167] op_sel:[1,1,0] op_sel_hi:[1,0,1]
    v_cvt_pk_bf16_f32 v128, v162, v163
    v_pk_mul_f32 v[166:167], v[162:163], v[148:149] op_sel:[0,0] op_sel_hi:[0,1] neg_hi:[0,1]
    v_pk_fma_f32 v[160:161], v[162:163], v[148:149], v[166:167] op_sel:[1,1,0] op_sel_hi:[1,0,1]
    v_cvt_pk_bf16_f32 v129, v160, v161
    v_pk_mul_f32 v[166:167], v[160:161], v[148:149] op_sel:[0,0] op_sel_hi:[0,1] neg_hi:[0,1]
    v_pk_fma_f32 v[160:161], v[160:161], v[148:149], v[166:167] op_sel:[1,1,0] op_sel_hi:[1,0,1]
    v_cvt_pk_bf16_f32 v130, v160, v161
    v_pk_mul_f32 v[166:167], v[158:159], v[156:157] op_sel:[0,0] op_sel_hi:[0,1] neg_hi:[0,1]
    v_pk_fma_f32 v[162:163], v[158:159], v[156:157], v[166:167] op_sel:[1,1,0] op_sel_hi:[1,0,1]
    v_cvt_pk_bf16_f32 v131, v162, v163
    v_pk_mul_f32 v[166:167], v[162:163], v[150:151] op_sel:[0,0] op_sel_hi:[0,1] neg_hi:[0,1]
    v_pk_fma_f32 v[160:161], v[162:163], v[150:151], v[166:167] op_sel:[1,1,0] op_sel_hi:[1,0,1]
    v_cvt_pk_bf16_f32 v132, v160, v161
    v_pk_mul_f32 v[166:167], v[162:163], v[152:153] op_sel:[0,0] op_sel_hi:[0,1] neg_hi:[0,1]
    v_pk_fma_f32 v[162:163], v[162:163], v[152:153], v[166:167] op_sel:[1,1,0] op_sel_hi:[1,0,1]
    v_cvt_pk_bf16_f32 v133, v162, v163
    v_pk_mul_f32 v[166:167], v[162:163], v[150:151] op_sel:[0,0] op_sel_hi:[0,1] neg_hi:[0,1]
    v_pk_fma_f32 v[160:161], v[162:163], v[150:151], v[166:167] op_sel:[1,1,0] op_sel_hi:[1,0,1]
    v_cvt_pk_bf16_f32 v134, v160, v161
    v_pk_mul_f32 v[166:167], v[162:163], v[152:153] op_sel:[0,0] op_sel_hi:[0,1] neg_hi:[0,1]
    v_pk_fma_f32 v[162:163], v[162:163], v[152:153], v[166:167] op_sel:[1,1,0] op_sel_hi:[1,0,1]
    v_cvt_pk_bf16_f32 v135, v162, v163
    ds_write_addtid_b32 v128 offset:3264
    ds_write_addtid_b32 v129 offset:3536
    ds_write_addtid_b32 v130 offset:3808
    ds_write_addtid_b32 v131 offset:4352
    ds_write_addtid_b32 v132 offset:4624
    ds_write_addtid_b32 v133 offset:4896
    ds_write_addtid_b32 v134 offset:5168
    ds_write_addtid_b32 v135 offset:5440
    v_pk_mul_f32 v[166:167], v[162:163], v[150:151] op_sel:[0,0] op_sel_hi:[0,1] neg_hi:[0,1]
    v_pk_fma_f32 v[160:161], v[162:163], v[150:151], v[166:167] op_sel:[1,1,0] op_sel_hi:[1,0,1]
    v_cvt_pk_bf16_f32 v136, v160, v161
    v_pk_mul_f32 v[166:167], v[162:163], v[152:153] op_sel:[0,0] op_sel_hi:[0,1] neg_hi:[0,1]
    v_pk_fma_f32 v[162:163], v[162:163], v[152:153], v[166:167] op_sel:[1,1,0] op_sel_hi:[1,0,1]
    v_cvt_pk_bf16_f32 v137, v162, v163
    v_pk_mul_f32 v[166:167], v[162:163], v[150:151] op_sel:[0,0] op_sel_hi:[0,1] neg_hi:[0,1]
    v_pk_fma_f32 v[160:161], v[162:163], v[150:151], v[166:167] op_sel:[1,1,0] op_sel_hi:[1,0,1]
    v_cvt_pk_bf16_f32 v138, v160, v161
    ds_write_addtid_b32 v136 offset:5712
    ds_write_addtid_b32 v137 offset:5984
    ds_write_addtid_b32 v138 offset:6256
    ds_read_b128 v[64:67], v26 offset:0
    ds_read_b128 v[72:75], v26 offset:32
    ds_read_b128 v[80:83], v26 offset:64
    ds_read_b128 v[88:91], v26 offset:96
    ds_read_b128 v[96:99], v26 offset:128
    ds_read_b128 v[104:107], v26 offset:160
    ds_read_b128 v[112:115], v26 offset:192
    ds_read_b128 v[120:123], v26 offset:224
    s_waitcnt lgkmcnt(7)
    v_mfma_f32_32x32x16_bf16 v[40:55], v[64:67], v[68:71], v[40:55]
    s_add_u32 m0, s29, 67584
    s_nop 0
    buffer_load_dwordx4 v216, s[8:11], s27 offen offset:0 lds
    s_waitcnt lgkmcnt(6)
    v_mfma_f32_32x32x16_bf16 v[40:55], v[72:75], v[76:79], v[40:55]
    buffer_load_dwordx4 v217, s[8:11], s27 offen offset:1024 lds
    s_waitcnt lgkmcnt(5)
    v_mfma_f32_32x32x16_bf16 v[40:55], v[80:83], v[84:87], v[40:55]
    buffer_load_dwordx4 v218, s[8:11], s27 offen offset:2048 lds
    s_waitcnt lgkmcnt(4)
    v_mfma_f32_32x32x16_bf16 v[40:55], v[88:91], v[92:95], v[40:55]
    buffer_load_dwordx4 v219, s[8:11], s27 offen offset:3072 lds
    s_waitcnt lgkmcnt(3)
    v_mfma_f32_32x32x16_bf16 v[40:55], v[96:99], v[100:103], v[40:55]
    s_add_u32 m0, s29, 83968
    s_add_u32 s27, s27, 128
    buffer_load_dwordx4 v220, s[16:19], s28 offen offset:0 lds
    s_waitcnt lgkmcnt(2)
    v_mfma_f32_32x32x16_bf16 v[40:55], v[104:107], v[108:111], v[40:55]
    buffer_load_dwordx4 v221, s[16:19], s28 offen offset:1024 lds
    s_waitcnt lgkmcnt(1)
    v_mfma_f32_32x32x16_bf16 v[40:55], v[112:115], v[116:119], v[40:55]
    buffer_load_dwordx4 v222, s[16:19], s28 offen offset:2048 lds
    s_waitcnt lgkmcnt(0)
    v_mfma_f32_32x32x16_bf16 v[40:55], v[120:123], v[124:127], v[40:55]
    buffer_load_dwordx4 v223, s[16:19], s28 offen offset:3072 lds
    s_add_u32 s28, s28, 221184
    s_add_u32 m0, s29, 100352
    s_nop 0
    buffer_load_dwordx4 v216, s[8:11], s27 offen offset:0 lds
    buffer_load_dwordx4 v217, s[8:11], s27 offen offset:1024 lds
    buffer_load_dwordx4 v218, s[8:11], s27 offen offset:2048 lds
    buffer_load_dwordx4 v219, s[8:11], s27 offen offset:3072 lds
    s_add_u32 m0, s29, 116736
    s_add_u32 s27, s27, 128
    buffer_load_dwordx4 v220, s[16:19], s28 offen offset:0 lds
    buffer_load_dwordx4 v221, s[16:19], s28 offen offset:1024 lds
    buffer_load_dwordx4 v222, s[16:19], s28 offen offset:2048 lds
    buffer_load_dwordx4 v223, s[16:19], s28 offen offset:3072 lds
    s_add_u32 s28, s28, 221184
    s_waitcnt vmcnt(8) lgkmcnt(0)
    s_barrier
    ds_read_b128 v[192:195], v212 offset:0
    ds_read_b64_tr_b16 v[128:129], v208 offset:0
    ds_read_b64_tr_b16 v[130:131], v208 offset:1024
    ds_read_b64_tr_b16 v[132:133], v209 offset:0
    ds_read_b64_tr_b16 v[134:135], v209 offset:1024
    ds_read_b64_tr_b16 v[136:137], v210 offset:0
    ds_read_b64_tr_b16 v[138:139], v210 offset:1024
    s_waitcnt lgkmcnt(0)
    v_mfma_f32_32x32x16_bf16 v[64:79], v[128:131], v[192:195], 0
    ds_read_b128 v[196:199], v213 offset:0
    s_add_u32 m0, s29, 34816
    ds_read_b64_tr_b16 v[144:145], v208 offset:4096
    s_nop 0
    ds_read_b64_tr_b16 v[146:147], v208 offset:5120
    v_mfma_f32_16x16x32_bf16 v[232:235], v[128:131], v[236:239], 0
    v_mfma_f32_32x32x16_bf16 v[80:95], v[132:135], v[192:195], 0
    buffer_load_dwordx4 v216, s[8:11], s27 offen offset:0 lds
    ds_read_b64_tr_b16 v[148:149], v209 offset:4096
    v_mfma_f32_32x32x16_bf16 v[96:111], v[136:139], v[192:195], 0
    buffer_load_dwordx4 v217, s[8:11], s27 offen offset:1024 lds
    ds_read_b64_tr_b16 v[150:151], v209 offset:5120
    buffer_load_dwordx4 v218, s[8:11], s27 offen offset:2048 lds
    ds_read_b64_tr_b16 v[152:153], v210 offset:4096
    buffer_load_dwordx4 v219, s[8:11], s27 offen offset:3072 lds
    ds_read_b64_tr_b16 v[154:155], v210 offset:5120
    s_add_u32 m0, s29, 51200
    ds_read_b128 v[200:203], v214 offset:0
    ds_read_b64_tr_b16 v[160:161], v208 offset:8192
    s_add_u32 s27, s27, 128
    s_waitcnt lgkmcnt(2)
    s_nop 0
    v_mfma_f32_32x32x16_bf16 v[64:79], v[144:147], v[196:199], v[64:79]
    ds_read_b64_tr_b16 v[162:163], v208 offset:9216
    buffer_load_dwordx4 v220, s[16:19], s28 offen offset:0 lds
    buffer_load_dwordx4 v221, s[16:19], s28 offen offset:1024 lds
    ds_read_b64_tr_b16 v[164:165], v209 offset:8192
    v_mfma_f32_16x16x32_bf16 v[232:235], v[144:147], v[236:239], v[232:235]
    v_mfma_f32_32x32x16_bf16 v[80:95], v[148:151], v[196:199], v[80:95]
    buffer_load_dwordx4 v222, s[16:19], s28 offen offset:2048 lds
    ds_read_b64_tr_b16 v[166:167], v209 offset:9216
    buffer_load_dwordx4 v223, s[16:19], s28 offen offset:3072 lds
    ds_read_b64_tr_b16 v[168:169], v210 offset:8192
    v_mfma_f32_32x32x16_bf16 v[96:111], v[152:155], v[196:199], v[96:111]
    s_add_u32 s28, s28, 221184
    ds_read_b64_tr_b16 v[170:171], v210 offset:9216
    s_add_u32 m0, s29, 2048
    ds_read_b128 v[204:207], v215 offset:0
    s_nop 0
    ds_read_b64_tr_b16 v[176:177], v208 offset:12288
    buffer_load_dwordx4 v216, s[8:11], s27 offen offset:0 lds
    ds_read_b64_tr_b16 v[178:179], v208 offset:13312
    buffer_load_dwordx4 v217, s[8:11], s27 offen offset:1024 lds
    s_waitcnt lgkmcnt(3)
    v_mfma_f32_32x32x16_bf16 v[64:79], v[160:163], v[200:203], v[64:79]
    ds_read_b64_tr_b16 v[180:181], v209 offset:12288
    ds_read_b64_tr_b16 v[182:183], v209 offset:13312
    ds_read_b64_tr_b16 v[184:185], v210 offset:12288
    ds_read_b64_tr_b16 v[186:187], v210 offset:13312
    buffer_load_dwordx4 v218, s[8:11], s27 offen offset:2048 lds
    buffer_load_dwordx4 v219, s[8:11], s27 offen offset:3072 lds
    s_add_u32 m0, s29, 18432
    v_mfma_f32_16x16x32_bf16 v[232:235], v[160:163], v[236:239], v[232:235]
    s_add_u32 s27, s27, 128
    v_mfma_f32_32x32x16_bf16 v[80:95], v[164:167], v[200:203], v[80:95]
    buffer_load_dwordx4 v220, s[16:19], s28 offen offset:0 lds
    buffer_load_dwordx4 v221, s[16:19], s28 offen offset:1024 lds
    buffer_load_dwordx4 v222, s[16:19], s28 offen offset:2048 lds
    buffer_load_dwordx4 v223, s[16:19], s28 offen offset:3072 lds
    s_add_u32 s28, s28, 221184
    v_mfma_f32_32x32x16_bf16 v[96:111], v[168:171], v[200:203], v[96:111]
    s_waitcnt vmcnt(16) lgkmcnt(0)
    s_barrier
    v_mfma_f32_32x32x16_bf16 v[64:79], v[176:179], v[204:207], v[64:79]
    ds_read_b128 v[192:195], v212 offset:32768
    ds_read_b64_tr_b16 v[128:129], v208 offset:32768
    ds_read_b64_tr_b16 v[130:131], v208 offset:33792
    ds_read_b64_tr_b16 v[132:133], v209 offset:32768
    ds_read_b64_tr_b16 v[134:135], v209 offset:33792
    ds_read_b64_tr_b16 v[136:137], v210 offset:32768
    v_mfma_f32_16x16x32_bf16 v[232:235], v[176:179], v[236:239], v[232:235]
    ds_read_b64_tr_b16 v[138:139], v210 offset:33792
    s_add_u32 m0, s29, 67584
    v_mfma_f32_32x32x16_bf16 v[80:95], v[180:183], v[204:207], v[80:95]
    s_nop 0
    buffer_load_dwordx4 v216, s[8:11], s27 offen offset:0 lds
    v_mfma_f32_32x32x16_bf16 v[96:111], v[184:187], v[204:207], v[96:111]
    buffer_load_dwordx4 v217, s[8:11], s27 offen offset:1024 lds
    s_waitcnt lgkmcnt(0)
    v_mfma_f32_32x32x16_bf16 v[64:79], v[128:131], v[192:195], v[64:79]
    ds_read_b128 v[196:199], v213 offset:32768
    ds_read_b64_tr_b16 v[144:145], v208 offset:36864
    ds_read_b64_tr_b16 v[146:147], v208 offset:37888
    v_mfma_f32_16x16x32_bf16 v[232:235], v[128:131], v[236:239], v[232:235]
    v_mfma_f32_32x32x16_bf16 v[80:95], v[132:135], v[192:195], v[80:95]
    buffer_load_dwordx4 v218, s[8:11], s27 offen offset:2048 lds
    ds_read_b64_tr_b16 v[148:149], v209 offset:36864
    ds_read_b64_tr_b16 v[150:151], v209 offset:37888
    v_mfma_f32_32x32x16_bf16 v[96:111], v[136:139], v[192:195], v[96:111]
    ds_read_b64_tr_b16 v[152:153], v210 offset:36864
    ds_read_b64_tr_b16 v[154:155], v210 offset:37888
    buffer_load_dwordx4 v219, s[8:11], s27 offen offset:3072 lds
    ds_read_b128 v[200:203], v214 offset:32768
    ds_read_b64_tr_b16 v[160:161], v208 offset:40960
    s_waitcnt lgkmcnt(2)
    s_nop 0
    v_mfma_f32_32x32x16_bf16 v[64:79], v[144:147], v[196:199], v[64:79]
    ds_read_b64_tr_b16 v[162:163], v208 offset:41984
    s_add_u32 m0, s29, 83968
    ds_read_b64_tr_b16 v[164:165], v209 offset:40960
    ds_read_b64_tr_b16 v[166:167], v209 offset:41984
    s_add_u32 s27, s27, 128
    ds_read_b64_tr_b16 v[168:169], v210 offset:40960
    v_mfma_f32_16x16x32_bf16 v[232:235], v[144:147], v[236:239], v[232:235]
    ds_read_b64_tr_b16 v[170:171], v210 offset:41984
    v_mfma_f32_32x32x16_bf16 v[80:95], v[148:151], v[196:199], v[80:95]
    buffer_load_dwordx4 v220, s[16:19], s28 offen offset:0 lds
    ds_read_b128 v[204:207], v215 offset:32768
    ds_read_b64_tr_b16 v[176:177], v208 offset:45056
    v_mfma_f32_32x32x16_bf16 v[96:111], v[152:155], v[196:199], v[96:111]
    buffer_load_dwordx4 v221, s[16:19], s28 offen offset:1024 lds
    ds_read_b64_tr_b16 v[178:179], v208 offset:46080
    s_waitcnt lgkmcnt(3)
    s_nop 0
    v_mfma_f32_32x32x16_bf16 v[64:79], v[160:163], v[200:203], v[64:79]
    ds_read_b64_tr_b16 v[180:181], v209 offset:45056
    ds_read_b64_tr_b16 v[182:183], v209 offset:46080
    ds_read_b64_tr_b16 v[184:185], v210 offset:45056
    ds_read_b64_tr_b16 v[186:187], v210 offset:46080
    v_mfma_f32_16x16x32_bf16 v[232:235], v[160:163], v[236:239], v[232:235]
    v_mfma_f32_32x32x16_bf16 v[80:95], v[164:167], v[200:203], v[80:95]
    buffer_load_dwordx4 v222, s[16:19], s28 offen offset:2048 lds
    buffer_load_dwordx4 v223, s[16:19], s28 offen offset:3072 lds
    s_add_u32 s28, s28, 221184
    v_mfma_f32_32x32x16_bf16 v[96:111], v[168:171], v[200:203], v[96:111]
    s_waitcnt vmcnt(16) lgkmcnt(0)
    s_barrier
    v_mfma_f32_32x32x16_bf16 v[64:79], v[176:179], v[204:207], v[64:79]
    ds_read_b128 v[192:195], v244 offset:32768
    ds_read_b64_tr_b16 v[128:129], v240 offset:32768
    ds_read_b64_tr_b16 v[130:131], v240 offset:33792
    ds_read_b64_tr_b16 v[132:133], v241 offset:32768
    ds_read_b64_tr_b16 v[134:135], v241 offset:33792
    ds_read_b64_tr_b16 v[136:137], v242 offset:32768
    v_mfma_f32_16x16x32_bf16 v[232:235], v[176:179], v[236:239], v[232:235]
    ds_read_b64_tr_b16 v[138:139], v242 offset:33792
    s_add_u32 m0, s29, 100352
    v_mfma_f32_32x32x16_bf16 v[80:95], v[180:183], v[204:207], v[80:95]
    s_nop 0
    buffer_load_dwordx4 v216, s[8:11], s27 offen offset:0 lds
    v_mfma_f32_32x32x16_bf16 v[96:111], v[184:187], v[204:207], v[96:111]
    buffer_load_dwordx4 v217, s[8:11], s27 offen offset:1024 lds
    s_waitcnt lgkmcnt(0)
    v_mfma_f32_32x32x16_bf16 v[64:79], v[128:131], v[192:195], v[64:79]
    ds_read_b128 v[196:199], v245 offset:32768
    ds_read_b64_tr_b16 v[144:145], v240 offset:36864
    ds_read_b64_tr_b16 v[146:147], v240 offset:37888
    v_mfma_f32_16x16x32_bf16 v[232:235], v[128:131], v[236:239], v[232:235]
    v_mfma_f32_32x32x16_bf16 v[80:95], v[132:135], v[192:195], v[80:95]
    buffer_load_dwordx4 v218, s[8:11], s27 offen offset:2048 lds
    ds_read_b64_tr_b16 v[148:149], v241 offset:36864
    ds_read_b64_tr_b16 v[150:151], v241 offset:37888
    v_mfma_f32_32x32x16_bf16 v[96:111], v[136:139], v[192:195], v[96:111]
    ds_read_b64_tr_b16 v[152:153], v242 offset:36864
    ds_read_b64_tr_b16 v[154:155], v242 offset:37888
    buffer_load_dwordx4 v219, s[8:11], s27 offen offset:3072 lds
    ds_read_b128 v[200:203], v246 offset:32768
    ds_read_b64_tr_b16 v[160:161], v240 offset:40960
    s_waitcnt lgkmcnt(2)
    s_nop 0
    v_mfma_f32_32x32x16_bf16 v[64:79], v[144:147], v[196:199], v[64:79]
    ds_read_b64_tr_b16 v[162:163], v240 offset:41984
    s_add_u32 m0, s29, 116736
    ds_read_b64_tr_b16 v[164:165], v241 offset:40960
    ds_read_b64_tr_b16 v[166:167], v241 offset:41984
    s_add_u32 s27, s27, 128
    ds_read_b64_tr_b16 v[168:169], v242 offset:40960
    v_mfma_f32_16x16x32_bf16 v[232:235], v[144:147], v[236:239], v[232:235]
    ds_read_b64_tr_b16 v[170:171], v242 offset:41984
    v_mfma_f32_32x32x16_bf16 v[80:95], v[148:151], v[196:199], v[80:95]
    buffer_load_dwordx4 v220, s[16:19], s28 offen offset:0 lds
    ds_read_b128 v[204:207], v247 offset:32768
    ds_read_b64_tr_b16 v[176:177], v240 offset:45056
    v_mfma_f32_32x32x16_bf16 v[96:111], v[152:155], v[196:199], v[96:111]
    buffer_load_dwordx4 v221, s[16:19], s28 offen offset:1024 lds
    ds_read_b64_tr_b16 v[178:179], v240 offset:46080
    s_waitcnt lgkmcnt(3)
    s_nop 0
    v_mfma_f32_32x32x16_bf16 v[64:79], v[160:163], v[200:203], v[64:79]
    ds_read_b64_tr_b16 v[180:181], v241 offset:45056
    ds_read_b64_tr_b16 v[182:183], v241 offset:46080
    ds_read_b64_tr_b16 v[184:185], v242 offset:45056
    ds_read_b64_tr_b16 v[186:187], v242 offset:46080
    v_mfma_f32_16x16x32_bf16 v[232:235], v[160:163], v[236:239], v[232:235]
    v_mfma_f32_32x32x16_bf16 v[80:95], v[164:167], v[200:203], v[80:95]
    buffer_load_dwordx4 v222, s[16:19], s28 offen offset:2048 lds
    buffer_load_dwordx4 v223, s[16:19], s28 offen offset:3072 lds
    s_add_u32 s28, s28, 221184
    v_mfma_f32_32x32x16_bf16 v[96:111], v[168:171], v[200:203], v[96:111]
    s_waitcnt vmcnt(16) lgkmcnt(0)
    s_barrier
    v_mfma_f32_32x32x16_bf16 v[64:79], v[176:179], v[204:207], v[64:79]
    ds_read_b128 v[192:195], v244 offset:0
    ds_read_b64_tr_b16 v[128:129], v240 offset:0
    ds_read_b64_tr_b16 v[130:131], v240 offset:1024
    ds_read_b64_tr_b16 v[132:133], v241 offset:0
    ds_read_b64_tr_b16 v[134:135], v241 offset:1024
    ds_read_b64_tr_b16 v[136:137], v242 offset:0
    v_mfma_f32_16x16x32_bf16 v[232:235], v[176:179], v[236:239], v[232:235]
    ds_read_b64_tr_b16 v[138:139], v242 offset:1024
    s_add_u32 m0, s29, 34816
    v_mfma_f32_32x32x16_bf16 v[80:95], v[180:183], v[204:207], v[80:95]
    s_nop 0
    buffer_load_dwordx4 v216, s[8:11], s27 offen offset:0 lds
    v_mfma_f32_32x32x16_bf16 v[96:111], v[184:187], v[204:207], v[96:111]
    buffer_load_dwordx4 v217, s[8:11], s27 offen offset:1024 lds
    s_waitcnt lgkmcnt(0)
    v_mfma_f32_32x32x16_bf16 v[64:79], v[128:131], v[192:195], v[64:79]
    ds_read_b128 v[196:199], v245 offset:0
    ds_read_b64_tr_b16 v[144:145], v240 offset:4096
    ds_read_b64_tr_b16 v[146:147], v240 offset:5120
    v_mfma_f32_16x16x32_bf16 v[232:235], v[128:131], v[236:239], v[232:235]
    v_mfma_f32_32x32x16_bf16 v[80:95], v[132:135], v[192:195], v[80:95]
    buffer_load_dwordx4 v218, s[8:11], s27 offen offset:2048 lds
    ds_read_b64_tr_b16 v[148:149], v241 offset:4096
    ds_read_b64_tr_b16 v[150:151], v241 offset:5120
    v_mfma_f32_32x32x16_bf16 v[96:111], v[136:139], v[192:195], v[96:111]
    ds_read_b64_tr_b16 v[152:153], v242 offset:4096
    ds_read_b64_tr_b16 v[154:155], v242 offset:5120
    buffer_load_dwordx4 v219, s[8:11], s27 offen offset:3072 lds
    ds_read_b128 v[200:203], v246 offset:0
    ds_read_b64_tr_b16 v[160:161], v240 offset:8192
    s_waitcnt lgkmcnt(2)
    s_nop 0
    v_mfma_f32_32x32x16_bf16 v[64:79], v[144:147], v[196:199], v[64:79]
    ds_read_b64_tr_b16 v[162:163], v240 offset:9216
    s_add_u32 m0, s29, 51200
    ds_read_b64_tr_b16 v[164:165], v241 offset:8192
    ds_read_b64_tr_b16 v[166:167], v241 offset:9216
    s_add_u32 s27, s27, 128
    ds_read_b64_tr_b16 v[168:169], v242 offset:8192
    v_mfma_f32_16x16x32_bf16 v[232:235], v[144:147], v[236:239], v[232:235]
    ds_read_b64_tr_b16 v[170:171], v242 offset:9216
    v_mfma_f32_32x32x16_bf16 v[80:95], v[148:151], v[196:199], v[80:95]
    buffer_load_dwordx4 v220, s[16:19], s28 offen offset:0 lds
    ds_read_b128 v[204:207], v247 offset:0
    ds_read_b64_tr_b16 v[176:177], v240 offset:12288
    v_mfma_f32_32x32x16_bf16 v[96:111], v[152:155], v[196:199], v[96:111]
    buffer_load_dwordx4 v221, s[16:19], s28 offen offset:1024 lds
    ds_read_b64_tr_b16 v[178:179], v240 offset:13312
    s_waitcnt lgkmcnt(3)
    s_nop 0
    v_mfma_f32_32x32x16_bf16 v[64:79], v[160:163], v[200:203], v[64:79]
    ds_read_b64_tr_b16 v[180:181], v241 offset:12288
    ds_read_b64_tr_b16 v[182:183], v241 offset:13312
    ds_read_b64_tr_b16 v[184:185], v242 offset:12288
    ds_read_b64_tr_b16 v[186:187], v242 offset:13312
    v_mfma_f32_16x16x32_bf16 v[232:235], v[160:163], v[236:239], v[232:235]
    v_mfma_f32_32x32x16_bf16 v[80:95], v[164:167], v[200:203], v[80:95]
    buffer_load_dwordx4 v222, s[16:19], s28 offen offset:2048 lds
    buffer_load_dwordx4 v223, s[16:19], s28 offen offset:3072 lds
    s_add_u32 s28, s28, 221184
    v_mfma_f32_32x32x16_bf16 v[96:111], v[168:171], v[200:203], v[96:111]
    s_waitcnt vmcnt(16) lgkmcnt(0)
    s_barrier
    v_mfma_f32_32x32x16_bf16 v[64:79], v[176:179], v[204:207], v[64:79]
    ds_read_b128 v[192:195], v212 offset:0
    ds_read_b64_tr_b16 v[128:129], v208 offset:0
    ds_read_b64_tr_b16 v[130:131], v208 offset:1024
    ds_read_b64_tr_b16 v[132:133], v209 offset:0
    ds_read_b64_tr_b16 v[134:135], v209 offset:1024
    ds_read_b64_tr_b16 v[136:137], v210 offset:0
    v_mfma_f32_16x16x32_bf16 v[232:235], v[176:179], v[236:239], v[232:235]
    ds_read_b64_tr_b16 v[138:139], v210 offset:1024
    s_add_u32 m0, s29, 2048
    v_mfma_f32_32x32x16_bf16 v[80:95], v[180:183], v[204:207], v[80:95]
    s_nop 0
    buffer_load_dwordx4 v216, s[8:11], s27 offen offset:0 lds
    v_mfma_f32_32x32x16_bf16 v[96:111], v[184:187], v[204:207], v[96:111]
    buffer_load_dwordx4 v217, s[8:11], s27 offen offset:1024 lds
    s_waitcnt lgkmcnt(0)
    v_mfma_f32_32x32x16_bf16 v[64:79], v[128:131], v[192:195], v[64:79]
    ds_read_b128 v[196:199], v213 offset:0
    ds_read_b64_tr_b16 v[144:145], v208 offset:4096
    ds_read_b64_tr_b16 v[146:147], v208 offset:5120
    v_mfma_f32_16x16x32_bf16 v[232:235], v[128:131], v[236:239], v[232:235]
    v_mfma_f32_32x32x16_bf16 v[80:95], v[132:135], v[192:195], v[80:95]
    buffer_load_dwordx4 v218, s[8:11], s27 offen offset:2048 lds
    ds_read_b64_tr_b16 v[148:149], v209 offset:4096
    ds_read_b64_tr_b16 v[150:151], v209 offset:5120
    v_mfma_f32_32x32x16_bf16 v[96:111], v[136:139], v[192:195], v[96:111]
    ds_read_b64_tr_b16 v[152:153], v210 offset:4096
    ds_read_b64_tr_b16 v[154:155], v210 offset:5120
    buffer_load_dwordx4 v219, s[8:11], s27 offen offset:3072 lds
    ds_read_b128 v[200:203], v214 offset:0
    ds_read_b64_tr_b16 v[160:161], v208 offset:8192
    s_waitcnt lgkmcnt(2)
    s_nop 0
    v_mfma_f32_32x32x16_bf16 v[64:79], v[144:147], v[196:199], v[64:79]
    ds_read_b64_tr_b16 v[162:163], v208 offset:9216
    s_add_u32 m0, s29, 18432
    ds_read_b64_tr_b16 v[164:165], v209 offset:8192
    ds_read_b64_tr_b16 v[166:167], v209 offset:9216
    s_add_u32 s27, s27, 128
    ds_read_b64_tr_b16 v[168:169], v210 offset:8192
    v_mfma_f32_16x16x32_bf16 v[232:235], v[144:147], v[236:239], v[232:235]
    ds_read_b64_tr_b16 v[170:171], v210 offset:9216
    v_mfma_f32_32x32x16_bf16 v[80:95], v[148:151], v[196:199], v[80:95]
    buffer_load_dwordx4 v220, s[16:19], s28 offen offset:0 lds
    ds_read_b128 v[204:207], v215 offset:0
    ds_read_b64_tr_b16 v[176:177], v208 offset:12288
    v_mfma_f32_32x32x16_bf16 v[96:111], v[152:155], v[196:199], v[96:111]
    buffer_load_dwordx4 v221, s[16:19], s28 offen offset:1024 lds
    ds_read_b64_tr_b16 v[178:179], v208 offset:13312
    s_waitcnt lgkmcnt(3)
    s_nop 0
    v_mfma_f32_32x32x16_bf16 v[64:79], v[160:163], v[200:203], v[64:79]
    ds_read_b64_tr_b16 v[180:181], v209 offset:12288
    ds_read_b64_tr_b16 v[182:183], v209 offset:13312
    ds_read_b64_tr_b16 v[184:185], v210 offset:12288
    ds_read_b64_tr_b16 v[186:187], v210 offset:13312
    v_mfma_f32_16x16x32_bf16 v[232:235], v[160:163], v[236:239], v[232:235]
    v_mfma_f32_32x32x16_bf16 v[80:95], v[164:167], v[200:203], v[80:95]
    buffer_load_dwordx4 v222, s[16:19], s28 offen offset:2048 lds
    buffer_load_dwordx4 v223, s[16:19], s28 offen offset:3072 lds
    s_add_u32 s28, s28, 221184
    v_mfma_f32_32x32x16_bf16 v[96:111], v[168:171], v[200:203], v[96:111]
    s_waitcnt vmcnt(16) lgkmcnt(0)
    s_barrier
    v_mfma_f32_32x32x16_bf16 v[64:79], v[176:179], v[204:207], v[64:79]
    ds_read_b128 v[192:195], v212 offset:32768
    ds_read_b64_tr_b16 v[128:129], v208 offset:32768
    ds_read_b64_tr_b16 v[130:131], v208 offset:33792
    ds_read_b64_tr_b16 v[132:133], v209 offset:32768
    ds_read_b64_tr_b16 v[134:135], v209 offset:33792
    ds_read_b64_tr_b16 v[136:137], v210 offset:32768
    v_mfma_f32_16x16x32_bf16 v[232:235], v[176:179], v[236:239], v[232:235]
    ds_read_b64_tr_b16 v[138:139], v210 offset:33792
    s_add_u32 m0, s29, 67584
    v_mfma_f32_32x32x16_bf16 v[80:95], v[180:183], v[204:207], v[80:95]
    s_nop 0
    buffer_load_dwordx4 v216, s[8:11], s27 offen offset:0 lds
    v_mfma_f32_32x32x16_bf16 v[96:111], v[184:187], v[204:207], v[96:111]
    buffer_load_dwordx4 v217, s[8:11], s27 offen offset:1024 lds
    s_waitcnt lgkmcnt(0)
    v_mfma_f32_32x32x16_bf16 v[64:79], v[128:131], v[192:195], v[64:79]
    ds_read_b128 v[196:199], v213 offset:32768
    ds_read_b64_tr_b16 v[144:145], v208 offset:36864
    ds_read_b64_tr_b16 v[146:147], v208 offset:37888
    v_mfma_f32_16x16x32_bf16 v[232:235], v[128:131], v[236:239], v[232:235]
    v_mfma_f32_32x32x16_bf16 v[80:95], v[132:135], v[192:195], v[80:95]
    buffer_load_dwordx4 v218, s[8:11], s27 offen offset:2048 lds
    ds_read_b64_tr_b16 v[148:149], v209 offset:36864
    ds_read_b64_tr_b16 v[150:151], v209 offset:37888
    v_mfma_f32_32x32x16_bf16 v[96:111], v[136:139], v[192:195], v[96:111]
    ds_read_b64_tr_b16 v[152:153], v210 offset:36864
    ds_read_b64_tr_b16 v[154:155], v210 offset:37888
    buffer_load_dwordx4 v219, s[8:11], s27 offen offset:3072 lds
    ds_read_b128 v[200:203], v214 offset:32768
    ds_read_b64_tr_b16 v[160:161], v208 offset:40960
    s_waitcnt lgkmcnt(2)
    s_nop 0
    v_mfma_f32_32x32x16_bf16 v[64:79], v[144:147], v[196:199], v[64:79]
    ds_read_b64_tr_b16 v[162:163], v208 offset:41984
    s_add_u32 m0, s29, 83968
    ds_read_b64_tr_b16 v[164:165], v209 offset:40960
    ds_read_b64_tr_b16 v[166:167], v209 offset:41984
    s_add_u32 s27, s27, 128
    ds_read_b64_tr_b16 v[168:169], v210 offset:40960
    v_mfma_f32_16x16x32_bf16 v[232:235], v[144:147], v[236:239], v[232:235]
    ds_read_b64_tr_b16 v[170:171], v210 offset:41984
    v_mfma_f32_32x32x16_bf16 v[80:95], v[148:151], v[196:199], v[80:95]
    buffer_load_dwordx4 v220, s[16:19], s28 offen offset:0 lds
    ds_read_b128 v[204:207], v215 offset:32768
    ds_read_b64_tr_b16 v[176:177], v208 offset:45056
    v_mfma_f32_32x32x16_bf16 v[96:111], v[152:155], v[196:199], v[96:111]
    buffer_load_dwordx4 v221, s[16:19], s28 offen offset:1024 lds
    ds_read_b64_tr_b16 v[178:179], v208 offset:46080
    s_waitcnt lgkmcnt(3)
    s_nop 0
    v_mfma_f32_32x32x16_bf16 v[64:79], v[160:163], v[200:203], v[64:79]
    ds_read_b64_tr_b16 v[180:181], v209 offset:45056
    ds_read_b64_tr_b16 v[182:183], v209 offset:46080
    ds_read_b64_tr_b16 v[184:185], v210 offset:45056
    ds_read_b64_tr_b16 v[186:187], v210 offset:46080
    v_mfma_f32_16x16x32_bf16 v[232:235], v[160:163], v[236:239], v[232:235]
    v_mfma_f32_32x32x16_bf16 v[80:95], v[164:167], v[200:203], v[80:95]
    buffer_load_dwordx4 v222, s[16:19], s28 offen offset:2048 lds
    buffer_load_dwordx4 v223, s[16:19], s28 offen offset:3072 lds
    s_add_u32 s28, s28, 221184
    v_mfma_f32_32x32x16_bf16 v[96:111], v[168:171], v[200:203], v[96:111]
    s_waitcnt vmcnt(16) lgkmcnt(0)
    s_barrier
    v_mfma_f32_32x32x16_bf16 v[64:79], v[176:179], v[204:207], v[64:79]
    ds_read_b128 v[192:195], v244 offset:32768
    ds_read_b64_tr_b16 v[128:129], v240 offset:32768
    ds_read_b64_tr_b16 v[130:131], v240 offset:33792
    ds_read_b64_tr_b16 v[132:133], v241 offset:32768
    ds_read_b64_tr_b16 v[134:135], v241 offset:33792
    ds_read_b64_tr_b16 v[136:137], v242 offset:32768
    v_mfma_f32_16x16x32_bf16 v[232:235], v[176:179], v[236:239], v[232:235]
    ds_read_b64_tr_b16 v[138:139], v242 offset:33792
    s_add_u32 m0, s29, 100352
    v_mfma_f32_32x32x16_bf16 v[80:95], v[180:183], v[204:207], v[80:95]
    s_nop 0
    buffer_load_dwordx4 v216, s[8:11], s27 offen offset:0 lds
    v_mfma_f32_32x32x16_bf16 v[96:111], v[184:187], v[204:207], v[96:111]
    buffer_load_dwordx4 v217, s[8:11], s27 offen offset:1024 lds
    s_waitcnt lgkmcnt(0)
    v_mfma_f32_32x32x16_bf16 v[64:79], v[128:131], v[192:195], v[64:79]
    ds_read_b128 v[196:199], v245 offset:32768
    ds_read_b64_tr_b16 v[144:145], v240 offset:36864
    ds_read_b64_tr_b16 v[146:147], v240 offset:37888
    v_mfma_f32_16x16x32_bf16 v[232:235], v[128:131], v[236:239], v[232:235]
    v_mfma_f32_32x32x16_bf16 v[80:95], v[132:135], v[192:195], v[80:95]
    buffer_load_dwordx4 v218, s[8:11], s27 offen offset:2048 lds
    ds_read_b64_tr_b16 v[148:149], v241 offset:36864
    ds_read_b64_tr_b16 v[150:151], v241 offset:37888
    v_mfma_f32_32x32x16_bf16 v[96:111], v[136:139], v[192:195], v[96:111]
    ds_read_b64_tr_b16 v[152:153], v242 offset:36864
    ds_read_b64_tr_b16 v[154:155], v242 offset:37888
    buffer_load_dwordx4 v219, s[8:11], s27 offen offset:3072 lds
    ds_read_b128 v[200:203], v246 offset:32768
    ds_read_b64_tr_b16 v[160:161], v240 offset:40960
    s_waitcnt lgkmcnt(2)
    s_nop 0
    v_mfma_f32_32x32x16_bf16 v[64:79], v[144:147], v[196:199], v[64:79]
    ds_read_b64_tr_b16 v[162:163], v240 offset:41984
    s_add_u32 m0, s29, 116736
    ds_read_b64_tr_b16 v[164:165], v241 offset:40960
    ds_read_b64_tr_b16 v[166:167], v241 offset:41984
    s_add_u32 s27, s27, 128
    ds_read_b64_tr_b16 v[168:169], v242 offset:40960
    v_mfma_f32_16x16x32_bf16 v[232:235], v[144:147], v[236:239], v[232:235]
    ds_read_b64_tr_b16 v[170:171], v242 offset:41984
    v_mfma_f32_32x32x16_bf16 v[80:95], v[148:151], v[196:199], v[80:95]
    buffer_load_dwordx4 v220, s[16:19], s28 offen offset:0 lds
    ds_read_b128 v[204:207], v247 offset:32768
    ds_read_b64_tr_b16 v[176:177], v240 offset:45056
    v_mfma_f32_32x32x16_bf16 v[96:111], v[152:155], v[196:199], v[96:111]
    buffer_load_dwordx4 v221, s[16:19], s28 offen offset:1024 lds
    ds_read_b64_tr_b16 v[178:179], v240 offset:46080
    s_waitcnt lgkmcnt(3)
    s_nop 0
    v_mfma_f32_32x32x16_bf16 v[64:79], v[160:163], v[200:203], v[64:79]
    ds_read_b64_tr_b16 v[180:181], v241 offset:45056
    ds_read_b64_tr_b16 v[182:183], v241 offset:46080
    ds_read_b64_tr_b16 v[184:185], v242 offset:45056
    ds_read_b64_tr_b16 v[186:187], v242 offset:46080
    v_mfma_f32_16x16x32_bf16 v[232:235], v[160:163], v[236:239], v[232:235]
    v_mfma_f32_32x32x16_bf16 v[80:95], v[164:167], v[200:203], v[80:95]
    buffer_load_dwordx4 v222, s[16:19], s28 offen offset:2048 lds
    buffer_load_dwordx4 v223, s[16:19], s28 offen offset:3072 lds
    s_add_u32 s28, s28, 221184
    v_mfma_f32_32x32x16_bf16 v[96:111], v[168:171], v[200:203], v[96:111]
    s_waitcnt vmcnt(16) lgkmcnt(0)
    s_barrier
    v_mfma_f32_32x32x16_bf16 v[64:79], v[176:179], v[204:207], v[64:79]
    ds_read_b128 v[192:195], v244 offset:0
    ds_read_b64_tr_b16 v[128:129], v240 offset:0
    ds_read_b64_tr_b16 v[130:131], v240 offset:1024
    ds_read_b64_tr_b16 v[132:133], v241 offset:0
    ds_read_b64_tr_b16 v[134:135], v241 offset:1024
    ds_read_b64_tr_b16 v[136:137], v242 offset:0
    v_mfma_f32_16x16x32_bf16 v[232:235], v[176:179], v[236:239], v[232:235]
    ds_read_b64_tr_b16 v[138:139], v242 offset:1024
    v_mfma_f32_32x32x16_bf16 v[80:95], v[180:183], v[204:207], v[80:95]
    v_mfma_f32_32x32x16_bf16 v[96:111], v[184:187], v[204:207], v[96:111]
    s_waitcnt lgkmcnt(0)
    s_nop 0
    v_mfma_f32_32x32x16_bf16 v[64:79], v[128:131], v[192:195], v[64:79]
    ds_read_b128 v[196:199], v245 offset:0
    ds_read_b64_tr_b16 v[144:145], v240 offset:4096
    ds_read_b64_tr_b16 v[146:147], v240 offset:5120
    ds_read_b64_tr_b16 v[148:149], v241 offset:4096
    ds_read_b64_tr_b16 v[150:151], v241 offset:5120
    ds_read_b64_tr_b16 v[152:153], v242 offset:4096
    v_mfma_f32_16x16x32_bf16 v[232:235], v[128:131], v[236:239], v[232:235]
    ds_read_b64_tr_b16 v[154:155], v242 offset:5120
    ds_read_b128 v[200:203], v246 offset:0
    v_mfma_f32_32x32x16_bf16 v[80:95], v[132:135], v[192:195], v[80:95]
    ds_read_b64_tr_b16 v[160:161], v240 offset:8192
    v_mfma_f32_32x32x16_bf16 v[96:111], v[136:139], v[192:195], v[96:111]
    s_waitcnt lgkmcnt(2)
    v_mfma_f32_32x32x16_bf16 v[64:79], v[144:147], v[196:199], v[64:79]
    ds_read_b64_tr_b16 v[162:163], v240 offset:9216
    ds_read_b64_tr_b16 v[164:165], v241 offset:8192
    s_mov_b32 s20, s62
    s_mov_b32 s21, s63
    s_nop 0
    s_mov_b32 s22, 256
    s_mov_b32 s23, 0x00020000
    ds_read_b64_tr_b16 v[166:167], v241 offset:9216
    ds_read_b64_tr_b16 v[168:169], v242 offset:8192
    ds_read_b64_tr_b16 v[170:171], v242 offset:9216
    v_mfma_f32_16x16x32_bf16 v[232:235], v[144:147], v[236:239], v[232:235]
    ds_read_b128 v[204:207], v247 offset:0
    v_mfma_f32_32x32x16_bf16 v[80:95], v[148:151], v[196:199], v[80:95]
    buffer_load_dword v56, v37, s[20:23], 0 offen sc1
    ds_read_b64_tr_b16 v[176:177], v240 offset:12288
    ds_read_b64_tr_b16 v[178:179], v240 offset:13312
    v_mfma_f32_32x32x16_bf16 v[96:111], v[152:155], v[196:199], v[96:111]
    s_waitcnt lgkmcnt(3)
    s_nop 0
    v_mfma_f32_32x32x16_bf16 v[64:79], v[160:163], v[200:203], v[64:79]
    ds_read_b64_tr_b16 v[180:181], v241 offset:12288
    ds_read_b64_tr_b16 v[182:183], v241 offset:13312
    ds_read_b64_tr_b16 v[184:185], v242 offset:12288
    ds_read_b64_tr_b16 v[186:187], v242 offset:13312
    v_mfma_f32_16x16x32_bf16 v[232:235], v[160:163], v[236:239], v[232:235]
    v_mfma_f32_32x32x16_bf16 v[80:95], v[164:167], v[200:203], v[80:95]
    v_mfma_f32_32x32x16_bf16 v[96:111], v[168:171], v[200:203], v[96:111]
    s_waitcnt vmcnt(9) lgkmcnt(0)
    s_barrier
    v_mfma_f32_32x32x16_bf16 v[64:79], v[176:179], v[204:207], v[64:79]
    ds_read_b128 v[192:195], v212 offset:0
    ds_read_b64_tr_b16 v[128:129], v208 offset:0
    ds_read_b64_tr_b16 v[130:131], v208 offset:1024
    ds_read_b64_tr_b16 v[132:133], v209 offset:0
    ds_read_b64_tr_b16 v[134:135], v209 offset:1024
    ds_read_b64_tr_b16 v[136:137], v210 offset:0
    v_mfma_f32_16x16x32_bf16 v[232:235], v[176:179], v[236:239], v[232:235]
    ds_read_b64_tr_b16 v[138:139], v210 offset:1024
    v_mfma_f32_32x32x16_bf16 v[80:95], v[180:183], v[204:207], v[80:95]
    v_mfma_f32_32x32x16_bf16 v[96:111], v[184:187], v[204:207], v[96:111]
    s_waitcnt lgkmcnt(0)
    s_nop 0
    v_mfma_f32_32x32x16_bf16 v[64:79], v[128:131], v[192:195], v[64:79]
    ds_read_b128 v[196:199], v213 offset:0
    ds_read_b64_tr_b16 v[144:145], v208 offset:4096
    ds_read_b64_tr_b16 v[146:147], v208 offset:5120
    ds_read_b64_tr_b16 v[148:149], v209 offset:4096
    ds_read_b64_tr_b16 v[150:151], v209 offset:5120
    ds_read_b64_tr_b16 v[152:153], v210 offset:4096
    v_mfma_f32_16x16x32_bf16 v[232:235], v[128:131], v[236:239], v[232:235]
    ds_read_b64_tr_b16 v[154:155], v210 offset:5120
    ds_read_b128 v[200:203], v214 offset:0
    v_mfma_f32_32x32x16_bf16 v[80:95], v[132:135], v[192:195], v[80:95]
    ds_read_b64_tr_b16 v[160:161], v208 offset:8192
    v_mfma_f32_32x32x16_bf16 v[96:111], v[136:139], v[192:195], v[96:111]
    s_waitcnt lgkmcnt(2)
    s_nop 0
    v_mfma_f32_32x32x16_bf16 v[64:79], v[144:147], v[196:199], v[64:79]
    ds_read_b64_tr_b16 v[162:163], v208 offset:9216
    ds_read_b64_tr_b16 v[164:165], v209 offset:8192
    ds_read_b64_tr_b16 v[166:167], v209 offset:9216
    ds_read_b64_tr_b16 v[168:169], v210 offset:8192
    ds_read_b64_tr_b16 v[170:171], v210 offset:9216
    ds_read_b128 v[204:207], v215 offset:0
    v_mfma_f32_16x16x32_bf16 v[232:235], v[144:147], v[236:239], v[232:235]
    ds_read_b64_tr_b16 v[176:177], v208 offset:12288
    ds_read_b64_tr_b16 v[178:179], v208 offset:13312
    v_mfma_f32_32x32x16_bf16 v[80:95], v[148:151], v[196:199], v[80:95]
    v_mfma_f32_32x32x16_bf16 v[96:111], v[152:155], v[196:199], v[96:111]
    s_waitcnt vmcnt(63)
    v_lshlrev_b32 v229, 16, v229
    ds_write_b32 v228, v229
    s_waitcnt lgkmcnt(4)
    s_nop 0
    v_mfma_f32_32x32x16_bf16 v[64:79], v[160:163], v[200:203], v[64:79]
    ds_read_b64_tr_b16 v[180:181], v209 offset:12288
    ds_read_b64_tr_b16 v[182:183], v209 offset:13312
    ds_read_b64_tr_b16 v[184:185], v210 offset:12288
    ds_read_b64_tr_b16 v[186:187], v210 offset:13312
    v_mfma_f32_16x16x32_bf16 v[232:235], v[160:163], v[236:239], v[232:235]
    v_mfma_f32_32x32x16_bf16 v[80:95], v[164:167], v[200:203], v[80:95]
    v_mfma_f32_32x32x16_bf16 v[96:111], v[168:171], v[200:203], v[96:111]
    s_waitcnt vmcnt(1) lgkmcnt(0)
    s_mov_b32 s5, 0
    s_cmp_lg_u32 s3, 0
    s_cbranch_scc1 L_pok_42
    s_waitcnt vmcnt(0)
L_ptop_43:
    v_cmp_gt_u32 vcc, 0x80, v56
    s_and_b32 s6, vcc_lo, 3
    s_cbranch_scc0 L_pok_42
    s_add_u32 s5, s5, 1
    s_cmp_gt_u32 s5, 200000
    s_cbranch_scc1 L_pok_42
    s_sleep 8
L_pld_44:
    s_mov_b64 exec, 3
    buffer_load_dword v56, v37, s[20:23], 0 offen sc1
    s_mov_b64 exec, -1
    s_waitcnt vmcnt(0)
    s_branch L_ptop_43
L_pok_42:
    s_barrier
    s_nop 0
    v_mfma_f32_32x32x16_bf16 v[64:79], v[176:179], v[204:207], v[64:79]
    ds_read_b128 v[192:195], v212 offset:32768
    ds_read_b64_tr_b16 v[128:129], v208 offset:32768
    ds_read_b64_tr_b16 v[130:131], v208 offset:33792
    ds_read_b64_tr_b16 v[132:133], v209 offset:32768
    ds_read_b64_tr_b16 v[134:135], v209 offset:33792
    ds_read_b64_tr_b16 v[136:137], v210 offset:32768
    v_mfma_f32_16x16x32_bf16 v[232:235], v[176:179], v[236:239], v[232:235]
    ds_read_b64_tr_b16 v[138:139], v210 offset:33792
    v_mfma_f32_32x32x16_bf16 v[80:95], v[180:183], v[204:207], v[80:95]
    v_mfma_f32_32x32x16_bf16 v[96:111], v[184:187], v[204:207], v[96:111]
    v_and_b32 v2, 31, v0
    v_lshlrev_b32_e64 v2, 4, v2
    s_lshl_b32 s4, s3, 5
    s_add_u32 s4, s4, s24
    s_lshl_b32 s4, s4, 4
    s_add_u32 s4, s4, 2621440
    buffer_load_dwordx2 v[226:227], v2, s[12:15], s4 offen sc1
    v_lshlrev_b32_e64 v252, 4, v0
    s_mul_i32 s4, s75, 5120
    s_mul_i32 s5, s3, 40960
    s_add_u32 s4, s4, s5
    s_add_u32 s77, s4, 5308416
    s_add_u32 s73, s77, 4096
    s_mov_b32 s44, 0
    s_sub_u32 s38, 13, s44
    s_cmp_lt_u32 s3, 2
    s_cselect_b32 s6, 0, 16777216
    s_add_u32 s39, s6, 163840
    s_sub_u32 s40, -2129920, s6
    s_add_u32 s41, s6, 4096
    s_sub_u32 s42, -53248, s6
    s_cmp_eq_u32 s38, 0
    s_cselect_b32 s31, s6, 0
    s_mul_i32 s4, s44, 163840
    s_add_u32 s4, s4, s31
    v_add_u32_e64 v253, s4, v252
    s_waitcnt lgkmcnt(0)
    v_mfma_f32_32x32x16_bf16 v[64:79], v[128:131], v[192:195], v[64:79]
    ds_read_b128 v[196:199], v213 offset:32768
    ds_read_b64_tr_b16 v[144:145], v208 offset:36864
    buffer_load_dwordx4 a[0:3], v253, s[12:15], s77 offen offset:0 sc1
    v_mfma_f32_16x16x32_bf16 v[232:235], v[128:131], v[236:239], v[232:235]
    ds_read_b64_tr_b16 v[146:147], v208 offset:37888
    ds_read_b64_tr_b16 v[148:149], v209 offset:36864
    v_mfma_f32_32x32x16_bf16 v[80:95], v[132:135], v[192:195], v[80:95]
    ds_read_b64_tr_b16 v[150:151], v209 offset:37888
    buffer_load_dwordx4 a[4:7], v253, s[12:15], s77 offen offset:1024 sc1
    ds_read_b64_tr_b16 v[152:153], v210 offset:36864
    v_mfma_f32_32x32x16_bf16 v[96:111], v[136:139], v[192:195], v[96:111]
    ds_read_b64_tr_b16 v[154:155], v210 offset:37888
    ds_read_b128 v[200:203], v214 offset:32768
    buffer_load_dwordx4 a[8:11], v253, s[12:15], s77 offen offset:2048 sc1
    ds_read_b64_tr_b16 v[160:161], v208 offset:40960
    s_waitcnt lgkmcnt(2)
    s_nop 0
    v_mfma_f32_32x32x16_bf16 v[64:79], v[144:147], v[196:199], v[64:79]
    ds_read_b64_tr_b16 v[162:163], v208 offset:41984
    buffer_load_dwordx4 a[12:15], v253, s[12:15], s77 offen offset:3072 sc1
    ds_read_b64_tr_b16 v[164:165], v209 offset:40960
    v_mfma_f32_16x16x32_bf16 v[232:235], v[144:147], v[236:239], v[232:235]
    ds_read_b64_tr_b16 v[166:167], v209 offset:41984
    v_mfma_f32_32x32x16_bf16 v[80:95], v[148:151], v[196:199], v[80:95]
    buffer_load_dwordx4 a[16:19], v253, s[12:15], s73 offen offset:0 sc1
    ds_read_b64_tr_b16 v[168:169], v210 offset:40960
    ds_read_b64_tr_b16 v[170:171], v210 offset:41984
    v_mfma_f32_32x32x16_bf16 v[96:111], v[152:155], v[196:199], v[96:111]
    s_cmp_eq_u32 s38, 1
    s_cselect_b32 s43, s39, 163840
    s_cmp_eq_u32 s38, 0
    s_cselect_b32 s43, s40, s43
    v_add_u32 v253, s43, v253
    ds_read_b128 v[204:207], v215 offset:32768
    ds_read_b64_tr_b16 v[176:177], v208 offset:45056
    buffer_load_dwordx4 a[20:23], v253, s[12:15], s77 offen offset:0 sc1
    ds_read_b64_tr_b16 v[178:179], v208 offset:46080
    s_waitcnt lgkmcnt(3)
    s_nop 0
    v_mfma_f32_32x32x16_bf16 v[64:79], v[160:163], v[200:203], v[64:79]
    ds_read_b64_tr_b16 v[180:181], v209 offset:45056
    ds_read_b64_tr_b16 v[182:183], v209 offset:46080
    ds_read_b64_tr_b16 v[184:185], v210 offset:45056
    ds_read_b64_tr_b16 v[186:187], v210 offset:46080
    v_mfma_f32_16x16x32_bf16 v[232:235], v[160:163], v[236:239], v[232:235]
    v_mfma_f32_32x32x16_bf16 v[80:95], v[164:167], v[200:203], v[80:95]
    buffer_load_dwordx4 a[24:27], v253, s[12:15], s77 offen offset:1024 sc1
    buffer_load_dwordx4 a[28:31], v253, s[12:15], s77 offen offset:2048 sc1
    buffer_load_dwordx4 a[32:35], v253, s[12:15], s77 offen offset:3072 sc1
    v_mfma_f32_32x32x16_bf16 v[96:111], v[168:171], v[200:203], v[96:111]
    s_waitcnt lgkmcnt(0)
    v_mfma_f32_32x32x16_bf16 v[64:79], v[176:179], v[204:207], v[64:79]
    v_mfma_f32_16x16x32_bf16 v[232:235], v[176:179], v[236:239], v[232:235]
    v_and_b32 v2, 15, v0
    v_lshrrev_b32 v3, 4, v0
    v_lshlrev_b32 v3, 4, v3
    v_lshl_add_u32 v3, v2, 6, v3
    v_mfma_f32_32x32x16_bf16 v[80:95], v[180:183], v[204:207], v[80:95]
    s_lshl_b32 s4, s66, 7
    s_add_u32 s4, s4, 133120
    v_add_u32 v3, s4, v3
    v_cmp_gt_u32_e64 vcc, 2, v2
    v_mfma_f32_32x32x16_bf16 v[96:111], v[184:187], v[204:207], v[96:111]
    s_and_saveexec_b64 s[6:7], vcc
    ds_write_b128 v3, v[232:235]
    s_mov_b64 exec, s[6:7]
    s_waitcnt lgkmcnt(0)
    s_barrier
    v_lshrrev_b32_e64 v2, 2, v0
    v_mul_u32_u24 v2, 10240, v2
    v_and_b32 v3, 3, v0
    v_lshrrev_b32 v4, 4, v0
    v_xor_b32_e64 v3, v3, v4
    v_lshl_add_u32 v2, v3, 4, v2
    s_mul_i32 s4, s3, 655360
    s_lshl_b32 s5, s70, 4
    s_add_u32 s4, s4, s5
    buffer_load_dwordx4 v[232:235], v2, s[12:15], s4 offen sc1
    s_add_u32 s4, s4, 163840
    buffer_load_dwordx4 v[236:239], v2, s[12:15], s4 offen sc1
    s_add_u32 s4, s4, 163840
    buffer_load_dwordx4 v[240:243], v2, s[12:15], s4 offen sc1
    s_add_u32 s4, s4, 163840
    buffer_load_dwordx4 v[244:247], v2, s[12:15], s4 offen sc1
    s_lshl_b32 s4, s66, 7
    s_add_u32 s4, s4, 133120
    v_add_u32 v6, s4, v60
    ds_read_b128 v[8:11], v6 offset:0
    ds_read_b128 v[24:27], v6 offset:512
    ds_read_b128 v[12:15], v6 offset:32
    ds_read_b128 v[28:31], v6 offset:544
    ds_read_b128 v[16:19], v6 offset:64
    ds_read_b128 v[32:35], v6 offset:576
    ds_read_b128 v[20:23], v6 offset:96
    ds_read_b128 v[36:39], v6 offset:608
    s_lshr_b32 s5, s24, 4
    s_lshl_b32 s6, s3, 1
    s_add_u32 s5, s5, s6
    s_mul_i32 s5, s5, 54
    s_add_u32 s5, s5, s25
    s_sub_u32 s5, s5, s32
    s_lshl_b32 s5, s5, 10
    s_add_u32 s33, s5, 7536640
    s_mov_b32 s34, 0xc0135761
    s_mov_b32 s35, 0xbdd2d3e8
    buffer_load_dwordx4 a[36:39], v253, s[12:15], s73 offen offset:0 sc1
    s_cmp_eq_u32 s38, 2
    s_cselect_b32 s43, s39, 163840
    s_cmp_eq_u32 s38, 1
    s_cselect_b32 s43, s40, s43
    v_add_u32_e64 v253, s43, v253
    s_waitcnt vmcnt(14)
    s_lshl_b32 s4, s67, 7
    s_add_u32 s4, s4, 133120
    v_add_u32_e64 v6, s4, v60
    ds_read_b128 v[192:195], v6 offset:0
    ds_read_b128 v[208:211], v6 offset:512
    ds_read_b128 v[196:199], v6 offset:32
    ds_read_b128 v[212:215], v6 offset:544
    ds_read_b128 v[200:203], v6 offset:64
    ds_read_b128 v[216:219], v6 offset:576
    ds_read_b128 v[204:207], v6 offset:96
    ds_read_b128 v[220:223], v6 offset:608
    s_waitcnt lgkmcnt(8)
    s_nop 0
    v_pk_fma_f32 v[8:9], v[8:9], v[226:227], v[24:25] op_sel:[0,1,0] op_sel_hi:[1,1,1]
    buffer_load_dwordx4 a[40:43], v253, s[12:15], s77 offen offset:0 sc1
    v_pk_fma_f32 v[10:11], v[10:11], v[226:227], v[26:27] op_sel:[0,1,0] op_sel_hi:[1,1,1]
    v_pk_fma_f32 v[12:13], v[12:13], v[226:227], v[28:29] op_sel:[0,1,0] op_sel_hi:[1,1,1]
    v_pk_fma_f32 v[14:15], v[14:15], v[226:227], v[30:31] op_sel:[0,1,0] op_sel_hi:[1,1,1]
    v_pk_fma_f32 v[16:17], v[16:17], v[226:227], v[32:33] op_sel:[0,1,0] op_sel_hi:[1,1,1]
    v_pk_fma_f32 v[18:19], v[18:19], v[226:227], v[34:35] op_sel:[0,1,0] op_sel_hi:[1,1,1]
    v_pk_fma_f32 v[20:21], v[20:21], v[226:227], v[36:37] op_sel:[0,1,0] op_sel_hi:[1,1,1]
    v_pk_fma_f32 v[22:23], v[22:23], v[226:227], v[38:39] op_sel:[0,1,0] op_sel_hi:[1,1,1]
    v_pk_fma_f32 v[128:129], v[64:65], v[226:227], v[8:9] op_sel:[0,0,0] op_sel_hi:[1,0,1]
    v_pk_fma_f32 v[130:131], v[66:67], v[226:227], v[10:11] op_sel:[0,0,0] op_sel_hi:[1,0,1]
    v_pk_fma_f32 v[132:133], v[68:69], v[226:227], v[12:13] op_sel:[0,0,0] op_sel_hi:[1,0,1]
    v_pk_fma_f32 v[134:135], v[70:71], v[226:227], v[14:15] op_sel:[0,0,0] op_sel_hi:[1,0,1]
    v_pk_fma_f32 v[136:137], v[72:73], v[226:227], v[16:17] op_sel:[0,0,0] op_sel_hi:[1,0,1]
    v_pk_fma_f32 v[138:139], v[74:75], v[226:227], v[18:19] op_sel:[0,0,0] op_sel_hi:[1,0,1]
    v_pk_fma_f32 v[140:141], v[76:77], v[226:227], v[20:21] op_sel:[0,0,0] op_sel_hi:[1,0,1]
    v_pk_fma_f32 v[142:143], v[78:79], v[226:227], v[22:23] op_sel:[0,0,0] op_sel_hi:[1,0,1]
    v_pk_mul_f32 v[144:145], v[128:129], v[128:129]
    v_pk_mul_f32 v[146:147], v[130:131], v[130:131]
    buffer_load_dwordx4 a[44:47], v253, s[12:15], s77 offen offset:1024 sc1
    v_pk_mul_f32 v[148:149], v[132:133], v[132:133]
    v_pk_mul_f32 v[150:151], v[134:135], v[134:135]
    v_pk_mul_f32 v[152:153], v[136:137], v[136:137]
    v_pk_mul_f32 v[154:155], v[138:139], v[138:139]
    v_pk_mul_f32 v[156:157], v[140:141], v[140:141]
    v_pk_mul_f32 v[158:159], v[142:143], v[142:143]
    v_pk_fma_f32 v[144:145], v[144:145], s[34:35], s[34:35] op_sel:[0,1,0] op_sel_hi:[1,1,0]
    v_pk_fma_f32 v[146:147], v[146:147], s[34:35], s[34:35] op_sel:[0,1,0] op_sel_hi:[1,1,0]
    v_pk_fma_f32 v[148:149], v[148:149], s[34:35], s[34:35] op_sel:[0,1,0] op_sel_hi:[1,1,0]
    v_pk_fma_f32 v[150:151], v[150:151], s[34:35], s[34:35] op_sel:[0,1,0] op_sel_hi:[1,1,0]
    v_pk_fma_f32 v[152:153], v[152:153], s[34:35], s[34:35] op_sel:[0,1,0] op_sel_hi:[1,1,0]
    v_pk_fma_f32 v[154:155], v[154:155], s[34:35], s[34:35] op_sel:[0,1,0] op_sel_hi:[1,1,0]
    v_pk_fma_f32 v[156:157], v[156:157], s[34:35], s[34:35] op_sel:[0,1,0] op_sel_hi:[1,1,0]
    v_pk_fma_f32 v[158:159], v[158:159], s[34:35], s[34:35] op_sel:[0,1,0] op_sel_hi:[1,1,0]
    v_pk_mul_f32 v[144:145], v[144:145], v[128:129]
    v_pk_mul_f32 v[146:147], v[146:147], v[130:131]
    v_pk_mul_f32 v[148:149], v[148:149], v[132:133]
    v_pk_mul_f32 v[150:151], v[150:151], v[134:135]
    buffer_load_dwordx4 a[48:51], v253, s[12:15], s77 offen offset:2048 sc1
    v_pk_mul_f32 v[152:153], v[152:153], v[136:137]
    v_pk_mul_f32 v[154:155], v[154:155], v[138:139]
    v_pk_mul_f32 v[156:157], v[156:157], v[140:141]
    v_pk_mul_f32 v[158:159], v[158:159], v[142:143]
    v_exp_f32 v144, v144
    v_exp_f32 v145, v145
    v_exp_f32 v146, v146
    v_exp_f32 v147, v147
    v_exp_f32 v148, v148
    v_exp_f32 v149, v149
    v_exp_f32_e64 v150, v150
    buffer_load_dwordx4 a[52:55], v253, s[12:15], s77 offen offset:3072 sc1
    v_exp_f32 v151, v151
    v_exp_f32 v152, v152
    v_exp_f32 v153, v153
    v_exp_f32 v154, v154
    v_exp_f32 v155, v155
    v_exp_f32 v156, v156
    v_exp_f32 v157, v157
    v_exp_f32 v158, v158
    v_exp_f32_e64 v159, v159
    v_pk_add_f32 v[144:145], v[144:145], 1.0 op_sel_hi:[1,0]
    v_pk_add_f32 v[146:147], v[146:147], 1.0 op_sel_hi:[1,0]
    v_pk_add_f32 v[148:149], v[148:149], 1.0 op_sel_hi:[1,0]
    v_pk_add_f32 v[150:151], v[150:151], 1.0 op_sel_hi:[1,0]
    v_pk_add_f32 v[152:153], v[152:153], 1.0 op_sel_hi:[1,0]
    v_pk_add_f32 v[154:155], v[154:155], 1.0 op_sel_hi:[1,0]
    v_pk_add_f32 v[156:157], v[156:157], 1.0 op_sel_hi:[1,0]
    v_pk_add_f32 v[158:159], v[158:159], 1.0 op_sel_hi:[1,0]
    v_rcp_f32 v144, v144
    v_rcp_f32 v145, v145
    v_rcp_f32 v146, v146
    v_rcp_f32 v147, v147
    v_rcp_f32 v148, v148
    v_rcp_f32 v149, v149
    v_rcp_f32 v150, v150
    v_rcp_f32 v151, v151
    v_rcp_f32 v152, v152
    v_rcp_f32 v153, v153
    v_rcp_f32 v154, v154
    v_rcp_f32 v155, v155
    v_rcp_f32 v156, v156
    v_rcp_f32 v157, v157
    v_rcp_f32 v158, v158
    v_rcp_f32 v159, v159
    v_pk_mul_f32 v[144:145], v[144:145], v[128:129]
    v_pk_mul_f32 v[146:147], v[146:147], v[130:131]
    v_pk_mul_f32 v[148:149], v[148:149], v[132:133]
    v_pk_mul_f32 v[150:151], v[150:151], v[134:135]
    v_pk_mul_f32 v[152:153], v[152:153], v[136:137]
    v_pk_mul_f32 v[154:155], v[154:155], v[138:139]
    v_pk_mul_f32 v[156:157], v[156:157], v[140:141]
    v_pk_mul_f32 v[158:159], v[158:159], v[142:143]
    v_cvt_pk_bf16_f32 v160, v144, v145
    v_cvt_pk_bf16_f32 v161, v146, v147
    v_cvt_pk_bf16_f32 v162, v148, v149
    v_cvt_pk_bf16_f32 v163, v150, v151
    v_cvt_pk_bf16_f32 v164, v152, v153
    v_cvt_pk_bf16_f32 v165, v154, v155
    v_cvt_pk_bf16_f32 v166, v156, v157
    v_cvt_pk_bf16_f32 v167, v158, v159
    s_lshl_b32 s4, s66, 10
    s_add_u32 s4, s4, s33
    buffer_store_dwordx4 v[160:163], v59, s[12:15], s4 offen sc1
    buffer_store_dwordx4 v[164:167], v59, s[12:15], s4 offen offset:512 sc1
    s_lshl_b32 s4, s68, 7
    s_add_u32 s4, s4, 133120
    v_add_u32 v6, s4, v60
    ds_read_b128 v[8:11], v6 offset:0
    ds_read_b128 v[24:27], v6 offset:512
    ds_read_b128 v[12:15], v6 offset:32
    ds_read_b128 v[28:31], v6 offset:544
    ds_read_b128 v[16:19], v6 offset:64
    ds_read_b128 v[32:35], v6 offset:576
    ds_read_b128 v[20:23], v6 offset:96
    ds_read_b128 v[36:39], v6 offset:608
    s_waitcnt lgkmcnt(8)
    s_nop 0
    v_pk_fma_f32 v[192:193], v[192:193], v[226:227], v[208:209] op_sel:[0,1,0] op_sel_hi:[1,1,1]
    v_pk_fma_f32 v[194:195], v[194:195], v[226:227], v[210:211] op_sel:[0,1,0] op_sel_hi:[1,1,1]
    v_pk_fma_f32 v[196:197], v[196:197], v[226:227], v[212:213] op_sel:[0,1,0] op_sel_hi:[1,1,1]
    v_pk_fma_f32 v[198:199], v[198:199], v[226:227], v[214:215] op_sel:[0,1,0] op_sel_hi:[1,1,1]
    v_pk_fma_f32 v[200:201], v[200:201], v[226:227], v[216:217] op_sel:[0,1,0] op_sel_hi:[1,1,1]
    v_pk_fma_f32 v[202:203], v[202:203], v[226:227], v[218:219] op_sel:[0,1,0] op_sel_hi:[1,1,1]
    v_pk_fma_f32 v[204:205], v[204:205], v[226:227], v[220:221] op_sel:[0,1,0] op_sel_hi:[1,1,1]
    v_pk_fma_f32 v[206:207], v[206:207], v[226:227], v[222:223] op_sel:[0,1,0] op_sel_hi:[1,1,1]
    v_pk_fma_f32 v[128:129], v[80:81], v[226:227], v[192:193] op_sel:[0,0,0] op_sel_hi:[1,0,1]
    v_pk_fma_f32 v[130:131], v[82:83], v[226:227], v[194:195] op_sel:[0,0,0] op_sel_hi:[1,0,1]
    v_pk_fma_f32 v[132:133], v[84:85], v[226:227], v[196:197] op_sel:[0,0,0] op_sel_hi:[1,0,1]
    v_pk_fma_f32 v[134:135], v[86:87], v[226:227], v[198:199] op_sel:[0,0,0] op_sel_hi:[1,0,1]
    v_pk_fma_f32 v[136:137], v[88:89], v[226:227], v[200:201] op_sel:[0,0,0] op_sel_hi:[1,0,1]
    v_pk_fma_f32 v[138:139], v[90:91], v[226:227], v[202:203] op_sel:[0,0,0] op_sel_hi:[1,0,1]
    v_pk_fma_f32 v[140:141], v[92:93], v[226:227], v[204:205] op_sel:[0,0,0] op_sel_hi:[1,0,1]
    v_pk_fma_f32 v[142:143], v[94:95], v[226:227], v[206:207] op_sel:[0,0,0] op_sel_hi:[1,0,1]
    v_pk_mul_f32 v[144:145], v[128:129], v[128:129]
    v_pk_mul_f32 v[146:147], v[130:131], v[130:131]
    v_pk_mul_f32 v[148:149], v[132:133], v[132:133]
    v_pk_mul_f32 v[150:151], v[134:135], v[134:135]
    v_pk_mul_f32 v[152:153], v[136:137], v[136:137]
    v_pk_mul_f32 v[154:155], v[138:139], v[138:139]
    v_pk_mul_f32 v[156:157], v[140:141], v[140:141]
    v_pk_mul_f32 v[158:159], v[142:143], v[142:143]
    v_pk_fma_f32 v[144:145], v[144:145], s[34:35], s[34:35] op_sel:[0,1,0] op_sel_hi:[1,1,0]
    v_pk_fma_f32 v[146:147], v[146:147], s[34:35], s[34:35] op_sel:[0,1,0] op_sel_hi:[1,1,0]
    v_pk_fma_f32 v[148:149], v[148:149], s[34:35], s[34:35] op_sel:[0,1,0] op_sel_hi:[1,1,0]
    v_pk_fma_f32 v[150:151], v[150:151], s[34:35], s[34:35] op_sel:[0,1,0] op_sel_hi:[1,1,0]
    v_pk_fma_f32 v[152:153], v[152:153], s[34:35], s[34:35] op_sel:[0,1,0] op_sel_hi:[1,1,0]
    v_pk_fma_f32 v[154:155], v[154:155], s[34:35], s[34:35] op_sel:[0,1,0] op_sel_hi:[1,1,0]
    v_pk_fma_f32 v[156:157], v[156:157], s[34:35], s[34:35] op_sel:[0,1,0] op_sel_hi:[1,1,0]
    v_pk_fma_f32 v[158:159], v[158:159], s[34:35], s[34:35] op_sel:[0,1,0] op_sel_hi:[1,1,0]
    v_pk_mul_f32 v[144:145], v[144:145], v[128:129]
    v_pk_mul_f32 v[146:147], v[146:147], v[130:131]
    v_pk_mul_f32 v[148:149], v[148:149], v[132:133]
    v_pk_mul_f32 v[150:151], v[150:151], v[134:135]
    v_pk_mul_f32 v[152:153], v[152:153], v[136:137]
    v_pk_mul_f32 v[154:155], v[154:155], v[138:139]
    v_pk_mul_f32 v[156:157], v[156:157], v[140:141]
    v_pk_mul_f32 v[158:159], v[158:159], v[142:143]
    v_exp_f32 v144, v144
    v_exp_f32 v145, v145
    v_exp_f32 v146, v146
    v_exp_f32 v147, v147
    v_exp_f32 v148, v148
    v_exp_f32 v149, v149
    v_exp_f32 v150, v150
    v_exp_f32 v151, v151
    v_exp_f32 v152, v152
    v_exp_f32 v153, v153
    v_exp_f32 v154, v154
    v_exp_f32 v155, v155
    v_exp_f32 v156, v156
    v_exp_f32 v157, v157
    v_exp_f32 v158, v158
    v_exp_f32 v159, v159
    v_pk_add_f32 v[144:145], v[144:145], 1.0 op_sel_hi:[1,0]
    v_pk_add_f32 v[146:147], v[146:147], 1.0 op_sel_hi:[1,0]
    v_pk_add_f32 v[148:149], v[148:149], 1.0 op_sel_hi:[1,0]
    v_pk_add_f32 v[150:151], v[150:151], 1.0 op_sel_hi:[1,0]
    v_pk_add_f32 v[152:153], v[152:153], 1.0 op_sel_hi:[1,0]
    v_pk_add_f32 v[154:155], v[154:155], 1.0 op_sel_hi:[1,0]
    v_pk_add_f32 v[156:157], v[156:157], 1.0 op_sel_hi:[1,0]
    v_pk_add_f32 v[158:159], v[158:159], 1.0 op_sel_hi:[1,0]
    v_rcp_f32 v144, v144
    v_rcp_f32 v145, v145
    v_rcp_f32 v146, v146
    v_rcp_f32 v147, v147
    v_rcp_f32 v148, v148
    v_rcp_f32 v149, v149
    v_rcp_f32 v150, v150
    v_rcp_f32 v151, v151
    v_rcp_f32 v152, v152
    v_rcp_f32 v153, v153
    v_rcp_f32 v154, v154
    v_rcp_f32 v155, v155
    v_rcp_f32 v156, v156
    v_rcp_f32 v157, v157
    v_rcp_f32 v158, v158
    v_rcp_f32 v159, v159
    v_pk_mul_f32 v[144:145], v[144:145], v[128:129]
    v_pk_mul_f32 v[146:147], v[146:147], v[130:131]
    v_pk_mul_f32 v[148:149], v[148:149], v[132:133]
    v_pk_mul_f32 v[150:151], v[150:151], v[134:135]
    v_pk_mul_f32 v[152:153], v[152:153], v[136:137]
    v_pk_mul_f32 v[154:155], v[154:155], v[138:139]
    v_pk_mul_f32 v[156:157], v[156:157], v[140:141]
    v_pk_mul_f32 v[158:159], v[158:159], v[142:143]
    v_cvt_pk_bf16_f32 v168, v144, v145
    v_cvt_pk_bf16_f32 v169, v146, v147
    v_cvt_pk_bf16_f32 v170, v148, v149
    v_cvt_pk_bf16_f32 v171, v150, v151
    v_cvt_pk_bf16_f32 v172, v152, v153
    v_cvt_pk_bf16_f32 v173, v154, v155
    v_cvt_pk_bf16_f32 v174, v156, v157
    v_cvt_pk_bf16_f32 v175, v158, v159
    s_lshl_b32 s4, s67, 10
    s_add_u32 s4, s4, s33
    buffer_store_dwordx4 v[168:171], v59, s[12:15], s4 offen sc1
    buffer_store_dwordx4 v[172:175], v59, s[12:15], s4 offen offset:512 sc1
    s_waitcnt lgkmcnt(0)
    s_nop 0
    v_pk_fma_f32 v[8:9], v[8:9], v[226:227], v[24:25] op_sel:[0,1,0] op_sel_hi:[1,1,1]
    v_pk_fma_f32 v[10:11], v[10:11], v[226:227], v[26:27] op_sel:[0,1,0] op_sel_hi:[1,1,1]
    v_pk_fma_f32 v[12:13], v[12:13], v[226:227], v[28:29] op_sel:[0,1,0] op_sel_hi:[1,1,1]
    v_pk_fma_f32 v[14:15], v[14:15], v[226:227], v[30:31] op_sel:[0,1,0] op_sel_hi:[1,1,1]
    v_pk_fma_f32 v[16:17], v[16:17], v[226:227], v[32:33] op_sel:[0,1,0] op_sel_hi:[1,1,1]
    v_pk_fma_f32 v[18:19], v[18:19], v[226:227], v[34:35] op_sel:[0,1,0] op_sel_hi:[1,1,1]
    v_pk_fma_f32 v[20:21], v[20:21], v[226:227], v[36:37] op_sel:[0,1,0] op_sel_hi:[1,1,1]
    v_pk_fma_f32 v[22:23], v[22:23], v[226:227], v[38:39] op_sel:[0,1,0] op_sel_hi:[1,1,1]
    v_pk_fma_f32 v[128:129], v[96:97], v[226:227], v[8:9] op_sel:[0,0,0] op_sel_hi:[1,0,1]
    v_pk_fma_f32 v[130:131], v[98:99], v[226:227], v[10:11] op_sel:[0,0,0] op_sel_hi:[1,0,1]
    v_pk_fma_f32 v[132:133], v[100:101], v[226:227], v[12:13] op_sel:[0,0,0] op_sel_hi:[1,0,1]
    v_pk_fma_f32 v[134:135], v[102:103], v[226:227], v[14:15] op_sel:[0,0,0] op_sel_hi:[1,0,1]
    v_pk_fma_f32 v[136:137], v[104:105], v[226:227], v[16:17] op_sel:[0,0,0] op_sel_hi:[1,0,1]
    v_pk_fma_f32 v[138:139], v[106:107], v[226:227], v[18:19] op_sel:[0,0,0] op_sel_hi:[1,0,1]
    v_pk_fma_f32 v[140:141], v[108:109], v[226:227], v[20:21] op_sel:[0,0,0] op_sel_hi:[1,0,1]
    v_pk_fma_f32 v[142:143], v[110:111], v[226:227], v[22:23] op_sel:[0,0,0] op_sel_hi:[1,0,1]
    v_pk_mul_f32 v[144:145], v[128:129], v[128:129]
    v_pk_mul_f32 v[146:147], v[130:131], v[130:131]
    v_pk_mul_f32 v[148:149], v[132:133], v[132:133]
    v_pk_mul_f32 v[150:151], v[134:135], v[134:135]
    v_pk_mul_f32 v[152:153], v[136:137], v[136:137]
    v_pk_mul_f32 v[154:155], v[138:139], v[138:139]
    v_pk_mul_f32 v[156:157], v[140:141], v[140:141]
    v_pk_mul_f32 v[158:159], v[142:143], v[142:143]
    v_pk_fma_f32 v[144:145], v[144:145], s[34:35], s[34:35] op_sel:[0,1,0] op_sel_hi:[1,1,0]
    v_pk_fma_f32 v[146:147], v[146:147], s[34:35], s[34:35] op_sel:[0,1,0] op_sel_hi:[1,1,0]
    v_pk_fma_f32 v[148:149], v[148:149], s[34:35], s[34:35] op_sel:[0,1,0] op_sel_hi:[1,1,0]
    v_pk_fma_f32 v[150:151], v[150:151], s[34:35], s[34:35] op_sel:[0,1,0] op_sel_hi:[1,1,0]
    v_pk_fma_f32 v[152:153], v[152:153], s[34:35], s[34:35] op_sel:[0,1,0] op_sel_hi:[1,1,0]
    v_pk_fma_f32 v[154:155], v[154:155], s[34:35], s[34:35] op_sel:[0,1,0] op_sel_hi:[1,1,0]
    v_pk_fma_f32 v[156:157], v[156:157], s[34:35], s[34:35] op_sel:[0,1,0] op_sel_hi:[1,1,0]
    v_pk_fma_f32 v[158:159], v[158:159], s[34:35], s[34:35] op_sel:[0,1,0] op_sel_hi:[1,1,0]
    v_pk_mul_f32 v[144:145], v[144:145], v[128:129]
    v_pk_mul_f32 v[146:147], v[146:147], v[130:131]
    v_pk_mul_f32 v[148:149], v[148:149], v[132:133]
    v_pk_mul_f32 v[150:151], v[150:151], v[134:135]
    v_pk_mul_f32 v[152:153], v[152:153], v[136:137]
    v_pk_mul_f32 v[154:155], v[154:155], v[138:139]
    v_pk_mul_f32 v[156:157], v[156:157], v[140:141]
    v_pk_mul_f32 v[158:159], v[158:159], v[142:143]
    v_exp_f32 v144, v144
    v_exp_f32 v145, v145
    v_exp_f32 v146, v146
    v_exp_f32 v147, v147
    v_exp_f32 v148, v148
    v_exp_f32 v149, v149
    v_exp_f32 v150, v150
    v_exp_f32 v151, v151
    v_exp_f32 v152, v152
    v_exp_f32 v153, v153
    v_exp_f32 v154, v154
    v_exp_f32 v155, v155
    v_exp_f32 v156, v156
    v_exp_f32 v157, v157
    v_exp_f32 v158, v158
    v_exp_f32 v159, v159
    v_pk_add_f32 v[144:145], v[144:145], 1.0 op_sel_hi:[1,0]
    v_pk_add_f32 v[146:147], v[146:147], 1.0 op_sel_hi:[1,0]
    v_pk_add_f32 v[148:149], v[148:149], 1.0 op_sel_hi:[1,0]
    v_pk_add_f32 v[150:151], v[150:151], 1.0 op_sel_hi:[1,0]
    v_pk_add_f32 v[152:153], v[152:153], 1.0 op_sel_hi:[1,0]
    v_pk_add_f32 v[154:155], v[154:155], 1.0 op_sel_hi:[1,0]
    v_pk_add_f32 v[156:157], v[156:157], 1.0 op_sel_hi:[1,0]
    v_pk_add_f32 v[158:159], v[158:159], 1.0 op_sel_hi:[1,0]
    v_rcp_f32 v144, v144
    v_rcp_f32 v145, v145
    v_rcp_f32 v146, v146
    v_rcp_f32 v147, v147
    v_rcp_f32 v148, v148
    v_rcp_f32 v149, v149
    v_rcp_f32 v150, v150
    v_rcp_f32 v151, v151
    v_rcp_f32 v152, v152
    v_rcp_f32 v153, v153
    v_rcp_f32 v154, v154
    v_rcp_f32 v155, v155
    v_rcp_f32 v156, v156
    v_rcp_f32 v157, v157
    v_rcp_f32 v158, v158
    v_rcp_f32 v159, v159
    v_pk_mul_f32 v[144:145], v[144:145], v[128:129]
    v_pk_mul_f32 v[146:147], v[146:147], v[130:131]
    v_pk_mul_f32 v[148:149], v[148:149], v[132:133]
    v_pk_mul_f32 v[150:151], v[150:151], v[134:135]
    v_pk_mul_f32 v[152:153], v[152:153], v[136:137]
    v_pk_mul_f32 v[154:155], v[154:155], v[138:139]
    v_pk_mul_f32 v[156:157], v[156:157], v[140:141]
    v_pk_mul_f32 v[158:159], v[158:159], v[142:143]
    v_cvt_pk_bf16_f32 v160, v144, v145
    v_cvt_pk_bf16_f32 v161, v146, v147
    v_cvt_pk_bf16_f32 v162, v148, v149
    v_cvt_pk_bf16_f32 v163, v150, v151
    v_cvt_pk_bf16_f32 v164, v152, v153
    v_cvt_pk_bf16_f32 v165, v154, v155
    v_cvt_pk_bf16_f32 v166, v156, v157
    v_cvt_pk_bf16_f32 v167, v158, v159
    s_lshl_b32 s4, s68, 10
    s_add_u32 s4, s4, s33
    buffer_store_dwordx4 v[160:163], v59, s[12:15], s4 offen sc1
    buffer_store_dwordx4 v[164:167], v59, s[12:15], s4 offen offset:512 sc1
    v_and_b32 v2, 31, v0
    v_lshrrev_b32 v3, 5, v0
    v_lshl_add_u32 v4, v2, 4, s71
    v_lshl_add_u32 v5, v3, 3, v4
    v_lshl_add_u32 v6, v3, 9, v4
    v_lshl_add_u32 v7, v3, 10, v4
    v_and_b32 v2, 1, v0
    v_cmp_eq_u32 vcc, 0, v2
    v_lshrrev_b32 v3, 1, v0
    v_and_b32 v3, 3, v3
    v_mul_u32_u24 v3, 4160, v3
    v_lshl_add_u32 v3, v2, 4, v3
    v_add_u32 v3, s71, v3
    v_mov_b32 v8, 0
    v_mov_b32 v9, 0
    v_mov_b32 v10, 0
    v_mov_b32_e64 v11, 0
    v_cvt_pk_bf16_f32 v14, v40, v41
    v_cvt_pk_bf16_f32 v15, v42, v43
    v_cvt_pk_bf16_f32 v16, v52, v52
    v_cvt_pk_bf16_f32 v17, v53, v54
    v_cvt_pk_bf16_f32 v20, v44, v44
    v_cvt_pk_bf16_f32 v21, v44, v45
    v_cvt_pk_bf16_f32 v22, v45, v45
    v_cvt_pk_bf16_f32 v23, v46, v46
    buffer_load_dwordx4 a[56:59], v253, s[12:15], s73 offen offset:0 sc1
    s_cmp_eq_u32 s38, 3
    s_cselect_b32 s43, s39, 163840
    s_cmp_eq_u32 s38, 2
    s_cselect_b32 s43, s40, s43
    v_add_u32 v253, s43, v253
    v_cndmask_b32_e64 v2, v49, v48, vcc
    v_cvt_pk_bf16_f32 v24, v48, v48
    v_cvt_pk_bf16_f32 v25, v48, v48
    v_cvt_pk_bf16_f32 v26, v2, v49
    v_cvt_pk_bf16_f32 v27, v49, v49
    v_cndmask_b32_e64 v2, v51, v50, vcc
    v_cvt_pk_bf16_f32 v28, v50, v50
    v_cvt_pk_bf16_f32 v29, v50, v50
    v_cvt_pk_bf16_f32 v30, v2, v51
    v_cvt_pk_bf16_f32 v31, v51, v51
    ds_write_b128 v3, v[8:11]
    ds_write_b64 v5, v[14:15] offset:32
    ds_write_b64 v5, v[16:17] offset:544
    ds_write_b128 v6, v[20:23] offset:1056
    buffer_load_dwordx4 a[60:63], v253, s[12:15], s77 offen offset:0 sc1
    ds_write_b128 v7, v[24:27] offset:2080
    ds_write_b128 v7, v[28:31] offset:2592
    v_lshl_add_u32 v4, v0, 4, s71
    ds_read_b64 v[64:65], v4 offset:24
    ds_read_b128 v[66:69], v4 offset:32
    ds_read_b64 v[72:73], v4 offset:1048
    ds_read_b128 v[74:77], v4 offset:1056
    ds_read_b64 v[80:81], v4 offset:2072
    ds_read_b128 v[82:85], v4 offset:2080
    ds_read_b64 v[88:89], v4 offset:3096
    ds_read_b128 v[90:93], v4 offset:3104
    s_waitcnt lgkmcnt(6)
    v_alignbit_b32 v96, v66, v65, 16
    buffer_load_dwordx4 a[64:67], v253, s[12:15], s77 offen offset:1024 sc1
    v_alignbit_b32 v97, v67, v66, 16
    v_alignbit_b32 v98, v68, v67, 16
    v_alignbit_b32 v99, v69, v68, 16
    v_mov_b32 v100, v65
    v_mov_b32 v101, v66
    v_mov_b32 v102, v67
    v_mov_b32_e64 v103, v68
    v_alignbit_b32 v104, v65, v64, 16
    v_alignbit_b32 v105, v66, v65, 16
    v_alignbit_b32 v106, v67, v66, 16
    v_alignbit_b32 v107, v68, v67, 16
    ds_write_b128 v4, v[96:99] offset:4192
    ds_write_b128 v4, v[100:103] offset:8352
    ds_write_b128 v4, v[104:107] offset:12512
    s_waitcnt lgkmcnt(7)
    v_alignbit_b32 v108, v74, v73, 16
    buffer_load_dwordx4 a[68:71], v253, s[12:15], s77 offen offset:2048 sc1
    v_alignbit_b32 v109, v75, v74, 16
    v_alignbit_b32 v110, v76, v75, 16
    v_alignbit_b32 v111, v77, v76, 16
    v_mov_b32 v112, v73
    v_mov_b32 v113, v74
    v_mov_b32 v114, v75
    v_mov_b32_e64 v115, v76
    v_alignbit_b32 v116, v73, v72, 16
    v_alignbit_b32 v117, v74, v73, 16
    v_alignbit_b32 v118, v75, v74, 16
    v_alignbit_b32 v119, v76, v75, 16
    ds_write_b128 v4, v[108:111] offset:5216
    ds_write_b128 v4, v[112:115] offset:9376
    ds_write_b128 v4, v[116:119] offset:13536
    s_waitcnt lgkmcnt(8)
    buffer_load_dwordx4 a[72:75], v253, s[12:15], s77 offen offset:3072 sc1
    v_alignbit_b32 v120, v82, v81, 16
    v_alignbit_b32 v121, v83, v82, 16
    v_alignbit_b32 v122, v84, v83, 16
    v_alignbit_b32 v123, v85, v84, 16
    v_mov_b32 v124, v81
    v_mov_b32 v125, v82
    v_mov_b32 v126, v83
    v_mov_b32_e64 v127, v84
    v_alignbit_b32 v128, v81, v80, 16
    v_alignbit_b32 v129, v82, v81, 16
    v_alignbit_b32 v130, v83, v82, 16
    v_alignbit_b32 v131, v84, v83, 16
    ds_write_b128 v4, v[120:123] offset:6240
    ds_write_b128 v4, v[124:127] offset:10400
    ds_write_b128 v4, v[128:131] offset:14560
    s_waitcnt lgkmcnt(9)
    buffer_load_dwordx4 a[76:79], v253, s[12:15], s73 offen offset:0 sc1
    s_cmp_eq_u32 s38, 4
    s_cselect_b32 s43, s39, 163840
    s_cmp_eq_u32 s38, 3
    s_cselect_b32 s43, s40, s43
    v_add_u32_e64 v253, s43, v253
    v_alignbit_b32 v132, v90, v89, 16
    v_alignbit_b32 v133, v91, v90, 16
    v_alignbit_b32 v134, v92, v91, 16
    v_alignbit_b32 v135, v93, v92, 16
    v_mov_b32 v136, v89
    v_mov_b32 v137, v90
    v_mov_b32 v138, v91
    v_mov_b32 v139, v92
    v_alignbit_b32 v140, v89, v88, 16
    v_alignbit_b32 v141, v90, v89, 16
    v_alignbit_b32 v142, v91, v90, 16
    v_alignbit_b32 v143, v92, v91, 16
    ds_write_b128 v4, v[132:135] offset:7264
    ds_write_b128 v4, v[136:139] offset:11424
    ds_write_b128 v4, v[140:143] offset:15584
    s_lshl_b32 s5, s3, 12
    s_add_u32 s5, s5, 68608
    v_lshl_add_u32 v2, v0, 4, s5
    s_lshl_b32 s5, s3, 9
    s_add_u32 s5, s5, 66560
    v_lshl_add_u32 v3, v0, 3, s5
    v_mov_b32 v4, 0
    v_mov_b32_e64 v5, 0
    s_waitcnt vmcnt(17)
    ds_write_b64 v3, v[4:5]
    ds_write_b128 v2, v[232:235] offset:0
    ds_write_b128 v2, v[236:239] offset:1024
    ds_write_b128 v2, v[240:243] offset:2048
    ds_write_b128 v2, v[244:247] offset:3072
    s_add_u32 s4, s3, 0
    s_and_b32 s4, s4, 3
    s_mul_i32 s4, s4, 55296
    v_add_u32_e64 v248, s4, v252
    s_add_u32 s4, s3, 1
    s_and_b32 s4, s4, 3
    s_mul_i32 s4, s4, 55296
    v_add_u32_e64 v249, s4, v252
    s_add_u32 s4, s3, 2
    s_and_b32 s4, s4, 3
    s_mul_i32 s4, s4, 55296
    v_add_u32_e64 v250, s4, v252
    s_add_u32 s4, s3, 3
    s_and_b32 s4, s4, 3
    s_mul_i32 s4, s4, 55296
    v_add_u32_e64 v251, s4, v252
    s_mul_i32 s4, s74, 216
    s_add_u32 s4, s4, s3
    s_lshl_b32 s4, s4, 10
    s_add_u32 s76, s4, 7536640
    s_lshl_b32 s4, s44, 12
    s_add_u32 s4, s4, s31
    s_add_u32 s76, s76, s4
    v_and_b32 v2, 3, v0
    v_sub_u32_e64 v2, 3, v2
    v_mul_u32_u24 v2, 4160, v2
    v_bfe_u32 v3, v0, 2, 2
    v_lshl_add_u32 v2, v3, 3, v2
    v_lshrrev_b32 v3, 4, v0
    v_lshlrev_b32 v4, 4, v3
    v_sub_u32 v2, v2, v4
    s_add_u32 s4, s71, 56
    v_add_u32 v224, s4, v2
    v_and_b32 v2, 15, v0
    v_lshl_add_u32 v2, v2, 1, v3
    v_add_u32 v225, 30, v2
    v_lshlrev_b32 v3, 6, v225
    v_add_u32 v3, 64768, v3
    v_lshrrev_b32 v4, 2, v225
    v_subrev_u32 v2, 0, v4
    v_and_b32 v2, 3, v2
    v_xor_b32 v2, s3, v2
    v_lshl_add_u32 v228, v2, 4, v3
    v_subrev_u32 v2, 1, v4
    v_and_b32 v2, 3, v2
    v_xor_b32_e64 v2, s3, v2
    v_lshl_add_u32 v229, v2, 4, v3
    v_subrev_u32 v2, 2, v4
    v_and_b32 v2, 3, v2
    v_xor_b32_e64 v2, s3, v2
    v_lshl_add_u32 v230, v2, 4, v3
    v_subrev_u32 v2, 3, v4
    v_and_b32 v2, 3, v2
    v_xor_b32_e64 v2, s3, v2
    v_lshl_add_u32 v231, v2, 4, v3
    s_waitcnt vmcnt(6) lgkmcnt(0)
    s_barrier
    s_cmp_lg_u32 s3, 0
    s_cbranch_scc1 L_pub_45
    s_mov_b64 exec, 1
    s_lshl_b64 exec, exec, 36
    s_mov_b32 s4, 14876672
    v_add_u32_e64 v2, 1, v255
    buffer_store_dword v2, v254, s[12:15], s4 offen sc1
    s_mov_b64 exec, -1
L_pub_45:
    s_nop 0
    ds_read_b64 v[96:97], v224 offset:0
    ds_read_b64 v[98:99], v224 offset:8
    ds_read_b128 v[128:131], v228 offset:1792
    ds_read_b64 v[100:101], v224 offset:512
    ds_read_b64 v[102:103], v224 offset:520
    ds_read_b128 v[132:135], v228 offset:3840
    ds_read_b64 v[104:105], v224 offset:1024
    ds_read_b64 v[106:107], v224 offset:1032
    ds_read_b128 v[136:139], v228 offset:5888
    ds_read_b64 v[108:109], v224 offset:1536
    ds_read_b64 v[110:111], v224 offset:1544
    ds_read_b128 v[140:143], v228 offset:7936
    ds_read_b64 v[112:113], v224 offset:2048
    ds_read_b64 v[114:115], v224 offset:2056
    ds_read_b128 v[144:147], v228 offset:9984
    ds_read_b64 v[116:117], v224 offset:2560
    ds_read_b64 v[118:119], v224 offset:2568
    ds_read_b128 v[148:151], v228 offset:12032
    ds_read_b64 v[120:121], v224 offset:3072
    ds_read_b64 v[122:123], v224 offset:3080
    ds_read_b128 v[152:155], v228 offset:14080
    ds_read_b64 v[124:125], v224 offset:3584
    ds_read_b64 v[126:127], v224 offset:3592
    ds_read_b128 v[156:159], v228 offset:16128
    s_waitcnt lgkmcnt(0)
    s_nop 0
    v_mfma_f32_16x16x32_bf16 v[64:67], v[96:99], v[128:131], 0
    ds_read_b64 v[160:161], v224 offset:64
    v_mfma_f32_16x16x32_bf16 v[68:71], v[96:99], v[132:135], 0
    ds_read_b64 v[162:163], v224 offset:72
    v_mfma_f32_16x16x32_bf16 v[72:75], v[96:99], v[136:139], 0
    buffer_load_dwordx4 a[80:83], v253, s[12:15], s77 offen offset:0 sc1
    v_mfma_f32_16x16x32_bf16 v[76:79], v[96:99], v[140:143], 0
    ds_read_b128 v[192:195], v229 offset:1536
    v_mfma_f32_16x16x32_bf16 v[80:83], v[96:99], v[144:147], 0
    ds_read_b64 v[164:165], v224 offset:576
    v_mfma_f32_16x16x32_bf16 v[84:87], v[96:99], v[148:151], 0
    ds_read_b64 v[166:167], v224 offset:584
    v_mfma_f32_16x16x32_bf16 v[88:91], v[96:99], v[152:155], 0
    buffer_load_dwordx4 a[84:87], v253, s[12:15], s77 offen offset:1024 sc1
    v_mfma_f32_16x16x32_bf16 v[92:95], v[96:99], v[156:159], 0
    ds_read_b128 v[196:199], v229 offset:3584
    v_mfma_f32_16x16x32_bf16 v[68:71], v[100:103], v[128:131], v[68:71]
    ds_read_b64 v[168:169], v224 offset:1088
    v_mfma_f32_16x16x32_bf16 v[72:75], v[100:103], v[132:135], v[72:75]
    ds_read_b64 v[170:171], v224 offset:1096
    v_mfma_f32_16x16x32_bf16 v[76:79], v[100:103], v[136:139], v[76:79]
    buffer_load_dwordx4 a[88:91], v253, s[12:15], s77 offen offset:2048 sc1
    v_mfma_f32_16x16x32_bf16 v[80:83], v[100:103], v[140:143], v[80:83]
    ds_read_b128 v[200:203], v229 offset:5632
    v_mfma_f32_16x16x32_bf16 v[84:87], v[100:103], v[144:147], v[84:87]
    ds_read_b64 v[172:173], v224 offset:1600
    v_mfma_f32_16x16x32_bf16 v[88:91], v[100:103], v[148:151], v[88:91]
    ds_read_b64 v[174:175], v224 offset:1608
    v_mfma_f32_16x16x32_bf16 v[92:95], v[100:103], v[152:155], v[92:95]
    buffer_load_dwordx4 a[92:95], v253, s[12:15], s77 offen offset:3072 sc1
    v_mfma_f32_16x16x32_bf16 v[72:75], v[104:107], v[128:131], v[72:75]
    ds_read_b128 v[204:207], v229 offset:7680
    v_mfma_f32_16x16x32_bf16 v[76:79], v[104:107], v[132:135], v[76:79]
    ds_read_b64 v[176:177], v224 offset:2112
    v_mfma_f32_16x16x32_bf16 v[80:83], v[104:107], v[136:139], v[80:83]
    ds_read_b64 v[178:179], v224 offset:2120
    v_mfma_f32_16x16x32_bf16 v[84:87], v[104:107], v[140:143], v[84:87]
    buffer_load_dwordx4 a[96:99], v253, s[12:15], s73 offen offset:0 sc1
    s_cmp_eq_u32 s38, 5
    s_cselect_b32 s43, s39, 163840
    s_cmp_eq_u32 s38, 4
    s_cselect_b32 s43, s40, s43
    v_add_u32 v253, s43, v253
    v_mfma_f32_16x16x32_bf16 v[88:91], v[104:107], v[144:147], v[88:91]
    ds_read_b128 v[208:211], v229 offset:9728
    v_mfma_f32_16x16x32_bf16 v[92:95], v[104:107], v[148:151], v[92:95]
    ds_read_b64 v[180:181], v224 offset:2624
    v_mfma_f32_16x16x32_bf16 v[76:79], v[108:111], v[128:131], v[76:79]
    ds_read_b64 v[182:183], v224 offset:2632
    v_mfma_f32_16x16x32_bf16 v[80:83], v[108:111], v[132:135], v[80:83]
    buffer_load_dwordx4 a[100:103], v253, s[12:15], s77 offen offset:0 sc1
    v_mfma_f32_16x16x32_bf16 v[84:87], v[108:111], v[136:139], v[84:87]
    ds_read_b128 v[212:215], v229 offset:11776
    v_mfma_f32_16x16x32_bf16 v[88:91], v[108:111], v[140:143], v[88:91]
    ds_read_b64 v[184:185], v224 offset:3136
    v_mfma_f32_16x16x32_bf16 v[92:95], v[108:111], v[144:147], v[92:95]
    ds_read_b64 v[186:187], v224 offset:3144
    v_mfma_f32_16x16x32_bf16 v[80:83], v[112:115], v[128:131], v[80:83]
    buffer_load_dwordx4 a[104:107], v253, s[12:15], s77 offen offset:1024 sc1
    v_mfma_f32_16x16x32_bf16 v[84:87], v[112:115], v[132:135], v[84:87]
    ds_read_b128 v[216:219], v229 offset:13824
    v_mfma_f32_16x16x32_bf16 v[88:91], v[112:115], v[136:139], v[88:91]
    ds_read_b64 v[188:189], v224 offset:3648
    v_mfma_f32_16x16x32_bf16 v[92:95], v[112:115], v[140:143], v[92:95]
    ds_read_b64 v[190:191], v224 offset:3656
    v_mfma_f32_16x16x32_bf16 v[84:87], v[116:119], v[128:131], v[84:87]
    buffer_load_dwordx4 a[108:111], v253, s[12:15], s77 offen offset:2048 sc1
    v_mfma_f32_16x16x32_bf16 v[88:91], v[116:119], v[132:135], v[88:91]
    ds_read_b128 v[220:223], v229 offset:15872
    v_mfma_f32_16x16x32_bf16 v[92:95], v[116:119], v[136:139], v[92:95]
    v_mfma_f32_16x16x32_bf16 v[88:91], v[120:123], v[128:131], v[88:91]
    v_mfma_f32_16x16x32_bf16 v[92:95], v[120:123], v[132:135], v[92:95]
    buffer_load_dwordx4 a[112:115], v253, s[12:15], s77 offen offset:3072 sc1
    v_mfma_f32_16x16x32_bf16 v[92:95], v[124:127], v[128:131], v[92:95]
    s_waitcnt lgkmcnt(0)
    s_nop 0
    v_mfma_f32_16x16x32_bf16 v[64:67], v[160:163], v[192:195], v[64:67]
    ds_read_b64 v[96:97], v224 offset:128
    v_mfma_f32_16x16x32_bf16 v[68:71], v[160:163], v[196:199], v[68:71]
    ds_read_b64 v[98:99], v224 offset:136
    v_mfma_f32_16x16x32_bf16 v[72:75], v[160:163], v[200:203], v[72:75]
    buffer_load_dwordx4 a[116:119], v253, s[12:15], s73 offen offset:0 sc1
    s_cmp_eq_u32 s38, 6
    s_cselect_b32 s43, s39, 163840
    s_cmp_eq_u32 s38, 5
    s_cselect_b32 s43, s40, s43
    v_add_u32 v253, s43, v253
    v_mfma_f32_16x16x32_bf16 v[76:79], v[160:163], v[204:207], v[76:79]
    ds_read_b128 v[128:131], v230 offset:1280
    v_mfma_f32_16x16x32_bf16 v[80:83], v[160:163], v[208:211], v[80:83]
    ds_read_b64 v[100:101], v224 offset:640
    v_mfma_f32_16x16x32_bf16 v[84:87], v[160:163], v[212:215], v[84:87]
    ds_read_b64 v[102:103], v224 offset:648
    v_mfma_f32_16x16x32_bf16 v[88:91], v[160:163], v[216:219], v[88:91]
    buffer_load_dwordx4 a[120:123], v253, s[12:15], s77 offen offset:0 sc1
    v_mfma_f32_16x16x32_bf16 v[92:95], v[160:163], v[220:223], v[92:95]
    ds_read_b128 v[132:135], v230 offset:3328
    v_mfma_f32_16x16x32_bf16 v[68:71], v[164:167], v[192:195], v[68:71]
    ds_read_b64 v[104:105], v224 offset:1152
    v_mfma_f32_16x16x32_bf16 v[72:75], v[164:167], v[196:199], v[72:75]
    ds_read_b64 v[106:107], v224 offset:1160
    v_mfma_f32_16x16x32_bf16 v[76:79], v[164:167], v[200:203], v[76:79]
    buffer_load_dwordx4 a[124:127], v253, s[12:15], s77 offen offset:1024 sc1
    v_mfma_f32_16x16x32_bf16 v[80:83], v[164:167], v[204:207], v[80:83]
    ds_read_b128 v[136:139], v230 offset:5376
    v_mfma_f32_16x16x32_bf16 v[84:87], v[164:167], v[208:211], v[84:87]
    ds_read_b64 v[108:109], v224 offset:1664
    v_mfma_f32_16x16x32_bf16 v[88:91], v[164:167], v[212:215], v[88:91]
    ds_read_b64 v[110:111], v224 offset:1672
    v_mfma_f32_16x16x32_bf16 v[92:95], v[164:167], v[216:219], v[92:95]
    buffer_load_dwordx4 a[128:131], v253, s[12:15], s77 offen offset:2048 sc1
    v_mfma_f32_16x16x32_bf16 v[72:75], v[168:171], v[192:195], v[72:75]
    ds_read_b128 v[140:143], v230 offset:7424
    v_mfma_f32_16x16x32_bf16 v[76:79], v[168:171], v[196:199], v[76:79]
    ds_read_b64 v[112:113], v224 offset:2176
    v_mfma_f32_16x16x32_bf16 v[80:83], v[168:171], v[200:203], v[80:83]
    ds_read_b64 v[114:115], v224 offset:2184
    v_mfma_f32_16x16x32_bf16 v[84:87], v[168:171], v[204:207], v[84:87]
    buffer_load_dwordx4 a[132:135], v253, s[12:15], s77 offen offset:3072 sc1
    v_mfma_f32_16x16x32_bf16 v[88:91], v[168:171], v[208:211], v[88:91]
    ds_read_b128 v[144:147], v230 offset:9472
    v_mfma_f32_16x16x32_bf16 v[92:95], v[168:171], v[212:215], v[92:95]
    ds_read_b64 v[116:117], v224 offset:2688
    v_mfma_f32_16x16x32_bf16 v[76:79], v[172:175], v[192:195], v[76:79]
    ds_read_b64 v[118:119], v224 offset:2696
    v_mfma_f32_16x16x32_bf16 v[80:83], v[172:175], v[196:199], v[80:83]
    buffer_load_dwordx4 a[136:139], v253, s[12:15], s73 offen offset:0 sc1
    s_cmp_eq_u32 s38, 7
    s_cselect_b32 s43, s39, 163840
    s_cmp_eq_u32 s38, 6
    s_cselect_b32 s43, s40, s43
    v_add_u32 v253, s43, v253
    v_mfma_f32_16x16x32_bf16 v[84:87], v[172:175], v[200:203], v[84:87]
    ds_read_b128 v[148:151], v230 offset:11520
    v_mfma_f32_16x16x32_bf16 v[88:91], v[172:175], v[204:207], v[88:91]
    ds_read_b64 v[120:121], v224 offset:3200
    v_mfma_f32_16x16x32_bf16 v[92:95], v[172:175], v[208:211], v[92:95]
    ds_read_b64 v[122:123], v224 offset:3208
    v_mfma_f32_16x16x32_bf16 v[80:83], v[176:179], v[192:195], v[80:83]
    buffer_load_dwordx4 a[140:143], v253, s[12:15], s77 offen offset:0 sc1
    v_mfma_f32_16x16x32_bf16 v[84:87], v[176:179], v[196:199], v[84:87]
    ds_read_b128 v[152:155], v230 offset:13568
    v_mfma_f32_16x16x32_bf16 v[88:91], v[176:179], v[200:203], v[88:91]
    ds_read_b64 v[124:125], v224 offset:3712
    v_mfma_f32_16x16x32_bf16 v[92:95], v[176:179], v[204:207], v[92:95]
    ds_read_b64 v[126:127], v224 offset:3720
    v_mfma_f32_16x16x32_bf16 v[84:87], v[180:183], v[192:195], v[84:87]
    buffer_load_dwordx4 a[144:147], v253, s[12:15], s77 offen offset:1024 sc1
    v_mfma_f32_16x16x32_bf16 v[88:91], v[180:183], v[196:199], v[88:91]
    ds_read_b128 v[156:159], v230 offset:15616
    v_mfma_f32_16x16x32_bf16 v[92:95], v[180:183], v[200:203], v[92:95]
    v_mfma_f32_16x16x32_bf16 v[88:91], v[184:187], v[192:195], v[88:91]
    v_mfma_f32_16x16x32_bf16 v[92:95], v[184:187], v[196:199], v[92:95]
    buffer_load_dwordx4 a[148:151], v253, s[12:15], s77 offen offset:2048 sc1
    v_mfma_f32_16x16x32_bf16 v[92:95], v[188:191], v[192:195], v[92:95]
    s_waitcnt lgkmcnt(0)
    s_nop 0
    v_mfma_f32_16x16x32_bf16 v[64:67], v[96:99], v[128:131], v[64:67]
    ds_read_b64 v[160:161], v224 offset:192
    v_mfma_f32_16x16x32_bf16 v[68:71], v[96:99], v[132:135], v[68:71]
    ds_read_b64 v[162:163], v224 offset:200
    v_mfma_f32_16x16x32_bf16 v[72:75], v[96:99], v[136:139], v[72:75]
    buffer_load_dwordx4 a[152:155], v253, s[12:15], s77 offen offset:3072 sc1
    v_mfma_f32_16x16x32_bf16 v[76:79], v[96:99], v[140:143], v[76:79]
    ds_read_b128 v[192:195], v231 offset:1024
    v_mfma_f32_16x16x32_bf16 v[80:83], v[96:99], v[144:147], v[80:83]
    ds_read_b64 v[164:165], v224 offset:704
    v_mfma_f32_16x16x32_bf16 v[84:87], v[96:99], v[148:151], v[84:87]
    ds_read_b64 v[166:167], v224 offset:712
    v_mfma_f32_16x16x32_bf16 v[88:91], v[96:99], v[152:155], v[88:91]
    buffer_load_dwordx4 a[156:159], v253, s[12:15], s73 offen offset:0 sc1
    s_cmp_eq_u32 s38, 8
    s_cselect_b32 s43, s39, 163840
    s_cmp_eq_u32 s38, 7
    s_cselect_b32 s43, s40, s43
    v_add_u32 v253, s43, v253
    v_mfma_f32_16x16x32_bf16 v[92:95], v[96:99], v[156:159], v[92:95]
    ds_read_b128 v[196:199], v231 offset:3072
    v_mfma_f32_16x16x32_bf16 v[68:71], v[100:103], v[128:131], v[68:71]
    ds_read_b64 v[168:169], v224 offset:1216
    v_mfma_f32_16x16x32_bf16 v[72:75], v[100:103], v[132:135], v[72:75]
    ds_read_b64 v[170:171], v224 offset:1224
    v_mfma_f32_16x16x32_bf16 v[76:79], v[100:103], v[136:139], v[76:79]
    buffer_load_dwordx4 a[160:163], v253, s[12:15], s77 offen offset:0 sc1
    v_mfma_f32_16x16x32_bf16 v[80:83], v[100:103], v[140:143], v[80:83]
    ds_read_b128 v[200:203], v231 offset:5120
    v_mfma_f32_16x16x32_bf16 v[84:87], v[100:103], v[144:147], v[84:87]
    ds_read_b64 v[172:173], v224 offset:1728
    v_mfma_f32_16x16x32_bf16 v[88:91], v[100:103], v[148:151], v[88:91]
    ds_read_b64 v[174:175], v224 offset:1736
    v_mfma_f32_16x16x32_bf16 v[92:95], v[100:103], v[152:155], v[92:95]
    buffer_load_dwordx4 a[164:167], v253, s[12:15], s77 offen offset:1024 sc1
    v_mfma_f32_16x16x32_bf16 v[72:75], v[104:107], v[128:131], v[72:75]
    ds_read_b128 v[204:207], v231 offset:7168
    v_mfma_f32_16x16x32_bf16 v[76:79], v[104:107], v[132:135], v[76:79]
    ds_read_b64 v[176:177], v224 offset:2240
    v_mfma_f32_16x16x32_bf16 v[80:83], v[104:107], v[136:139], v[80:83]
    ds_read_b64 v[178:179], v224 offset:2248
    v_mfma_f32_16x16x32_bf16 v[84:87], v[104:107], v[140:143], v[84:87]
    buffer_load_dwordx4 a[168:171], v253, s[12:15], s77 offen offset:2048 sc1
    v_mfma_f32_16x16x32_bf16 v[88:91], v[104:107], v[144:147], v[88:91]
    ds_read_b128 v[208:211], v231 offset:9216
    v_mfma_f32_16x16x32_bf16 v[92:95], v[104:107], v[148:151], v[92:95]
    ds_read_b64 v[180:181], v224 offset:2752
    v_mfma_f32_16x16x32_bf16 v[76:79], v[108:111], v[128:131], v[76:79]
    ds_read_b64 v[182:183], v224 offset:2760
    v_mfma_f32_16x16x32_bf16 v[80:83], v[108:111], v[132:135], v[80:83]
    buffer_load_dwordx4 a[172:175], v253, s[12:15], s77 offen offset:3072 sc1
    v_mfma_f32_16x16x32_bf16 v[84:87], v[108:111], v[136:139], v[84:87]
    ds_read_b128 v[212:215], v231 offset:11264
    v_mfma_f32_16x16x32_bf16 v[88:91], v[108:111], v[140:143], v[88:91]
    ds_read_b64 v[184:185], v224 offset:3264
    v_mfma_f32_16x16x32_bf16 v[92:95], v[108:111], v[144:147], v[92:95]
    ds_read_b64 v[186:187], v224 offset:3272
    v_mfma_f32_16x16x32_bf16 v[80:83], v[112:115], v[128:131], v[80:83]
    buffer_load_dwordx4 a[176:179], v253, s[12:15], s73 offen offset:0 sc1
    s_cmp_eq_u32 s38, 9
    s_cselect_b32 s43, s39, 163840
    s_cmp_eq_u32 s38, 8
    s_cselect_b32 s43, s40, s43
    v_add_u32 v253, s43, v253
    v_mfma_f32_16x16x32_bf16 v[84:87], v[112:115], v[132:135], v[84:87]
    ds_read_b128 v[216:219], v231 offset:13312
    v_mfma_f32_16x16x32_bf16 v[88:91], v[112:115], v[136:139], v[88:91]
    ds_read_b64 v[188:189], v224 offset:3776
    v_mfma_f32_16x16x32_bf16 v[92:95], v[112:115], v[140:143], v[92:95]
    ds_read_b64 v[190:191], v224 offset:3784
    v_mfma_f32_16x16x32_bf16 v[84:87], v[116:119], v[128:131], v[84:87]
    buffer_load_dwordx4 a[180:183], v253, s[12:15], s77 offen offset:0 sc1
    v_mfma_f32_16x16x32_bf16 v[88:91], v[116:119], v[132:135], v[88:91]
    ds_read_b128 v[220:223], v231 offset:15360
    v_mfma_f32_16x16x32_bf16 v[92:95], v[116:119], v[136:139], v[92:95]
    v_mfma_f32_16x16x32_bf16 v[88:91], v[120:123], v[128:131], v[88:91]
    v_mfma_f32_16x16x32_bf16 v[92:95], v[120:123], v[132:135], v[92:95]
    buffer_load_dwordx4 a[184:187], v253, s[12:15], s77 offen offset:1024 sc1
    v_mfma_f32_16x16x32_bf16 v[92:95], v[124:127], v[128:131], v[92:95]
    s_waitcnt lgkmcnt(0)
    s_nop 0
    s_mov_b32 s4, 14876672
    buffer_load_dword v56, v254, s[12:15], s4 offen sc1
    v_mfma_f32_16x16x32_bf16 v[64:67], v[160:163], v[192:195], v[64:67]
    ds_read_b64 v[96:97], v224 offset:256
    v_mfma_f32_16x16x32_bf16 v[68:71], v[160:163], v[196:199], v[68:71]
    ds_read_b64 v[98:99], v224 offset:264
    v_mfma_f32_16x16x32_bf16 v[72:75], v[160:163], v[200:203], v[72:75]
    buffer_load_dwordx4 a[188:191], v253, s[12:15], s77 offen offset:2048 sc1
    v_mfma_f32_16x16x32_bf16 v[76:79], v[160:163], v[204:207], v[76:79]
    ds_read_b128 v[128:131], v228 offset:768
    v_mfma_f32_16x16x32_bf16 v[80:83], v[160:163], v[208:211], v[80:83]
    ds_read_b64 v[100:101], v224 offset:768
    v_mfma_f32_16x16x32_bf16 v[84:87], v[160:163], v[212:215], v[84:87]
    ds_read_b64 v[102:103], v224 offset:776
    v_mfma_f32_16x16x32_bf16 v[88:91], v[160:163], v[216:219], v[88:91]
    buffer_load_dwordx4 a[192:195], v253, s[12:15], s77 offen offset:3072 sc1
    v_mfma_f32_16x16x32_bf16 v[92:95], v[160:163], v[220:223], v[92:95]
    ds_read_b128 v[132:135], v228 offset:2816
    v_mfma_f32_16x16x32_bf16 v[68:71], v[164:167], v[192:195], v[68:71]
    ds_read_b64 v[104:105], v224 offset:1280
    v_mfma_f32_16x16x32_bf16 v[72:75], v[164:167], v[196:199], v[72:75]
    ds_read_b64 v[106:107], v224 offset:1288
    v_mfma_f32_16x16x32_bf16 v[76:79], v[164:167], v[200:203], v[76:79]
    buffer_load_dwordx4 a[196:199], v253, s[12:15], s73 offen offset:0 sc1
    s_cmp_eq_u32 s38, 10
    s_cselect_b32 s43, s39, 163840
    s_cmp_eq_u32 s38, 9
    s_cselect_b32 s43, s40, s43
    v_add_u32 v253, s43, v253
    v_mfma_f32_16x16x32_bf16 v[80:83], v[164:167], v[204:207], v[80:83]
    ds_read_b128 v[136:139], v228 offset:4864
    v_mfma_f32_16x16x32_bf16 v[84:87], v[164:167], v[208:211], v[84:87]
    ds_read_b64 v[108:109], v224 offset:1792
    v_mfma_f32_16x16x32_bf16 v[88:91], v[164:167], v[212:215], v[88:91]
    ds_read_b64 v[110:111], v224 offset:1800
    v_mfma_f32_16x16x32_bf16 v[92:95], v[164:167], v[216:219], v[92:95]
    buffer_load_dwordx4 a[200:203], v253, s[12:15], s77 offen offset:0 sc1
    v_mfma_f32_16x16x32_bf16 v[72:75], v[168:171], v[192:195], v[72:75]
    ds_read_b128 v[140:143], v228 offset:6912
    v_mfma_f32_16x16x32_bf16 v[76:79], v[168:171], v[196:199], v[76:79]
    ds_read_b64 v[112:113], v224 offset:2304
    v_mfma_f32_16x16x32_bf16 v[80:83], v[168:171], v[200:203], v[80:83]
    ds_read_b64 v[114:115], v224 offset:2312
    v_mfma_f32_16x16x32_bf16 v[84:87], v[168:171], v[204:207], v[84:87]
    buffer_load_dwordx4 a[204:207], v253, s[12:15], s77 offen offset:1024 sc1
    v_mfma_f32_16x16x32_bf16 v[88:91], v[168:171], v[208:211], v[88:91]
    ds_read_b128 v[144:147], v228 offset:8960
    v_mfma_f32_16x16x32_bf16 v[92:95], v[168:171], v[212:215], v[92:95]
    ds_read_b64 v[116:117], v224 offset:2816
    v_mfma_f32_16x16x32_bf16 v[76:79], v[172:175], v[192:195], v[76:79]
    ds_read_b64 v[118:119], v224 offset:2824
    v_mfma_f32_16x16x32_bf16 v[80:83], v[172:175], v[196:199], v[80:83]
    buffer_load_dwordx4 a[208:211], v253, s[12:15], s77 offen offset:2048 sc1
    v_mfma_f32_16x16x32_bf16 v[84:87], v[172:175], v[200:203], v[84:87]
    ds_read_b128 v[148:151], v228 offset:11008
    v_mfma_f32_16x16x32_bf16 v[88:91], v[172:175], v[204:207], v[88:91]
    ds_read_b64 v[120:121], v224 offset:3328
    v_mfma_f32_16x16x32_bf16 v[92:95], v[172:175], v[208:211], v[92:95]
    ds_read_b64 v[122:123], v224 offset:3336
    v_mfma_f32_16x16x32_bf16 v[80:83], v[176:179], v[192:195], v[80:83]
    buffer_load_dwordx4 a[212:215], v253, s[12:15], s77 offen offset:3072 sc1
    v_mfma_f32_16x16x32_bf16 v[84:87], v[176:179], v[196:199], v[84:87]
    ds_read_b128 v[152:155], v228 offset:13056
    v_mfma_f32_16x16x32_bf16 v[88:91], v[176:179], v[200:203], v[88:91]
    ds_read_b64 v[124:125], v224 offset:3840
    v_mfma_f32_16x16x32_bf16 v[92:95], v[176:179], v[204:207], v[92:95]
    ds_read_b64 v[126:127], v224 offset:3848
    v_mfma_f32_16x16x32_bf16 v[84:87], v[180:183], v[192:195], v[84:87]
    buffer_load_dwordx4 a[216:219], v253, s[12:15], s73 offen offset:0 sc1
    s_cmp_eq_u32 s38, 11
    s_cselect_b32 s43, s39, 163840
    s_cmp_eq_u32 s38, 10
    s_cselect_b32 s43, s40, s43
    v_add_u32 v253, s43, v253
    v_mfma_f32_16x16x32_bf16 v[88:91], v[180:183], v[196:199], v[88:91]
    ds_read_b128 v[156:159], v228 offset:15104
    v_mfma_f32_16x16x32_bf16 v[92:95], v[180:183], v[200:203], v[92:95]
    v_mfma_f32_16x16x32_bf16 v[88:91], v[184:187], v[192:195], v[88:91]
    v_mfma_f32_16x16x32_bf16 v[92:95], v[184:187], v[196:199], v[92:95]
    buffer_load_dwordx4 a[220:223], v253, s[12:15], s77 offen offset:0 sc1
    v_mfma_f32_16x16x32_bf16 v[92:95], v[188:191], v[192:195], v[92:95]
    s_waitcnt lgkmcnt(0)
    s_nop 0
    v_mfma_f32_16x16x32_bf16 v[64:67], v[96:99], v[128:131], v[64:67]
    ds_read_b64 v[160:161], v224 offset:320
    v_mfma_f32_16x16x32_bf16 v[68:71], v[96:99], v[132:135], v[68:71]
    ds_read_b64 v[162:163], v224 offset:328
    v_mfma_f32_16x16x32_bf16 v[72:75], v[96:99], v[136:139], v[72:75]
    buffer_load_dwordx4 a[224:227], v253, s[12:15], s77 offen offset:1024 sc1
    v_mfma_f32_16x16x32_bf16 v[76:79], v[96:99], v[140:143], v[76:79]
    ds_read_b128 v[192:195], v229 offset:512
    v_mfma_f32_16x16x32_bf16 v[80:83], v[96:99], v[144:147], v[80:83]
    ds_read_b64 v[164:165], v224 offset:832
    v_mfma_f32_16x16x32_bf16 v[84:87], v[96:99], v[148:151], v[84:87]
    ds_read_b64 v[166:167], v224 offset:840
    v_mfma_f32_16x16x32_bf16 v[88:91], v[96:99], v[152:155], v[88:91]
    buffer_load_dwordx4 a[228:231], v253, s[12:15], s77 offen offset:2048 sc1
    v_mfma_f32_16x16x32_bf16 v[92:95], v[96:99], v[156:159], v[92:95]
    ds_read_b128 v[196:199], v229 offset:2560
    v_mfma_f32_16x16x32_bf16 v[68:71], v[100:103], v[128:131], v[68:71]
    ds_read_b64 v[168:169], v224 offset:1344
    v_mfma_f32_16x16x32_bf16 v[72:75], v[100:103], v[132:135], v[72:75]
    ds_read_b64 v[170:171], v224 offset:1352
    v_mfma_f32_16x16x32_bf16 v[76:79], v[100:103], v[136:139], v[76:79]
    ds_read_b128 v[200:203], v229 offset:4608
    v_mfma_f32_16x16x32_bf16 v[80:83], v[100:103], v[140:143], v[80:83]
    buffer_load_dwordx4 a[232:235], v253, s[12:15], s77 offen offset:3072 sc1
    v_mfma_f32_16x16x32_bf16 v[84:87], v[100:103], v[144:147], v[84:87]
    ds_read_b64 v[172:173], v224 offset:1856
    v_mfma_f32_16x16x32_bf16 v[88:91], v[100:103], v[148:151], v[88:91]
    ds_read_b64 v[174:175], v224 offset:1864
    v_mfma_f32_16x16x32_bf16 v[92:95], v[100:103], v[152:155], v[92:95]
    ds_read_b128 v[204:207], v229 offset:6656
    v_mfma_f32_16x16x32_bf16 v[72:75], v[104:107], v[128:131], v[72:75]
    buffer_load_dwordx4 a[236:239], v253, s[12:15], s73 offen offset:0 sc1
    s_cmp_eq_u32 s38, 12
    s_cselect_b32 s43, s39, 163840
    s_cmp_eq_u32 s38, 11
    s_cselect_b32 s43, s40, s43
    v_add_u32 v253, s43, v253
    v_mfma_f32_16x16x32_bf16 v[76:79], v[104:107], v[132:135], v[76:79]
    ds_read_b64 v[176:177], v224 offset:2368
    v_mfma_f32_16x16x32_bf16 v[80:83], v[104:107], v[136:139], v[80:83]
    ds_read_b64 v[178:179], v224 offset:2376
    v_mfma_f32_16x16x32_bf16 v[84:87], v[104:107], v[140:143], v[84:87]
    ds_read_b128 v[208:211], v229 offset:8704
    v_mfma_f32_16x16x32_bf16 v[88:91], v[104:107], v[144:147], v[88:91]
    ds_read_b64 v[180:181], v224 offset:2880
    v_mfma_f32_16x16x32_bf16 v[92:95], v[104:107], v[148:151], v[92:95]
    buffer_load_dwordx4 a[240:243], v253, s[12:15], s77 offen offset:0 sc1
    v_mfma_f32_16x16x32_bf16 v[76:79], v[108:111], v[128:131], v[76:79]
    ds_read_b64 v[182:183], v224 offset:2888
    v_mfma_f32_16x16x32_bf16 v[80:83], v[108:111], v[132:135], v[80:83]
    ds_read_b128 v[212:215], v229 offset:10752
    v_mfma_f32_16x16x32_bf16 v[84:87], v[108:111], v[136:139], v[84:87]
    ds_read_b64 v[184:185], v224 offset:3392
    v_mfma_f32_16x16x32_bf16 v[88:91], v[108:111], v[140:143], v[88:91]
    buffer_load_dwordx4 a[244:247], v253, s[12:15], s77 offen offset:1024 sc1
    v_mfma_f32_16x16x32_bf16 v[92:95], v[108:111], v[144:147], v[92:95]
    ds_read_b64 v[186:187], v224 offset:3400
    v_mfma_f32_16x16x32_bf16 v[80:83], v[112:115], v[128:131], v[80:83]
    ds_read_b128 v[216:219], v229 offset:12800
    v_mfma_f32_16x16x32_bf16 v[84:87], v[112:115], v[132:135], v[84:87]
    ds_read_b64 v[188:189], v224 offset:3904
    v_mfma_f32_16x16x32_bf16 v[88:91], v[112:115], v[136:139], v[88:91]
    ds_read_b64 v[190:191], v224 offset:3912
    v_mfma_f32_16x16x32_bf16 v[92:95], v[112:115], v[140:143], v[92:95]
    buffer_load_dwordx4 a[248:251], v253, s[12:15], s77 offen offset:2048 sc1
    v_mfma_f32_16x16x32_bf16 v[84:87], v[116:119], v[128:131], v[84:87]
    ds_read_b128 v[220:223], v229 offset:14848
    v_mfma_f32_16x16x32_bf16 v[88:91], v[116:119], v[132:135], v[88:91]
    v_mfma_f32_16x16x32_bf16 v[92:95], v[116:119], v[136:139], v[92:95]
    v_mfma_f32_16x16x32_bf16 v[88:91], v[120:123], v[128:131], v[88:91]
    buffer_load_dwordx4 a[252:255], v253, s[12:15], s77 offen offset:3072 sc1
    v_mfma_f32_16x16x32_bf16 v[92:95], v[120:123], v[132:135], v[92:95]
    v_mfma_f32_16x16x32_bf16 v[92:95], v[124:127], v[128:131], v[92:95]
    s_waitcnt lgkmcnt(0)
    s_mov_b32 s5, 0
    s_waitcnt vmcnt(17)
L_ptop_47:
    v_cmp_eq_u32_e64 vcc, v56, v255
    s_lshr_b64 s[6:7], vcc, 20
    s_and_b32 s6, s6, 0xffff
    s_cbranch_scc0 L_pok_46
    s_add_u32 s5, s5, 1
    s_cmp_gt_u32 s5, 200000
    s_cbranch_scc1 L_pok_46
    s_sleep 4
L_pld_48:
    s_mov_b64 exec, 0xffff
    s_lshl_b64 exec, exec, 20
    s_mov_b32 s4, 14876672
    buffer_load_dword v56, v254, s[12:15], s4 offen sc1
    s_mov_b64 exec, -1
    s_waitcnt vmcnt(0)
    s_branch L_ptop_47
L_pok_46:
    v_mfma_f32_16x16x32_bf16 v[64:67], v[160:163], v[192:195], v[64:67]
    ds_read_b64 v[96:97], v224 offset:384
    v_mfma_f32_16x16x32_bf16 v[68:71], v[160:163], v[196:199], v[68:71]
    ds_read_b64 v[98:99], v224 offset:392
    v_mfma_f32_16x16x32_bf16 v[72:75], v[160:163], v[200:203], v[72:75]
    ds_read_b128 v[128:131], v230 offset:256
    v_mfma_f32_16x16x32_bf16 v[76:79], v[160:163], v[204:207], v[76:79]
    buffer_load_dwordx4 v[8:11], v248, s[12:15], s76 offen sc1
    v_mfma_f32_16x16x32_bf16 v[80:83], v[160:163], v[208:211], v[80:83]
    ds_read_b64 v[100:101], v224 offset:896
    v_mfma_f32_16x16x32_bf16 v[84:87], v[160:163], v[212:215], v[84:87]
    ds_read_b64 v[102:103], v224 offset:904
    v_mfma_f32_16x16x32_bf16 v[88:91], v[160:163], v[216:219], v[88:91]
    ds_read_b128 v[132:135], v230 offset:2304
    v_mfma_f32_16x16x32_bf16 v[92:95], v[160:163], v[220:223], v[92:95]
    ds_read_b64 v[104:105], v224 offset:1408
    v_mfma_f32_16x16x32_bf16 v[68:71], v[164:167], v[192:195], v[68:71]
    ds_read_b64 v[106:107], v224 offset:1416
    v_mfma_f32_16x16x32_bf16 v[72:75], v[164:167], v[196:199], v[72:75]
    buffer_load_dwordx4 v[12:15], v249, s[12:15], s76 offen sc1
    v_mfma_f32_16x16x32_bf16 v[76:79], v[164:167], v[200:203], v[76:79]
    ds_read_b128 v[136:139], v230 offset:4352
    v_mfma_f32_16x16x32_bf16 v[80:83], v[164:167], v[204:207], v[80:83]
    ds_read_b64 v[108:109], v224 offset:1920
    v_mfma_f32_16x16x32_bf16 v[84:87], v[164:167], v[208:211], v[84:87]
    ds_read_b64 v[110:111], v224 offset:1928
    v_mfma_f32_16x16x32_bf16 v[88:91], v[164:167], v[212:215], v[88:91]
    ds_read_b128 v[140:143], v230 offset:6400
    v_mfma_f32_16x16x32_bf16 v[92:95], v[164:167], v[216:219], v[92:95]
    ds_read_b64 v[112:113], v224 offset:2432
    v_mfma_f32_16x16x32_bf16 v[72:75], v[168:171], v[192:195], v[72:75]
    buffer_load_dwordx4 v[16:19], v250, s[12:15], s76 offen sc1
    v_mfma_f32_16x16x32_bf16 v[76:79], v[168:171], v[196:199], v[76:79]
    ds_read_b64 v[114:115], v224 offset:2440
    v_mfma_f32_16x16x32_bf16 v[80:83], v[168:171], v[200:203], v[80:83]
    ds_read_b128 v[144:147], v230 offset:8448
    v_mfma_f32_16x16x32_bf16 v[84:87], v[168:171], v[204:207], v[84:87]
    ds_read_b64 v[116:117], v224 offset:2944
    v_mfma_f32_16x16x32_bf16 v[88:91], v[168:171], v[208:211], v[88:91]
    ds_read_b64 v[118:119], v224 offset:2952
    v_mfma_f32_16x16x32_bf16 v[92:95], v[168:171], v[212:215], v[92:95]
    ds_read_b128 v[148:151], v230 offset:10496
    v_mfma_f32_16x16x32_bf16 v[76:79], v[172:175], v[192:195], v[76:79]
    buffer_load_dwordx4 v[20:23], v251, s[12:15], s76 offen sc1
    s_cmp_eq_u32 s38, 1
    s_cselect_b32 s43, s41, 4096
    s_cmp_eq_u32 s38, 0
    s_cselect_b32 s43, s42, s43
    s_add_u32 s76, s76, s43
    v_mfma_f32_16x16x32_bf16 v[80:83], v[172:175], v[196:199], v[80:83]
    ds_read_b64 v[120:121], v224 offset:3456
    v_mfma_f32_16x16x32_bf16 v[84:87], v[172:175], v[200:203], v[84:87]
    ds_read_b64 v[122:123], v224 offset:3464
    v_mfma_f32_16x16x32_bf16 v[88:91], v[172:175], v[204:207], v[88:91]
    ds_read_b128 v[152:155], v230 offset:12544
    v_mfma_f32_16x16x32_bf16 v[92:95], v[172:175], v[208:211], v[92:95]
    ds_read_b64 v[124:125], v224 offset:3968
    v_mfma_f32_16x16x32_bf16 v[80:83], v[176:179], v[192:195], v[80:83]
    ds_read_b64 v[126:127], v224 offset:3976
    v_mfma_f32_16x16x32_bf16 v[84:87], v[176:179], v[196:199], v[84:87]
    buffer_load_dwordx4 v[24:27], v248, s[12:15], s76 offen sc1
    v_mfma_f32_16x16x32_bf16 v[88:91], v[176:179], v[200:203], v[88:91]
    ds_read_b128 v[156:159], v230 offset:14592
    v_mfma_f32_16x16x32_bf16 v[92:95], v[176:179], v[204:207], v[92:95]
    v_mfma_f32_16x16x32_bf16 v[84:87], v[180:183], v[192:195], v[84:87]
    v_mfma_f32_16x16x32_bf16 v[88:91], v[180:183], v[196:199], v[88:91]
    v_mfma_f32_16x16x32_bf16 v[92:95], v[180:183], v[200:203], v[92:95]
    v_mfma_f32_16x16x32_bf16 v[88:91], v[184:187], v[192:195], v[88:91]
    buffer_load_dwordx4 v[28:31], v249, s[12:15], s76 offen sc1
    v_mfma_f32_16x16x32_bf16 v[92:95], v[184:187], v[196:199], v[92:95]
    v_mfma_f32_16x16x32_bf16 v[92:95], v[188:191], v[192:195], v[92:95]
    s_waitcnt lgkmcnt(0)
    s_nop 0
    v_mfma_f32_16x16x32_bf16 v[64:67], v[96:99], v[128:131], v[64:67]
    ds_read_b64 v[160:161], v224 offset:448
    v_mfma_f32_16x16x32_bf16 v[68:71], v[96:99], v[132:135], v[68:71]
    ds_read_b64 v[162:163], v224 offset:456
    v_mfma_f32_16x16x32_bf16 v[72:75], v[96:99], v[136:139], v[72:75]
    ds_read_b128 v[192:195], v231 offset:0
    v_mfma_f32_16x16x32_bf16 v[76:79], v[96:99], v[140:143], v[76:79]
    buffer_load_dwordx4 v[32:35], v250, s[12:15], s76 offen sc1
    v_mfma_f32_16x16x32_bf16 v[80:83], v[96:99], v[144:147], v[80:83]
    ds_read_b64 v[164:165], v224 offset:960
    v_mfma_f32_16x16x32_bf16 v[84:87], v[96:99], v[148:151], v[84:87]
    ds_read_b64 v[166:167], v224 offset:968
    v_mfma_f32_16x16x32_bf16 v[88:91], v[96:99], v[152:155], v[88:91]
    ds_read_b128 v[196:199], v231 offset:2048
    v_mfma_f32_16x16x32_bf16 v[92:95], v[96:99], v[156:159], v[92:95]
    ds_read_b64 v[168:169], v224 offset:1472
    v_mfma_f32_16x16x32_bf16 v[68:71], v[100:103], v[128:131], v[68:71]
    ds_read_b64 v[170:171], v224 offset:1480
    v_mfma_f32_16x16x32_bf16 v[72:75], v[100:103], v[132:135], v[72:75]
    buffer_load_dwordx4 v[36:39], v251, s[12:15], s76 offen sc1
    s_cmp_eq_u32 s38, 2
    s_cselect_b32 s43, s41, 4096
    s_cmp_eq_u32 s38, 1
    s_cselect_b32 s43, s42, s43
    s_add_u32 s76, s76, s43
    v_mfma_f32_16x16x32_bf16 v[76:79], v[100:103], v[136:139], v[76:79]
    ds_read_b128 v[200:203], v231 offset:4096
    v_mfma_f32_16x16x32_bf16 v[80:83], v[100:103], v[140:143], v[80:83]
    ds_read_b64 v[172:173], v224 offset:1984
    v_mfma_f32_16x16x32_bf16 v[84:87], v[100:103], v[144:147], v[84:87]
    ds_read_b64 v[174:175], v224 offset:1992
    v_mfma_f32_16x16x32_bf16 v[88:91], v[100:103], v[148:151], v[88:91]
    ds_read_b128 v[204:207], v231 offset:6144
    v_mfma_f32_16x16x32_bf16 v[92:95], v[100:103], v[152:155], v[92:95]
    ds_read_b64 v[176:177], v224 offset:2496
    v_mfma_f32_16x16x32_bf16 v[72:75], v[104:107], v[128:131], v[72:75]
    buffer_load_dwordx4 v[40:43], v248, s[12:15], s76 offen sc1
    v_mfma_f32_16x16x32_bf16 v[76:79], v[104:107], v[132:135], v[76:79]
    ds_read_b64 v[178:179], v224 offset:2504
    v_mfma_f32_16x16x32_bf16 v[80:83], v[104:107], v[136:139], v[80:83]
    ds_read_b128 v[208:211], v231 offset:8192
    v_mfma_f32_16x16x32_bf16 v[84:87], v[104:107], v[140:143], v[84:87]
    ds_read_b64 v[180:181], v224 offset:3008
    v_mfma_f32_16x16x32_bf16 v[88:91], v[104:107], v[144:147], v[88:91]
    ds_read_b64 v[182:183], v224 offset:3016
    v_mfma_f32_16x16x32_bf16 v[92:95], v[104:107], v[148:151], v[92:95]
    ds_read_b128 v[212:215], v231 offset:10240
    v_mfma_f32_16x16x32_bf16 v[76:79], v[108:111], v[128:131], v[76:79]
    buffer_load_dwordx4 v[44:47], v249, s[12:15], s76 offen sc1
    v_mfma_f32_16x16x32_bf16 v[80:83], v[108:111], v[132:135], v[80:83]
    ds_read_b64 v[184:185], v224 offset:3520
    v_mfma_f32_16x16x32_bf16 v[84:87], v[108:111], v[136:139], v[84:87]
    ds_read_b64 v[186:187], v224 offset:3528
    v_mfma_f32_16x16x32_bf16 v[88:91], v[108:111], v[140:143], v[88:91]
    ds_read_b128 v[216:219], v231 offset:12288
    v_mfma_f32_16x16x32_bf16 v[92:95], v[108:111], v[144:147], v[92:95]
    ds_read_b64 v[188:189], v224 offset:4032
    v_mfma_f32_16x16x32_bf16 v[80:83], v[112:115], v[128:131], v[80:83]
    ds_read_b64 v[190:191], v224 offset:4040
    v_mfma_f32_16x16x32_bf16 v[84:87], v[112:115], v[132:135], v[84:87]
    buffer_load_dwordx4 v[48:51], v250, s[12:15], s76 offen sc1
    v_mfma_f32_16x16x32_bf16 v[88:91], v[112:115], v[136:139], v[88:91]
    ds_read_b128 v[220:223], v231 offset:14336
    v_mfma_f32_16x16x32_bf16 v[92:95], v[112:115], v[140:143], v[92:95]
    v_mfma_f32_16x16x32_bf16 v[84:87], v[116:119], v[128:131], v[84:87]
    v_mfma_f32_16x16x32_bf16 v[88:91], v[116:119], v[132:135], v[88:91]
    v_mfma_f32_16x16x32_bf16 v[92:95], v[116:119], v[136:139], v[92:95]
    v_mfma_f32_16x16x32_bf16 v[88:91], v[120:123], v[128:131], v[88:91]
    buffer_load_dwordx4 v[52:55], v251, s[12:15], s76 offen sc1
    s_cmp_eq_u32 s38, 3
    s_cselect_b32 s43, s41, 4096
    s_cmp_eq_u32 s38, 2
    s_cselect_b32 s43, s42, s43
    s_add_u32 s76, s76, s43
    v_mfma_f32_16x16x32_bf16 v[92:95], v[120:123], v[132:135], v[92:95]
    v_mfma_f32_16x16x32_bf16 v[92:95], v[124:127], v[128:131], v[92:95]
    s_waitcnt lgkmcnt(0)
    s_nop 0
    v_mfma_f32_16x16x32_bf16 v[64:67], v[160:163], v[192:195], v[64:67]
    v_mfma_f32_16x16x32_bf16 v[68:71], v[160:163], v[196:199], v[68:71]
    v_mfma_f32_16x16x32_bf16 v[72:75], v[160:163], v[200:203], v[72:75]
    buffer_load_dwordx4 v[144:147], v248, s[12:15], s76 offen sc1
    v_mfma_f32_16x16x32_bf16 v[76:79], v[160:163], v[204:207], v[76:79]
    v_mfma_f32_16x16x32_bf16 v[80:83], v[160:163], v[208:211], v[80:83]
    v_mfma_f32_16x16x32_bf16 v[84:87], v[160:163], v[212:215], v[84:87]
    v_mfma_f32_16x16x32_bf16 v[88:91], v[160:163], v[216:219], v[88:91]
    buffer_load_dwordx4 v[148:151], v249, s[12:15], s76 offen sc1
    v_mfma_f32_16x16x32_bf16 v[92:95], v[160:163], v[220:223], v[92:95]
    v_mfma_f32_16x16x32_bf16 v[68:71], v[164:167], v[192:195], v[68:71]
    v_mfma_f32_16x16x32_bf16 v[72:75], v[164:167], v[196:199], v[72:75]
    v_mfma_f32_16x16x32_bf16 v[76:79], v[164:167], v[200:203], v[76:79]
    v_mfma_f32_16x16x32_bf16 v[80:83], v[164:167], v[204:207], v[80:83]
    buffer_load_dwordx4 v[152:155], v250, s[12:15], s76 offen sc1
    v_mfma_f32_16x16x32_bf16 v[84:87], v[164:167], v[208:211], v[84:87]
    v_mfma_f32_16x16x32_bf16 v[88:91], v[164:167], v[212:215], v[88:91]
    v_mfma_f32_16x16x32_bf16 v[92:95], v[164:167], v[216:219], v[92:95]
    v_mfma_f32_16x16x32_bf16 v[72:75], v[168:171], v[192:195], v[72:75]
    buffer_load_dwordx4 v[156:159], v251, s[12:15], s76 offen sc1
    s_cmp_eq_u32 s38, 4
    s_cselect_b32 s43, s41, 4096
    s_cmp_eq_u32 s38, 3
    s_cselect_b32 s43, s42, s43
    s_add_u32 s76, s76, s43
    v_mfma_f32_16x16x32_bf16 v[76:79], v[168:171], v[196:199], v[76:79]
    v_mfma_f32_16x16x32_bf16 v[80:83], v[168:171], v[200:203], v[80:83]
    v_mfma_f32_16x16x32_bf16 v[84:87], v[168:171], v[204:207], v[84:87]
    v_mfma_f32_16x16x32_bf16 v[88:91], v[168:171], v[208:211], v[88:91]
    v_mfma_f32_16x16x32_bf16 v[92:95], v[168:171], v[212:215], v[92:95]
    buffer_load_dwordx4 v[232:235], v248, s[12:15], s76 offen sc1
    v_mfma_f32_16x16x32_bf16 v[76:79], v[172:175], v[192:195], v[76:79]
    v_mfma_f32_16x16x32_bf16 v[80:83], v[172:175], v[196:199], v[80:83]
    v_mfma_f32_16x16x32_bf16 v[84:87], v[172:175], v[200:203], v[84:87]
    v_mfma_f32_16x16x32_bf16 v[88:91], v[172:175], v[204:207], v[88:91]
    buffer_load_dwordx4 v[236:239], v249, s[12:15], s76 offen sc1
    v_mfma_f32_16x16x32_bf16 v[92:95], v[172:175], v[208:211], v[92:95]
    v_mfma_f32_16x16x32_bf16 v[80:83], v[176:179], v[192:195], v[80:83]
    v_mfma_f32_16x16x32_bf16 v[84:87], v[176:179], v[196:199], v[84:87]
    v_mfma_f32_16x16x32_bf16 v[88:91], v[176:179], v[200:203], v[88:91]
    v_mfma_f32_16x16x32_bf16 v[92:95], v[176:179], v[204:207], v[92:95]
    buffer_load_dwordx4 v[240:243], v250, s[12:15], s76 offen sc1
    v_mfma_f32_16x16x32_bf16 v[84:87], v[180:183], v[192:195], v[84:87]
    v_mfma_f32_16x16x32_bf16 v[88:91], v[180:183], v[196:199], v[88:91]
    v_mfma_f32_16x16x32_bf16 v[92:95], v[180:183], v[200:203], v[92:95]
    v_mfma_f32_16x16x32_bf16 v[88:91], v[184:187], v[192:195], v[88:91]
    buffer_load_dwordx4 v[244:247], v251, s[12:15], s76 offen sc1
    s_cmp_eq_u32 s38, 5
    s_cselect_b32 s43, s41, 4096
    s_cmp_eq_u32 s38, 4
    s_cselect_b32 s43, s42, s43
    s_add_u32 s76, s76, s43
    v_mfma_f32_16x16x32_bf16 v[92:95], v[184:187], v[196:199], v[92:95]
    v_mfma_f32_16x16x32_bf16 v[92:95], v[188:191], v[192:195], v[92:95]
    v_and_b32 v2, 15, v0
    v_lshlrev_b32 v2, 5, v2
    v_bfe_u32 v3, v0, 4, 1
    v_lshl_add_u32 v2, v3, 9, v2
    v_lshrrev_b32_e64 v3, 5, v0
    v_lshl_add_u32 v224, v3, 4, v2
    s_lshl_b32 s45, s72, 12
    s_nop 0
    s_add_u32 s45, s45, 2686976
    v_cvt_pk_bf16_f32 v208, v64, v65
    v_cvt_pk_bf16_f32 v209, v66, v67
    v_cvt_pk_bf16_f32 v210, v68, v69
    v_cvt_pk_bf16_f32 v211, v70, v71
    v_cvt_pk_bf16_f32 v212, v72, v73
    v_cvt_pk_bf16_f32 v213, v74, v75
    v_cvt_pk_bf16_f32 v214, v76, v77
    v_cvt_pk_bf16_f32 v215, v78, v79
    v_cvt_pk_bf16_f32 v216, v80, v81
    v_cvt_pk_bf16_f32 v217, v82, v83
    v_cvt_pk_bf16_f32 v218, v84, v85
    v_cvt_pk_bf16_f32 v219, v86, v87
    v_cvt_pk_bf16_f32 v220, v88, v89
    v_cvt_pk_bf16_f32 v221, v90, v91
    v_cvt_pk_bf16_f32 v222, v92, v93
    v_cvt_pk_bf16_f32 v223, v94, v95
    s_nop 0
    v_permlane16_swap_b32 v208, v210
    v_permlane16_swap_b32 v209, v211
    v_permlane16_swap_b32 v212, v214
    v_permlane16_swap_b32 v213, v215
    v_permlane16_swap_b32 v216, v218
    v_permlane16_swap_b32 v217, v219
    v_permlane16_swap_b32 v220, v222
    v_permlane16_swap_b32 v221, v223
    s_waitcnt vmcnt(16)
    v_mfma_f32_16x16x32_bf16 v[64:67], a[0:3], v[8:11], 0
    v_mfma_f32_16x16x32_bf16 v[68:71], a[4:7], v[8:11], 0
    buffer_load_dwordx4 v[160:163], v248, s[12:15], s76 offen sc1
    v_mfma_f32_16x16x32_bf16 v[72:75], a[8:11], v[8:11], 0
    buffer_load_dwordx4 v[164:167], v249, s[12:15], s76 offen sc1
    v_mfma_f32_16x16x32_bf16 v[76:79], a[12:15], v[8:11], 0
    v_mfma_f32_16x16x32_bf16 v[80:83], a[16:19], v[8:11], 0
    buffer_load_dwordx4 v[168:171], v250, s[12:15], s76 offen sc1
    v_mfma_f32_16x16x32_bf16 v[84:87], a[0:3], v[12:15], 0
    buffer_load_dwordx4 v[172:175], v251, s[12:15], s76 offen sc1
    v_mfma_f32_16x16x32_bf16 v[88:91], a[4:7], v[12:15], 0
    v_mfma_f32_16x16x32_bf16 v[92:95], a[8:11], v[12:15], 0
    s_cmp_eq_u32 s38, 6
    s_cselect_b32 s43, s41, 4096
    s_cmp_eq_u32 s38, 5
    s_cselect_b32 s43, s42, s43
    s_add_u32 s76, s76, s43
    v_mfma_f32_16x16x32_bf16 v[96:99], a[12:15], v[12:15], 0
    buffer_load_dwordx4 v[176:179], v248, s[12:15], s76 offen sc1
    v_mfma_f32_16x16x32_bf16 v[100:103], a[16:19], v[12:15], 0
    buffer_load_dwordx4 v[180:183], v249, s[12:15], s76 offen sc1
    v_mfma_f32_16x16x32_bf16 v[104:107], a[0:3], v[16:19], 0
    v_mfma_f32_16x16x32_bf16 v[108:111], a[4:7], v[16:19], 0
    buffer_load_dwordx4 v[184:187], v250, s[12:15], s76 offen sc1
    v_mfma_f32_16x16x32_bf16 v[112:115], a[8:11], v[16:19], 0
    buffer_load_dwordx4 v[188:191], v251, s[12:15], s76 offen sc1
    v_mfma_f32_16x16x32_bf16 v[116:119], a[12:15], v[16:19], 0
    v_mfma_f32_16x16x32_bf16 v[120:123], a[16:19], v[16:19], 0
    s_cmp_eq_u32 s38, 7
    s_cselect_b32 s43, s41, 4096
    s_cmp_eq_u32 s38, 6
    s_cselect_b32 s43, s42, s43
    s_add_u32 s76, s76, s43
    v_mfma_f32_16x16x32_bf16 v[124:127], a[0:3], v[20:23], 0
    buffer_store_dwordx4 v[208:211], v224, s[12:15], s45 offen offset:0 sc1
    v_mfma_f32_16x16x32_bf16 v[128:131], a[4:7], v[20:23], 0
    v_mfma_f32_16x16x32_bf16 v[132:135], a[8:11], v[20:23], 0
    buffer_store_dwordx4 v[212:215], v224, s[12:15], s45 offen offset:1024 sc1
    v_mfma_f32_16x16x32_bf16 v[136:139], a[12:15], v[20:23], 0
    buffer_store_dwordx4 v[216:219], v224, s[12:15], s45 offen offset:2048 sc1
    v_mfma_f32_16x16x32_bf16 v[140:143], a[16:19], v[20:23], 0
    buffer_store_dwordx4 v[220:223], v224, s[12:15], s45 offen offset:3072 sc1
    s_waitcnt vmcnt(24)
    s_nop 0
    v_mfma_f32_16x16x32_bf16 v[64:67], a[20:23], v[24:27], v[64:67]
    v_mfma_f32_16x16x32_bf16 v[68:71], a[24:27], v[24:27], v[68:71]
    buffer_load_dwordx4 v[192:195], v248, s[12:15], s76 offen sc1
    v_mfma_f32_16x16x32_bf16 v[72:75], a[28:31], v[24:27], v[72:75]
    v_mfma_f32_16x16x32_bf16 v[76:79], a[32:35], v[24:27], v[76:79]
    buffer_load_dwordx4 v[196:199], v249, s[12:15], s76 offen sc1
    v_mfma_f32_16x16x32_bf16 v[80:83], a[36:39], v[24:27], v[80:83]
    v_mfma_f32_16x16x32_bf16 v[84:87], a[20:23], v[28:31], v[84:87]
    buffer_load_dwordx4 v[200:203], v250, s[12:15], s76 offen sc1
    v_mfma_f32_16x16x32_bf16 v[88:91], a[24:27], v[28:31], v[88:91]
    v_mfma_f32_16x16x32_bf16 v[92:95], a[28:31], v[28:31], v[92:95]
    buffer_load_dwordx4 v[204:207], v251, s[12:15], s76 offen sc1
    v_mfma_f32_16x16x32_bf16 v[96:99], a[32:35], v[28:31], v[96:99]
    v_mfma_f32_16x16x32_bf16 v[100:103], a[36:39], v[28:31], v[100:103]
    s_cmp_eq_u32 s38, 8
    s_cselect_b32 s43, s41, 4096
    s_cmp_eq_u32 s38, 7
    s_cselect_b32 s43, s42, s43
    s_add_u32 s76, s76, s43
    v_mfma_f32_16x16x32_bf16 v[104:107], a[20:23], v[32:35], v[104:107]
    v_mfma_f32_16x16x32_bf16 v[108:111], a[24:27], v[32:35], v[108:111]
    buffer_load_dwordx4 a[0:3], v248, s[12:15], s76 offen sc1
    v_mfma_f32_16x16x32_bf16 v[112:115], a[28:31], v[32:35], v[112:115]
    v_mfma_f32_16x16x32_bf16 v[116:119], a[32:35], v[32:35], v[116:119]
    buffer_load_dwordx4 a[4:7], v249, s[12:15], s76 offen sc1
    v_mfma_f32_16x16x32_bf16 v[120:123], a[36:39], v[32:35], v[120:123]
    v_mfma_f32_16x16x32_bf16 v[124:127], a[20:23], v[36:39], v[124:127]
    buffer_load_dwordx4 a[8:11], v250, s[12:15], s76 offen sc1
    v_mfma_f32_16x16x32_bf16 v[128:131], a[24:27], v[36:39], v[128:131]
    v_mfma_f32_16x16x32_bf16 v[132:135], a[28:31], v[36:39], v[132:135]
    buffer_load_dwordx4 a[12:15], v251, s[12:15], s76 offen sc1
    v_mfma_f32_16x16x32_bf16 v[136:139], a[32:35], v[36:39], v[136:139]
    v_mfma_f32_16x16x32_bf16 v[140:143], a[36:39], v[36:39], v[140:143]
    s_cmp_eq_u32 s38, 9
    s_cselect_b32 s43, s41, 4096
    s_cmp_eq_u32 s38, 8
    s_cselect_b32 s43, s42, s43
    s_add_u32 s76, s76, s43
    s_waitcnt vmcnt(28)
    s_nop 0
    v_mfma_f32_16x16x32_bf16 v[64:67], a[40:43], v[40:43], v[64:67]
    v_mfma_f32_16x16x32_bf16 v[68:71], a[44:47], v[40:43], v[68:71]
    v_mfma_f32_16x16x32_bf16 v[72:75], a[48:51], v[40:43], v[72:75]
    v_mfma_f32_16x16x32_bf16 v[76:79], a[52:55], v[40:43], v[76:79]
    buffer_load_dwordx4 a[20:23], v248, s[12:15], s76 offen sc1
    v_mfma_f32_16x16x32_bf16 v[80:83], a[56:59], v[40:43], v[80:83]
    v_mfma_f32_16x16x32_bf16 v[84:87], a[40:43], v[44:47], v[84:87]
    v_mfma_f32_16x16x32_bf16 v[88:91], a[44:47], v[44:47], v[88:91]
    v_mfma_f32_16x16x32_bf16 v[92:95], a[48:51], v[44:47], v[92:95]
    buffer_load_dwordx4 a[24:27], v249, s[12:15], s76 offen sc1
    v_mfma_f32_16x16x32_bf16 v[96:99], a[52:55], v[44:47], v[96:99]
    v_mfma_f32_16x16x32_bf16 v[100:103], a[56:59], v[44:47], v[100:103]
    v_mfma_f32_16x16x32_bf16 v[104:107], a[40:43], v[48:51], v[104:107]
    v_mfma_f32_16x16x32_bf16 v[108:111], a[44:47], v[48:51], v[108:111]
    buffer_load_dwordx4 a[28:31], v250, s[12:15], s76 offen sc1
    v_mfma_f32_16x16x32_bf16 v[112:115], a[48:51], v[48:51], v[112:115]
    v_mfma_f32_16x16x32_bf16 v[116:119], a[52:55], v[48:51], v[116:119]
    v_mfma_f32_16x16x32_bf16 v[120:123], a[56:59], v[48:51], v[120:123]
    v_mfma_f32_16x16x32_bf16 v[124:127], a[40:43], v[52:55], v[124:127]
    buffer_load_dwordx4 a[32:35], v251, s[12:15], s76 offen sc1
    v_mfma_f32_16x16x32_bf16 v[128:131], a[44:47], v[52:55], v[128:131]
    v_mfma_f32_16x16x32_bf16 v[132:135], a[48:51], v[52:55], v[132:135]
    v_mfma_f32_16x16x32_bf16 v[136:139], a[52:55], v[52:55], v[136:139]
    v_mfma_f32_16x16x32_bf16 v[140:143], a[56:59], v[52:55], v[140:143]
    s_cmp_eq_u32 s38, 10
    s_cselect_b32 s43, s41, 4096
    s_cmp_eq_u32 s38, 9
    s_cselect_b32 s43, s42, s43
    s_add_u32 s76, s76, s43
    s_waitcnt vmcnt(28)
    v_mfma_f32_16x16x32_bf16 v[64:67], a[60:63], v[144:147], v[64:67]
    v_add_u32 v6, 0, v0
    v_mfma_f32_16x16x32_bf16 v[68:71], a[64:67], v[144:147], v[68:71]
    v_mul_u32_u24 v7, 6554, v6
    v_mfma_f32_16x16x32_bf16 v[72:75], a[68:71], v[144:147], v[72:75]
    v_lshrrev_b32_e64 v7, 16, v7
    buffer_load_dwordx4 a[40:43], v248, s[12:15], s76 offen sc1
    v_mfma_f32_16x16x32_bf16 v[76:79], a[72:75], v[144:147], v[76:79]
    v_mul_u32_u24 v50, 1120, v7
    v_mfma_f32_16x16x32_bf16 v[80:83], a[76:79], v[144:147], v[80:83]
    v_lshl_add_u32 v50, v6, 4, v50
    v_add_u32_e64 v6, 64, v0
    v_mfma_f32_16x16x32_bf16 v[84:87], a[60:63], v[148:151], v[84:87]
    v_mul_u32_u24 v7, 6554, v6
    v_mfma_f32_16x16x32_bf16 v[88:91], a[64:67], v[148:151], v[88:91]
    buffer_load_dwordx4 a[44:47], v249, s[12:15], s76 offen sc1
    v_mfma_f32_16x16x32_bf16 v[92:95], a[68:71], v[148:151], v[92:95]
    v_lshrrev_b32_e64 v7, 16, v7
    v_mul_u32_u24 v51, 1120, v7
    v_mfma_f32_16x16x32_bf16 v[96:99], a[72:75], v[148:151], v[96:99]
    v_lshl_add_u32 v51, v6, 4, v51
    v_mfma_f32_16x16x32_bf16 v[100:103], a[76:79], v[148:151], v[100:103]
    v_add_u32 v6, 128, v0
    v_mul_u32_u24 v7, 6554, v6
    v_mfma_f32_16x16x32_bf16 v[104:107], a[60:63], v[152:155], v[104:107]
    buffer_load_dwordx4 a[48:51], v250, s[12:15], s76 offen sc1
    v_mfma_f32_16x16x32_bf16 v[108:111], a[64:67], v[152:155], v[108:111]
    v_lshrrev_b32_e64 v7, 16, v7
    v_mfma_f32_16x16x32_bf16 v[112:115], a[68:71], v[152:155], v[112:115]
    v_mul_u32_u24 v52, 1120, v7
    v_lshl_add_u32 v52, v6, 4, v52
    v_mfma_f32_16x16x32_bf16 v[116:119], a[72:75], v[152:155], v[116:119]
    v_cmp_gt_u32_e64 vcc, 32, v0
    v_mfma_f32_16x16x32_bf16 v[120:123], a[76:79], v[152:155], v[120:123]
    v_mov_b32 v6, 16777216
    buffer_load_dwordx4 a[52:55], v251, s[12:15], s76 offen sc1
    v_mfma_f32_16x16x32_bf16 v[124:127], a[60:63], v[156:159], v[124:127]
    s_lshl_b32 s30, s74, 2
    v_mfma_f32_16x16x32_bf16 v[128:131], a[64:67], v[156:159], v[128:131]
    s_add_u32 s30, s30, s3
    v_mfma_f32_16x16x32_bf16 v[132:135], a[68:71], v[156:159], v[132:135]
    s_mul_i32 s32, s75, 160
    s_mul_i32 s35, s30, 20480
    v_mfma_f32_16x16x32_bf16 v[136:139], a[72:75], v[156:159], v[136:139]
    s_cmp_eq_u32 s38, 11
    s_cselect_b32 s43, s41, 4096
    s_cmp_eq_u32 s38, 10
    s_cselect_b32 s43, s42, s43
    s_add_u32 s76, s76, s43
    v_mfma_f32_16x16x32_bf16 v[140:143], a[76:79], v[156:159], v[140:143]
    s_add_u32 s35, s35, s32
    v_cndmask_b32 v52, v6, v52, vcc
    s_waitcnt vmcnt(16)
    s_barrier
    s_cmp_lg_u32 s3, 0
    s_cbranch_scc1 L_pub_49
    s_mov_b64 exec, 1
    s_lshl_b64 exec, exec, 37
    s_mov_b32 s4, 14876672
    v_add_u32_e64 v2, 1, v255
    buffer_store_dword v2, v254, s[12:15], s4 offen sc1
    s_mov_b64 exec, -1
L_pub_49:
    s_waitcnt vmcnt(28)
    v_mfma_f32_16x16x32_bf16 v[64:67], a[80:83], v[232:235], v[64:67]
    buffer_load_dwordx4 a[60:63], v248, s[12:15], s76 offen sc1
    v_mfma_f32_16x16x32_bf16 v[68:71], a[84:87], v[232:235], v[68:71]
    buffer_load_dwordx4 a[64:67], v249, s[12:15], s76 offen sc1
    v_mfma_f32_16x16x32_bf16 v[72:75], a[88:91], v[232:235], v[72:75]
    buffer_load_dwordx4 a[68:71], v250, s[12:15], s76 offen sc1
    v_mfma_f32_16x16x32_bf16 v[76:79], a[92:95], v[232:235], v[76:79]
    buffer_load_dwordx4 a[72:75], v251, s[12:15], s76 offen sc1
    v_mfma_f32_16x16x32_bf16 v[80:83], a[96:99], v[232:235], v[80:83]
    s_cmp_eq_u32 s38, 12
    s_cselect_b32 s43, s41, 4096
    s_cmp_eq_u32 s38, 11
    s_cselect_b32 s43, s42, s43
    s_add_u32 s76, s76, s43
    buffer_load_dwordx4 v[8:11], v50, s[8:11], s35 offen
    v_mfma_f32_16x16x32_bf16 v[84:87], a[80:83], v[236:239], v[84:87]
    buffer_load_dwordx4 v[12:15], v51, s[8:11], s35 offen
    v_mfma_f32_16x16x32_bf16 v[88:91], a[84:87], v[236:239], v[88:91]
    buffer_load_dwordx4 v[16:19], v52, s[8:11], s35 offen
    v_mfma_f32_16x16x32_bf16 v[92:95], a[88:91], v[236:239], v[92:95]
    v_lshlrev_b32_e64 v3, 2, v0
    v_mfma_f32_16x16x32_bf16 v[96:99], a[92:95], v[236:239], v[96:99]
    s_mov_b32 s20, s58
    v_mfma_f32_16x16x32_bf16 v[100:103], a[96:99], v[236:239], v[100:103]
    s_mov_b32 s21, s59
    s_mov_b32 s22, 1280
    v_mfma_f32_16x16x32_bf16 v[104:107], a[80:83], v[240:243], v[104:107]
    s_mov_b32 s23, 0x00020000
    v_mfma_f32_16x16x32_bf16 v[108:111], a[84:87], v[240:243], v[108:111]
    buffer_load_dword v20, v3, s[20:23], s32 offen
    v_mfma_f32_16x16x32_bf16 v[112:115], a[88:91], v[240:243], v[112:115]
    s_mov_b32 s20, s48
    v_mfma_f32_16x16x32_bf16 v[116:119], a[92:95], v[240:243], v[116:119]
    s_mov_b32 s21, s49
    v_mfma_f32_16x16x32_bf16 v[120:123], a[96:99], v[240:243], v[120:123]
    s_mov_b32 s22, 1280
    s_mov_b32 s23, 0x00020000
    v_mfma_f32_16x16x32_bf16 v[124:127], a[80:83], v[244:247], v[124:127]
    buffer_load_dword v21, v3, s[20:23], s32 offen
    v_mfma_f32_16x16x32_bf16 v[128:131], a[84:87], v[244:247], v[128:131]
    v_and_b32_e64 v2, 15, v0
    v_mfma_f32_16x16x32_bf16 v[132:135], a[88:91], v[244:247], v[132:135]
    v_lshlrev_b32_e64 v2, 4, v2
    v_mfma_f32_16x16x32_bf16 v[136:139], a[92:95], v[244:247], v[136:139]
    s_lshl_b32 s30, s30, 8
    v_mfma_f32_16x16x32_bf16 v[140:143], a[96:99], v[244:247], v[140:143]
    s_add_u32 s30, s30, 2621440
    buffer_load_dwordx2 v[38:39], v2, s[12:15], s30 offen offset:8 sc1
    s_waitcnt vmcnt(34)
    v_mfma_f32_16x16x32_bf16 v[64:67], a[100:103], v[160:163], v[64:67]
    s_mul_i32 s4, s3, 2560
    s_add_u32 s34, s4, 97280
    v_mfma_f32_16x16x32_bf16 v[68:71], a[104:107], v[160:163], v[68:71]
    v_add_u32 v53, s34, v252
    v_min_u32 v2, 39, v0
    v_mfma_f32_16x16x32_bf16 v[72:75], a[108:111], v[160:163], v[72:75]
    v_lshlrev_b32_e64 v2, 3, v2
    buffer_load_dwordx4 a[80:83], v248, s[12:15], s76 offen sc1
    v_mfma_f32_16x16x32_bf16 v[76:79], a[112:115], v[160:163], v[76:79]
    v_add_u32 v2, 107520, v2
    v_and_b32_e64 v4, 15, v0
    v_mul_u32_u24 v4, 160, v4
    v_mfma_f32_16x16x32_bf16 v[80:83], a[116:119], v[160:163], v[80:83]
    v_lshrrev_b32_e64 v5, 4, v0
    v_lshl_add_u32 v4, v5, 3, v4
    v_mfma_f32_16x16x32_bf16 v[84:87], a[100:103], v[164:167], v[84:87]
    v_add_u32 v54, s34, v4
    v_lshlrev_b32 v5, 4, v5
    v_mfma_f32_16x16x32_bf16 v[88:91], a[104:107], v[164:167], v[88:91]
    v_add_u32 v55, 107520, v5
    buffer_load_dwordx4 a[84:87], v249, s[12:15], s76 offen sc1
    s_lshl_b32 s5, s3, 10
    v_mfma_f32_16x16x32_bf16 v[92:95], a[108:111], v[164:167], v[92:95]
    s_add_u32 s5, s5, 84992
    v_add_u32 v6, s5, v252
    v_mfma_f32_16x16x32_bf16 v[96:99], a[112:115], v[164:167], v[96:99]
    s_add_u32 s4, s3, 1
    s_and_b32 s4, s4, 3
    v_mfma_f32_16x16x32_bf16 v[100:103], a[116:119], v[164:167], v[100:103]
    s_mul_i32 s4, s4, 15360
    s_add_u32 s4, s4, 0
    v_add_u32 v3, s4, v252
    v_mfma_f32_16x16x32_bf16 v[104:107], a[100:103], v[168:171], v[104:107]
    buffer_load_dwordx4 a[88:91], v250, s[12:15], s76 offen sc1
    s_add_u32 s4, s3, 2
    v_mfma_f32_16x16x32_bf16 v[108:111], a[104:107], v[168:171], v[108:111]
    s_and_b32 s4, s4, 3
    s_mul_i32 s4, s4, 15360
    v_mfma_f32_16x16x32_bf16 v[112:115], a[108:111], v[168:171], v[112:115]
    s_add_u32 s4, s4, 5120
    v_add_u32_e64 v4, s4, v252
    v_mfma_f32_16x16x32_bf16 v[116:119], a[112:115], v[168:171], v[116:119]
    s_add_u32 s4, s3, 3
    s_and_b32 s4, s4, 3
    s_mul_i32 s4, s4, 15360
    v_mfma_f32_16x16x32_bf16 v[120:123], a[116:119], v[168:171], v[120:123]
    s_add_u32 s4, s4, 10240
    buffer_load_dwordx4 a[92:95], v251, s[12:15], s76 offen sc1
    v_mfma_f32_16x16x32_bf16 v[124:127], a[100:103], v[172:175], v[124:127]
    v_add_u32_e64 v5, s4, v252
    s_mul_i32 s4, s3, 15360
    v_mfma_f32_16x16x32_bf16 v[128:131], a[104:107], v[172:175], v[128:131]
    s_add_u32 s4, s4, 0
    v_add_u32 v48, s4, v252
    v_lshrrev_b32_e64 v49, 2, v0
    v_mfma_f32_16x16x32_bf16 v[132:135], a[108:111], v[172:175], v[132:135]
    v_lshlrev_b32 v49, 7, v49
    v_and_b32 v7, 3, v0
    v_mfma_f32_16x16x32_bf16 v[136:139], a[112:115], v[172:175], v[136:139]
    v_lshl_add_u32 v49, v7, 3, v49
    s_cmp_eq_u32 s38, 13
    s_cselect_b32 s43, s41, 4096
    s_cmp_eq_u32 s38, 12
    s_cselect_b32 s43, s42, s43
    s_add_u32 s76, s76, s43
    v_mfma_f32_16x16x32_bf16 v[140:143], a[116:119], v[172:175], v[140:143]
    s_lshl_b32 s4, s3, 5
    s_add_u32 s4, s4, 84992
    v_add_u32_e64 v49, s4, v49
    s_waitcnt vmcnt(34)
    v_mfma_f32_16x16x32_bf16 v[64:67], a[120:123], v[176:179], v[64:67]
    v_mfma_f32_16x16x32_bf16 v[68:71], a[124:127], v[176:179], v[68:71]
    buffer_load_dwordx4 a[100:103], v248, s[12:15], s76 offen sc1
    v_mfma_f32_16x16x32_bf16 v[72:75], a[128:131], v[176:179], v[72:75]
    v_mfma_f32_16x16x32_bf16 v[76:79], a[132:135], v[176:179], v[76:79]
    buffer_load_dwordx4 a[104:107], v249, s[12:15], s76 offen sc1
    v_mfma_f32_16x16x32_bf16 v[80:83], a[136:139], v[176:179], v[80:83]
    v_mfma_f32_16x16x32_bf16 v[84:87], a[120:123], v[180:183], v[84:87]
    buffer_load_dwordx4 a[108:111], v250, s[12:15], s76 offen sc1
    v_mfma_f32_16x16x32_bf16 v[88:91], a[124:127], v[180:183], v[88:91]
    v_mfma_f32_16x16x32_bf16 v[92:95], a[128:131], v[180:183], v[92:95]
    buffer_load_dwordx4 a[112:115], v251, s[12:15], s76 offen sc1
    v_mfma_f32_16x16x32_bf16 v[96:99], a[132:135], v[180:183], v[96:99]
    v_mfma_f32_16x16x32_bf16 v[100:103], a[136:139], v[180:183], v[100:103]
    buffer_load_dwordx4 a[16:19], v253, s[12:15], s73 offen offset:0 sc1
    v_mfma_f32_16x16x32_bf16 v[104:107], a[120:123], v[184:187], v[104:107]
    s_cmp_eq_u32 s38, 13
    s_cselect_b32 s43, s39, 163840
    s_cmp_eq_u32 s38, 12
    s_cselect_b32 s43, s40, s43
    v_add_u32 v253, s43, v253
    v_mfma_f32_16x16x32_bf16 v[108:111], a[124:127], v[184:187], v[108:111]
    v_mfma_f32_16x16x32_bf16 v[112:115], a[128:131], v[184:187], v[112:115]
    buffer_load_dwordx4 a[36:39], v253, s[12:15], s77 offen offset:0 sc1
    v_mfma_f32_16x16x32_bf16 v[116:119], a[132:135], v[184:187], v[116:119]
    v_mfma_f32_16x16x32_bf16 v[120:123], a[136:139], v[184:187], v[120:123]
    buffer_load_dwordx4 a[56:59], v253, s[12:15], s77 offen offset:1024 sc1
    v_mfma_f32_16x16x32_bf16 v[124:127], a[120:123], v[188:191], v[124:127]
    v_mfma_f32_16x16x32_bf16 v[128:131], a[124:127], v[188:191], v[128:131]
    buffer_load_dwordx4 a[76:79], v253, s[12:15], s77 offen offset:2048 sc1
    v_mfma_f32_16x16x32_bf16 v[132:135], a[128:131], v[188:191], v[132:135]
    v_mfma_f32_16x16x32_bf16 v[136:139], a[132:135], v[188:191], v[136:139]
    buffer_load_dwordx4 a[96:99], v253, s[12:15], s77 offen offset:3072 sc1
    v_mfma_f32_16x16x32_bf16 v[140:143], a[136:139], v[188:191], v[140:143]
    buffer_load_dwordx4 a[116:119], v253, s[12:15], s73 offen offset:0 sc1
    s_waitcnt vmcnt(14)
    s_waitcnt vmcnt(36)
    v_mfma_f32_16x16x32_bf16 v[64:67], a[140:143], v[192:195], v[64:67]
    v_mfma_f32_16x16x32_bf16 v[68:71], a[144:147], v[192:195], v[68:71]
    v_mfma_f32_16x16x32_bf16 v[72:75], a[148:151], v[192:195], v[72:75]
    v_cmp_gt_u32_e64 vcc, 40, v0
    v_mfma_f32_16x16x32_bf16 v[76:79], a[152:155], v[192:195], v[76:79]
    v_mfma_f32_16x16x32_bf16 v[80:83], a[156:159], v[192:195], v[80:83]
    v_lshlrev_b32_e64 v22, 16, v20
    v_mfma_f32_16x16x32_bf16 v[84:87], a[140:143], v[196:199], v[84:87]
    v_mfma_f32_16x16x32_bf16 v[88:91], a[144:147], v[196:199], v[88:91]
    v_and_b32 v23, 0xffff0000, v20
    v_mfma_f32_16x16x32_bf16 v[92:95], a[148:151], v[196:199], v[92:95]
    v_mfma_f32_16x16x32_bf16 v[96:99], a[152:155], v[196:199], v[96:99]
    v_lshlrev_b32_e64 v24, 16, v21
    v_mfma_f32_16x16x32_bf16 v[100:103], a[156:159], v[196:199], v[100:103]
    v_mfma_f32_16x16x32_bf16 v[104:107], a[140:143], v[200:203], v[104:107]
    v_mfma_f32_16x16x32_bf16 v[108:111], a[144:147], v[200:203], v[108:111]
    v_and_b32 v25, 0xffff0000, v21
    v_mfma_f32_16x16x32_bf16 v[112:115], a[148:151], v[200:203], v[112:115]
    v_mfma_f32_16x16x32_bf16 v[116:119], a[152:155], v[200:203], v[116:119]
    s_mov_b64 exec, vcc
    ds_write_b64 v2, v[22:23]
    ds_write_b64 v2, v[24:25] offset:320
    s_mov_b64 exec, -1
    v_mfma_f32_16x16x32_bf16 v[120:123], a[156:159], v[200:203], v[120:123]
    v_mfma_f32_16x16x32_bf16 v[124:127], a[140:143], v[204:207], v[124:127]
    ds_write_b128 v53, v[8:11]
    v_mfma_f32_16x16x32_bf16 v[128:131], a[144:147], v[204:207], v[128:131]
    v_mfma_f32_16x16x32_bf16 v[132:135], a[148:151], v[204:207], v[132:135]
    ds_write_b128 v53, v[12:15] offset:1024
    v_mfma_f32_16x16x32_bf16 v[136:139], a[152:155], v[204:207], v[136:139]
    v_mfma_f32_16x16x32_bf16 v[140:143], a[156:159], v[204:207], v[140:143]
    s_mov_b64 exec, 0xffffffff
    ds_write_b128 v53, v[16:19] offset:2048
    s_mov_b64 exec, -1
    s_mov_b32 s4, 14876672
    buffer_load_dword v56, v254, s[12:15], s4 offen sc1
    s_waitcnt vmcnt(33)
    s_waitcnt vmcnt(63)
    s_nop 0
    v_mfma_f32_16x16x32_bf16 v[84:87], a[160:163], a[4:7], v[84:87]
    ds_read_b64 v[8:9], v54 offset:0
    ds_read_b64 v[10:11], v54 offset:32
    v_mfma_f32_16x16x32_bf16 v[88:91], a[164:167], a[4:7], v[88:91]
    ds_read_b64 v[12:13], v54 offset:64
    ds_read_b64 v[14:15], v54 offset:96
    v_mfma_f32_16x16x32_bf16 v[92:95], a[168:171], a[4:7], v[92:95]
    ds_read_b64 v[16:17], v54 offset:128
    ds_read_b128 v[160:163], v55 offset:0
    v_mfma_f32_16x16x32_bf16 v[96:99], a[172:175], a[4:7], v[96:99]
    ds_read_b128 v[180:183], v55 offset:320
    ds_read_b128 v[164:167], v55 offset:64
    v_mfma_f32_16x16x32_bf16 v[100:103], a[176:179], a[4:7], v[100:103]
    ds_read_b128 v[184:187], v55 offset:384
    ds_read_b128 v[168:171], v55 offset:128
    s_waitcnt vmcnt(29)
    s_waitcnt vmcnt(63)
    v_mfma_f32_16x16x32_bf16 v[84:87], a[180:183], a[24:27], v[84:87]
    ds_read_b128 v[188:191], v55 offset:448
    ds_read_b128 v[172:175], v55 offset:192
    v_mfma_f32_16x16x32_bf16 v[88:91], a[184:187], a[24:27], v[88:91]
    ds_read_b128 v[192:195], v55 offset:512
    ds_read_b128 v[176:179], v55 offset:256
    v_mfma_f32_16x16x32_bf16 v[92:95], a[188:191], a[24:27], v[92:95]
    ds_read_b128 v[196:199], v55 offset:576
    v_mfma_f32_16x16x32_bf16 v[96:99], a[192:195], a[24:27], v[96:99]
    v_mfma_f32_16x16x32_bf16 v[100:103], a[196:199], a[24:27], v[100:103]
    s_waitcnt vmcnt(25)
    s_waitcnt vmcnt(63)
    v_mfma_f32_16x16x32_bf16 v[84:87], a[200:203], a[44:47], v[84:87]
    v_mfma_f32_16x16x32_bf16 v[88:91], a[204:207], a[44:47], v[88:91]
    s_waitcnt lgkmcnt(0)
    v_lshlrev_b32 v204, 16, v8
    v_and_b32 v205, 0xffff0000, v8
    v_mfma_f32_16x16x32_bf16 v[92:95], a[208:211], a[44:47], v[92:95]
    v_fma_f32 v20, v204, v38, v39
    v_fma_f32 v21, v205, v38, v39
    v_mfma_f32_16x16x32_bf16 v[96:99], a[212:215], a[44:47], v[96:99]
    v_mul_f32 v20, v20, v180
    v_mul_f32 v21, v21, v181
    v_mfma_f32_16x16x32_bf16 v[100:103], a[216:219], a[44:47], v[100:103]
    v_lshlrev_b32_e64 v206, 16, v9
    v_and_b32 v207, 0xffff0000, v9
    s_waitcnt vmcnt(21)
    s_waitcnt vmcnt(63)
    v_mfma_f32_16x16x32_bf16 v[84:87], a[220:223], a[64:67], v[84:87]
    v_fma_f32 v22, v206, v38, v39
    v_fma_f32 v23, v207, v38, v39
    v_mfma_f32_16x16x32_bf16 v[88:91], a[224:227], a[64:67], v[88:91]
    v_mul_f32 v22, v22, v182
    v_mul_f32 v23, v23, v183
    v_mfma_f32_16x16x32_bf16 v[92:95], a[228:231], a[64:67], v[92:95]
    v_lshlrev_b32_e64 v208, 16, v10
    v_and_b32 v209, 0xffff0000, v10
    v_mfma_f32_16x16x32_bf16 v[96:99], a[232:235], a[64:67], v[96:99]
    v_fma_f32 v24, v208, v38, v39
    v_fma_f32 v25, v209, v38, v39
    v_mfma_f32_16x16x32_bf16 v[100:103], a[236:239], a[64:67], v[100:103]
    v_mul_f32 v24, v24, v184
    v_mul_f32 v25, v25, v185
    s_waitcnt vmcnt(11)
    s_waitcnt vmcnt(1)
    v_mfma_f32_16x16x32_bf16 v[84:87], a[240:243], a[84:87], v[84:87]
    v_lshlrev_b32_e64 v210, 16, v11
    v_and_b32 v211, 0xffff0000, v11
    v_mfma_f32_16x16x32_bf16 v[88:91], a[244:247], a[84:87], v[88:91]
    v_fma_f32 v26, v210, v38, v39
    v_fma_f32 v27, v211, v38, v39
    v_mfma_f32_16x16x32_bf16 v[92:95], a[248:251], a[84:87], v[92:95]
    v_mul_f32 v26, v26, v186
    v_mul_f32 v27, v27, v187
    v_mfma_f32_16x16x32_bf16 v[96:99], a[252:255], a[84:87], v[96:99]
    v_lshlrev_b32_e64 v212, 16, v12
    v_and_b32 v213, 0xffff0000, v12
    v_mfma_f32_16x16x32_bf16 v[100:103], a[16:19], a[84:87], v[100:103]
    v_fma_f32 v28, v212, v38, v39
    v_fma_f32 v29, v213, v38, v39
    s_waitcnt vmcnt(7)
    s_waitcnt vmcnt(1)
    v_mfma_f32_16x16x32_bf16 v[84:87], a[36:39], a[104:107], v[84:87]
    v_mul_f32 v28, v28, v188
    v_mul_f32 v29, v29, v189
    v_mfma_f32_16x16x32_bf16 v[88:91], a[56:59], a[104:107], v[88:91]
    v_lshlrev_b32_e64 v214, 16, v13
    v_and_b32 v215, 0xffff0000, v13
    v_mfma_f32_16x16x32_bf16 v[92:95], a[76:79], a[104:107], v[92:95]
    v_fma_f32 v30, v214, v38, v39
    v_fma_f32 v31, v215, v38, v39
    v_mfma_f32_16x16x32_bf16 v[96:99], a[96:99], a[104:107], v[96:99]
    v_mul_f32 v30, v30, v190
    v_mul_f32 v31, v31, v191
    v_mfma_f32_16x16x32_bf16 v[100:103], a[116:119], a[104:107], v[100:103]
    v_mfma_f32_16x16x32_bf16 v[104:107], a[160:163], a[8:11], v[104:107]
    v_lshlrev_b32_e64 v216, 16, v14
    v_and_b32 v217, 0xffff0000, v14
    v_mfma_f32_16x16x32_bf16 v[108:111], a[164:167], a[8:11], v[108:111]
    v_fma_f32 v32, v216, v38, v39
    v_fma_f32 v33, v217, v38, v39
    v_mfma_f32_16x16x32_bf16 v[112:115], a[168:171], a[8:11], v[112:115]
    v_mul_f32 v32, v32, v192
    v_mul_f32 v33, v33, v193
    v_mfma_f32_16x16x32_bf16 v[116:119], a[172:175], a[8:11], v[116:119]
    v_lshlrev_b32_e64 v218, 16, v15
    v_and_b32 v219, 0xffff0000, v15
    v_mfma_f32_16x16x32_bf16 v[120:123], a[176:179], a[8:11], v[120:123]
    v_fma_f32 v34, v218, v38, v39
    v_fma_f32 v35, v219, v38, v39
    v_mfma_f32_16x16x32_bf16 v[104:107], a[180:183], a[28:31], v[104:107]
    ds_write_b128 v3, v[84:87] offset:0
    v_mfma_f32_16x16x32_bf16 v[108:111], a[184:187], a[28:31], v[108:111]
    v_mfma_f32_16x16x32_bf16 v[112:115], a[188:191], a[28:31], v[112:115]
    v_mul_f32 v34, v34, v194
    v_mul_f32 v35, v35, v195
    v_mfma_f32_16x16x32_bf16 v[116:119], a[192:195], a[28:31], v[116:119]
    v_mfma_f32_16x16x32_bf16 v[120:123], a[196:199], a[28:31], v[120:123]
    v_lshlrev_b32_e64 v220, 16, v16
    v_and_b32 v221, 0xffff0000, v16
    v_mfma_f32_16x16x32_bf16 v[104:107], a[200:203], a[48:51], v[104:107]
    ds_write_b128 v3, v[88:91] offset:1024
    v_mfma_f32_16x16x32_bf16 v[108:111], a[204:207], a[48:51], v[108:111]
    v_fma_f32 v36, v220, v38, v39
    v_fma_f32 v37, v221, v38, v39
    v_mfma_f32_16x16x32_bf16 v[112:115], a[208:211], a[48:51], v[112:115]
    v_mfma_f32_16x16x32_bf16 v[116:119], a[212:215], a[48:51], v[116:119]
    v_mul_f32 v36, v36, v196
    v_mul_f32 v37, v37, v197
    v_mfma_f32_16x16x32_bf16 v[120:123], a[216:219], a[48:51], v[120:123]
    v_mfma_f32_16x16x32_bf16 v[104:107], a[220:223], a[68:71], v[104:107]
    ds_write_b128 v3, v[92:95] offset:2048
    v_lshlrev_b32_e64 v222, 16, v17
    v_and_b32 v223, 0xffff0000, v17
    v_mfma_f32_16x16x32_bf16 v[108:111], a[224:227], a[68:71], v[108:111]
    v_mfma_f32_16x16x32_bf16 v[112:115], a[228:231], a[68:71], v[112:115]
    v_fma_f32 v40, v222, v38, v39
    v_fma_f32 v41, v223, v38, v39
    v_mfma_f32_16x16x32_bf16 v[116:119], a[232:235], a[68:71], v[116:119]
    v_mfma_f32_16x16x32_bf16 v[120:123], a[236:239], a[68:71], v[120:123]
    v_mul_f32 v40, v40, v198
    v_mul_f32 v41, v41, v199
    v_mfma_f32_16x16x32_bf16 v[104:107], a[240:243], a[88:91], v[104:107]
    ds_write_b128 v3, v[96:99] offset:3072
    v_mfma_f32_16x16x32_bf16 v[108:111], a[244:247], a[88:91], v[108:111]
    v_mfma_f32_16x16x32_bf16 v[112:115], a[248:251], a[88:91], v[112:115]
    v_mfma_f32_16x16x32_bf16 v[116:119], a[252:255], a[88:91], v[116:119]
    v_mfma_f32_16x16x32_bf16 v[120:123], a[16:19], a[88:91], v[120:123]
    v_mfma_f32_16x16x32_bf16 v[104:107], a[36:39], a[108:111], v[104:107]
    ds_write_b128 v3, v[100:103] offset:4096
    v_mfma_f32_16x16x32_bf16 v[108:111], a[56:59], a[108:111], v[108:111]
    v_mfma_f32_16x16x32_bf16 v[112:115], a[76:79], a[108:111], v[112:115]
    v_mfma_f32_16x16x32_bf16 v[116:119], a[96:99], a[108:111], v[116:119]
    v_mfma_f32_16x16x32_bf16 v[120:123], a[116:119], a[108:111], v[120:123]
    s_waitcnt lgkmcnt(0)
    s_mov_b32 s5, 0
    s_cmp_lg_u32 s3, 0
    s_cbranch_scc1 L_pok_50
    s_waitcnt vmcnt(0)
L_ptop_51:
    v_cmp_eq_u32 vcc, v56, v255
    s_and_b32 s6, vcc_lo, 0xfffff
    s_cbranch_scc0 L_pok_50
    s_add_u32 s5, s5, 1
    s_cmp_gt_u32 s5, 200000
    s_cbranch_scc1 L_pok_50
    s_sleep 8
L_pld_52:
    s_mov_b64 exec, 0xfffff
    s_mov_b32 s4, 14876672
    buffer_load_dword v56, v254, s[12:15], s4 offen sc1
    s_mov_b64 exec, -1
    s_waitcnt vmcnt(0)
    s_branch L_ptop_51
L_pok_50:
    s_barrier
    v_mfma_f32_16x16x32_bf16 v[124:127], a[160:163], a[12:15], v[124:127]
    ds_read_b128 v[84:87], v48 offset:0
    v_lshrrev_b32 v2, 3, v0
    v_lshlrev_b32 v2, 12, v2
    v_mfma_f32_16x16x32_bf16 v[128:131], a[164:167], a[12:15], v[128:131]
    ds_read_b128 v[88:91], v48 offset:1024
    v_and_b32_e64 v7, 7, v0
    v_lshl_add_u32 v2, v7, 4, v2
    v_mfma_f32_16x16x32_bf16 v[132:135], a[168:171], a[12:15], v[132:135]
    ds_read_b128 v[92:95], v48 offset:2048
    s_mul_i32 s4, s75, 80
    s_lshl_b32 s5, s3, 3
    v_mfma_f32_16x16x32_bf16 v[136:139], a[172:175], a[12:15], v[136:139]
    ds_read_b128 v[96:99], v48 offset:3072
    s_add_u32 s4, s4, s5
    s_lshl_b32 s4, s4, 12
    v_mfma_f32_16x16x32_bf16 v[140:143], a[176:179], a[12:15], v[140:143]
    ds_read_b128 v[100:103], v48 offset:4096
    s_lshl_b32 s5, s74, 7
    s_add_u32 s4, s4, s5
    s_nop 0
    v_mfma_f32_16x16x32_bf16 v[124:127], a[180:183], a[32:35], v[124:127]
    s_add_u32 s4, s4, 2686976
    buffer_load_dwordx4 v[144:147], v2, s[12:15], s4 offen sc1
    v_mfma_f32_16x16x32_bf16 v[128:131], a[184:187], a[32:35], v[128:131]
    s_add_u32 s4, s4, 131072
    buffer_load_dwordx4 v[148:151], v2, s[12:15], s4 offen sc1
    v_mfma_f32_16x16x32_bf16 v[132:135], a[188:191], a[32:35], v[132:135]
    s_add_u32 s4, s4, 131072
    s_cmp_lt_u32 s3, 2
    s_nop 0
    v_mfma_f32_16x16x32_bf16 v[136:139], a[192:195], a[32:35], v[136:139]
    s_cselect_b32 s4, s4, 16777216
    buffer_load_dwordx4 v[152:155], v2, s[12:15], s4 offen sc1
    v_mfma_f32_16x16x32_bf16 v[140:143], a[196:199], a[32:35], v[140:143]
    ds_write_b128 v4, v[104:107] offset:0
    v_mfma_f32_16x16x32_bf16 v[124:127], a[200:203], a[52:55], v[124:127]
    v_mfma_f32_16x16x32_bf16 v[128:131], a[204:207], a[52:55], v[128:131]
    s_waitcnt lgkmcnt(1)
    v_add_f32 v160, v160, v84
    v_add_f32_e64 v161, v161, v85
    v_mfma_f32_16x16x32_bf16 v[132:135], a[208:211], a[52:55], v[132:135]
    v_add_f32 v170, v170, v94
    v_add_f32 v171, v171, v95
    v_mfma_f32_16x16x32_bf16 v[136:139], a[212:215], a[52:55], v[136:139]
    ds_write_b128 v4, v[108:111] offset:1024
    v_mfma_f32_16x16x32_bf16 v[140:143], a[216:219], a[52:55], v[140:143]
    v_mfma_f32_16x16x32_bf16 v[124:127], a[220:223], a[72:75], v[124:127]
    v_add_f32 v162, v162, v86
    v_add_f32 v163, v163, v87
    v_mfma_f32_16x16x32_bf16 v[128:131], a[224:227], a[72:75], v[128:131]
    v_add_f32 v172, v172, v96
    v_add_f32 v173, v173, v97
    v_mfma_f32_16x16x32_bf16 v[132:135], a[228:231], a[72:75], v[132:135]
    ds_write_b128 v4, v[112:115] offset:2048
    v_mfma_f32_16x16x32_bf16 v[136:139], a[232:235], a[72:75], v[136:139]
    v_mfma_f32_16x16x32_bf16 v[140:143], a[236:239], a[72:75], v[140:143]
    v_add_f32 v164, v164, v88
    v_add_f32 v165, v165, v89
    v_mfma_f32_16x16x32_bf16 v[124:127], a[240:243], a[92:95], v[124:127]
    v_add_f32 v174, v174, v98
    v_add_f32 v175, v175, v99
    v_mfma_f32_16x16x32_bf16 v[128:131], a[244:247], a[92:95], v[128:131]
    ds_write_b128 v4, v[116:119] offset:3072
    v_mfma_f32_16x16x32_bf16 v[132:135], a[248:251], a[92:95], v[132:135]
    v_mfma_f32_16x16x32_bf16 v[136:139], a[252:255], a[92:95], v[136:139]
    v_add_f32 v166, v166, v90
    v_add_f32 v167, v167, v91
    v_mfma_f32_16x16x32_bf16 v[140:143], a[16:19], a[92:95], v[140:143]
    v_add_f32 v176, v176, v100
    v_add_f32 v177, v177, v101
    v_mfma_f32_16x16x32_bf16 v[124:127], a[36:39], a[112:115], v[124:127]
    ds_write_b128 v4, v[120:123] offset:4096
    v_mfma_f32_16x16x32_bf16 v[128:131], a[56:59], a[112:115], v[128:131]
    v_mfma_f32_16x16x32_bf16 v[132:135], a[76:79], a[112:115], v[132:135]
    v_add_f32 v168, v168, v92
    v_add_f32 v169, v169, v93
    v_mfma_f32_16x16x32_bf16 v[136:139], a[96:99], a[112:115], v[136:139]
    v_add_f32 v178, v178, v102
    v_add_f32 v179, v179, v103
    v_mfma_f32_16x16x32_bf16 v[140:143], a[116:119], a[112:115], v[140:143]
    s_waitcnt lgkmcnt(0)
    s_barrier
    v_mfma_f32_16x16x32_bf16 v[64:67], a[160:163], a[0:3], v[64:67]
    ds_read_b128 v[104:107], v48 offset:5120
    ds_read_b128 v[108:111], v48 offset:6144
    v_mfma_f32_16x16x32_bf16 v[68:71], a[164:167], a[0:3], v[68:71]
    ds_read_b128 v[112:115], v48 offset:7168
    ds_read_b128 v[116:119], v48 offset:8192
    v_mfma_f32_16x16x32_bf16 v[72:75], a[168:171], a[0:3], v[72:75]
    ds_read_b128 v[120:123], v48 offset:9216
    v_mfma_f32_16x16x32_bf16 v[76:79], a[172:175], a[0:3], v[76:79]
    ds_write_b128 v5, v[124:127] offset:0
    v_mfma_f32_16x16x32_bf16 v[80:83], a[176:179], a[0:3], v[80:83]
    v_mfma_f32_16x16x32_bf16 v[64:67], a[180:183], a[20:23], v[64:67]
    v_mfma_f32_16x16x32_bf16 v[68:71], a[184:187], a[20:23], v[68:71]
    ds_write_b128 v5, v[128:131] offset:1024
    v_mfma_f32_16x16x32_bf16 v[72:75], a[188:191], a[20:23], v[72:75]
    s_waitcnt lgkmcnt(2)
    v_add_f32 v160, v160, v104
    v_add_f32_e64 v161, v161, v105
    v_mfma_f32_16x16x32_bf16 v[76:79], a[192:195], a[20:23], v[76:79]
    v_add_f32 v168, v168, v112
    v_add_f32 v169, v169, v113
    v_mfma_f32_16x16x32_bf16 v[80:83], a[196:199], a[20:23], v[80:83]
    ds_write_b128 v5, v[132:135] offset:2048
    v_mfma_f32_16x16x32_bf16 v[64:67], a[200:203], a[40:43], v[64:67]
    v_add_f32 v162, v162, v106
    v_add_f32 v163, v163, v107
    v_mfma_f32_16x16x32_bf16 v[68:71], a[204:207], a[40:43], v[68:71]
    v_add_f32 v170, v170, v114
    v_add_f32 v171, v171, v115
    v_mfma_f32_16x16x32_bf16 v[72:75], a[208:211], a[40:43], v[72:75]
    ds_write_b128 v5, v[136:139] offset:3072
    v_mfma_f32_16x16x32_bf16 v[76:79], a[212:215], a[40:43], v[76:79]
    v_add_f32 v164, v164, v108
    v_add_f32 v165, v165, v109
    v_mfma_f32_16x16x32_bf16 v[80:83], a[216:219], a[40:43], v[80:83]
    v_add_f32 v172, v172, v116
    v_add_f32 v173, v173, v117
    v_mfma_f32_16x16x32_bf16 v[64:67], a[220:223], a[60:63], v[64:67]
    ds_write_b128 v5, v[140:143] offset:4096
    v_mfma_f32_16x16x32_bf16 v[68:71], a[224:227], a[60:63], v[68:71]
    v_add_f32 v166, v166, v110
    v_add_f32 v167, v167, v111
    v_mfma_f32_16x16x32_bf16 v[72:75], a[228:231], a[60:63], v[72:75]
    v_add_f32 v174, v174, v118
    v_add_f32 v175, v175, v119
    v_mfma_f32_16x16x32_bf16 v[76:79], a[232:235], a[60:63], v[76:79]
    s_waitcnt vmcnt(0)
    ds_write_b128 v6, v[144:147] offset:0
    v_mfma_f32_16x16x32_bf16 v[80:83], a[236:239], a[60:63], v[80:83]
    v_add_f32 v176, v176, v120
    v_add_f32_e64 v177, v177, v121
    v_mfma_f32_16x16x32_bf16 v[64:67], a[240:243], a[80:83], v[64:67]
    v_add_f32 v178, v178, v122
    v_add_f32 v179, v179, v123
    v_mfma_f32_16x16x32_bf16 v[68:71], a[244:247], a[80:83], v[68:71]
    ds_write_b128 v6, v[148:151] offset:4096
    v_mfma_f32_16x16x32_bf16 v[72:75], a[248:251], a[80:83], v[72:75]
    v_mfma_f32_16x16x32_bf16 v[76:79], a[252:255], a[80:83], v[76:79]
    v_mfma_f32_16x16x32_bf16 v[80:83], a[16:19], a[80:83], v[80:83]
    ds_write_b128 v6, v[152:155] offset:8192
    v_mfma_f32_16x16x32_bf16 v[64:67], a[36:39], a[100:103], v[64:67]
    v_mfma_f32_16x16x32_bf16 v[68:71], a[56:59], a[100:103], v[68:71]
    v_mfma_f32_16x16x32_bf16 v[72:75], a[76:79], a[100:103], v[72:75]
    v_mfma_f32_16x16x32_bf16 v[76:79], a[96:99], a[100:103], v[76:79]
    s_waitcnt lgkmcnt(0)
    s_barrier
    v_mfma_f32_16x16x32_bf16 v[80:83], a[116:119], a[100:103], v[80:83]
    ds_read_b128 v[124:127], v48 offset:10240
    ds_read_b128 v[128:131], v48 offset:11264
    ds_read_b128 v[132:135], v48 offset:12288
    ds_read_b128 v[136:139], v48 offset:13312
    ds_read_b128 v[140:143], v48 offset:14336
    ds_read_b64_tr_b16 v[8:9], v49 offset:0
    ds_read_b64_tr_b16 v[10:11], v49 offset:2048
    ds_read_b64_tr_b16 v[12:13], v49 offset:4096
    ds_read_b64_tr_b16 v[14:15], v49 offset:6144
    ds_read_b64_tr_b16 v[16:17], v49 offset:8192
    s_mov_b32 s6, 0xbfb8aa3b
    s_mov_b32 s7, 0xbfb8aa3b
    v_pk_add_f32 v[64:65], v[64:65], v[160:161]
    v_pk_add_f32 v[66:67], v[66:67], v[162:163]
    v_pk_add_f32 v[68:69], v[68:69], v[164:165]
    v_pk_add_f32 v[70:71], v[70:71], v[166:167]
    v_pk_add_f32 v[72:73], v[72:73], v[168:169]
    v_pk_add_f32 v[74:75], v[74:75], v[170:171]
    v_pk_add_f32 v[76:77], v[76:77], v[172:173]
    v_pk_add_f32 v[78:79], v[78:79], v[174:175]
    v_pk_add_f32 v[80:81], v[80:81], v[176:177]
    v_pk_add_f32 v[82:83], v[82:83], v[178:179]
    s_waitcnt lgkmcnt(5)
    s_nop 0
    v_pk_add_f32 v[64:65], v[64:65], v[124:125]
    v_pk_add_f32 v[66:67], v[66:67], v[126:127]
    v_pk_add_f32 v[68:69], v[68:69], v[128:129]
    v_pk_add_f32 v[70:71], v[70:71], v[130:131]
    v_pk_add_f32 v[72:73], v[72:73], v[132:133]
    v_pk_add_f32 v[74:75], v[74:75], v[134:135]
    v_pk_add_f32 v[76:77], v[76:77], v[136:137]
    v_pk_add_f32 v[78:79], v[78:79], v[138:139]
    v_pk_add_f32 v[80:81], v[80:81], v[140:141]
    v_pk_add_f32 v[82:83], v[82:83], v[142:143]
    s_waitcnt lgkmcnt(0)
    v_lshlrev_b32 v84, 16, v8
    v_and_b32 v85, 0xffff0000, v8
    v_pk_add_f32 v[20:21], v[20:21], v[84:85]
    v_lshlrev_b32_e64 v84, 16, v9
    v_and_b32 v85, 0xffff0000, v9
    v_pk_add_f32 v[22:23], v[22:23], v[84:85]
    v_lshlrev_b32_e64 v84, 16, v10
    v_and_b32 v85, 0xffff0000, v10
    v_pk_add_f32 v[24:25], v[24:25], v[84:85]
    v_lshlrev_b32_e64 v84, 16, v11
    v_and_b32 v85, 0xffff0000, v11
    v_pk_add_f32 v[26:27], v[26:27], v[84:85]
    v_lshlrev_b32_e64 v84, 16, v12
    v_and_b32 v85, 0xffff0000, v12
    v_pk_add_f32 v[28:29], v[28:29], v[84:85]
    v_lshlrev_b32_e64 v84, 16, v13
    v_and_b32 v85, 0xffff0000, v13
    v_pk_add_f32 v[30:31], v[30:31], v[84:85]
    v_lshlrev_b32_e64 v84, 16, v14
    v_and_b32 v85, 0xffff0000, v14
    v_pk_add_f32 v[32:33], v[32:33], v[84:85]
    v_lshlrev_b32_e64 v84, 16, v15
    v_and_b32 v85, 0xffff0000, v15
    v_pk_add_f32 v[34:35], v[34:35], v[84:85]
    v_lshlrev_b32_e64 v84, 16, v16
    v_and_b32 v85, 0xffff0000, v16
    v_pk_add_f32 v[36:37], v[36:37], v[84:85]
    v_lshlrev_b32_e64 v84, 16, v17
    v_and_b32 v85, 0xffff0000, v17
    v_pk_add_f32 v[40:41], v[40:41], v[84:85]
    v_pk_mul_f32 v[84:85], v[64:65], s[6:7]
    v_pk_mul_f32 v[86:87], v[66:67], s[6:7]
    v_pk_mul_f32 v[88:89], v[68:69], s[6:7]
    v_pk_mul_f32 v[90:91], v[70:71], s[6:7]
    v_pk_mul_f32 v[92:93], v[72:73], s[6:7]
    v_pk_mul_f32 v[94:95], v[74:75], s[6:7]
    v_pk_mul_f32 v[96:97], v[76:77], s[6:7]
    v_pk_mul_f32 v[98:99], v[78:79], s[6:7]
    v_pk_mul_f32 v[100:101], v[80:81], s[6:7]
    v_pk_mul_f32 v[102:103], v[82:83], s[6:7]
    v_exp_f32 v84, v84
    v_exp_f32 v85, v85
    v_exp_f32 v86, v86
    v_exp_f32 v87, v87
    v_exp_f32 v88, v88
    v_exp_f32 v89, v89
    v_exp_f32 v90, v90
    v_exp_f32 v91, v91
    v_exp_f32 v92, v92
    v_exp_f32 v93, v93
    v_exp_f32 v94, v94
    v_exp_f32 v95, v95
    v_exp_f32 v96, v96
    v_exp_f32 v97, v97
    v_exp_f32 v98, v98
    v_exp_f32 v99, v99
    v_exp_f32 v100, v100
    v_exp_f32 v101, v101
    v_exp_f32 v102, v102
    v_exp_f32 v103, v103
    v_pk_add_f32 v[84:85], v[84:85], 1.0 op_sel_hi:[1,0]
    v_pk_add_f32 v[86:87], v[86:87], 1.0 op_sel_hi:[1,0]
    v_pk_add_f32 v[88:89], v[88:89], 1.0 op_sel_hi:[1,0]
    v_pk_add_f32 v[90:91], v[90:91], 1.0 op_sel_hi:[1,0]
    v_pk_add_f32 v[92:93], v[92:93], 1.0 op_sel_hi:[1,0]
    v_pk_add_f32 v[94:95], v[94:95], 1.0 op_sel_hi:[1,0]
    v_pk_add_f32 v[96:97], v[96:97], 1.0 op_sel_hi:[1,0]
    v_pk_add_f32 v[98:99], v[98:99], 1.0 op_sel_hi:[1,0]
    v_pk_add_f32 v[100:101], v[100:101], 1.0 op_sel_hi:[1,0]
    v_pk_add_f32 v[102:103], v[102:103], 1.0 op_sel_hi:[1,0]
    v_rcp_f32 v84, v84
    v_rcp_f32 v85, v85
    v_rcp_f32 v86, v86
    v_rcp_f32 v87, v87
    v_rcp_f32 v88, v88
    v_rcp_f32 v89, v89
    v_rcp_f32 v90, v90
    v_rcp_f32 v91, v91
    v_rcp_f32 v92, v92
    v_rcp_f32 v93, v93
    v_rcp_f32 v94, v94
    v_rcp_f32 v95, v95
    v_rcp_f32 v96, v96
    v_rcp_f32 v97, v97
    v_rcp_f32 v98, v98
    v_rcp_f32 v99, v99
    v_rcp_f32 v100, v100
    v_rcp_f32 v101, v101
    v_rcp_f32 v102, v102
    v_rcp_f32 v103, v103
    v_pk_mul_f32 v[20:21], v[20:21], v[64:65]
    v_pk_mul_f32 v[22:23], v[22:23], v[66:67]
    v_pk_mul_f32 v[24:25], v[24:25], v[68:69]
    v_pk_mul_f32 v[26:27], v[26:27], v[70:71]
    v_pk_mul_f32 v[28:29], v[28:29], v[72:73]
    v_pk_mul_f32 v[30:31], v[30:31], v[74:75]
    v_pk_mul_f32 v[32:33], v[32:33], v[76:77]
    v_pk_mul_f32 v[34:35], v[34:35], v[78:79]
    v_pk_mul_f32 v[36:37], v[36:37], v[80:81]
    v_pk_mul_f32 v[40:41], v[40:41], v[82:83]
    v_pk_fma_f32 v[20:21], v[20:21], v[84:85], v[204:205]
    v_cvt_pk_bf16_f32 v8, v20, v21
    v_pk_fma_f32 v[22:23], v[22:23], v[86:87], v[206:207]
    v_cvt_pk_bf16_f32 v9, v22, v23
    v_pk_fma_f32 v[24:25], v[24:25], v[88:89], v[208:209]
    v_cvt_pk_bf16_f32 v10, v24, v25
    v_pk_fma_f32 v[26:27], v[26:27], v[90:91], v[210:211]
    v_cvt_pk_bf16_f32 v11, v26, v27
    v_pk_fma_f32 v[28:29], v[28:29], v[92:93], v[212:213]
    v_cvt_pk_bf16_f32 v12, v28, v29
    v_pk_fma_f32 v[30:31], v[30:31], v[94:95], v[214:215]
    v_cvt_pk_bf16_f32 v13, v30, v31
    v_pk_fma_f32 v[32:33], v[32:33], v[96:97], v[216:217]
    v_cvt_pk_bf16_f32 v14, v32, v33
    v_pk_fma_f32 v[34:35], v[34:35], v[98:99], v[218:219]
    v_cvt_pk_bf16_f32 v15, v34, v35
    v_pk_fma_f32 v[36:37], v[36:37], v[100:101], v[220:221]
    v_cvt_pk_bf16_f32 v16, v36, v37
    v_pk_fma_f32 v[40:41], v[40:41], v[102:103], v[222:223]
    v_cvt_pk_bf16_f32 v17, v40, v41
    ds_write_b64 v54, v[8:9] offset:0
    ds_write_b64 v54, v[10:11] offset:32
    ds_write_b64 v54, v[12:13] offset:64
    ds_write_b64 v54, v[14:15] offset:96
    ds_write_b64 v54, v[16:17] offset:128
    ds_read_b128 v[84:87], v53 offset:0
    ds_read_b128 v[88:91], v53 offset:1024
    ds_read_b128 v[92:95], v53 offset:2048
    s_mov_b32 s20, s60
    s_mov_b32 s21, s61
    s_mov_b32 s22, 2621440
    s_mov_b32 s23, 0x00020000
    s_waitcnt lgkmcnt(2)
    buffer_store_dwordx4 v[84:87], v50, s[20:23], s35 offen
    s_waitcnt lgkmcnt(1)
    buffer_store_dwordx4 v[88:91], v51, s[20:23], s35 offen
    s_waitcnt lgkmcnt(0)
    buffer_store_dwordx4 v[92:95], v52, s[20:23], s35 offen
    s_endpgm
recurrent_scan__ssm_conv_s4d__mixer_channel_mlp__prompt_kernel_end:
    s_endpgm
.section .rodata,"a"
.p2align 6
.amdhsa_kernel recurrent_scan__ssm_conv_s4d__mixer_channel_mlp__prompt_kernel
  .amdhsa_next_free_vgpr 512
  .amdhsa_next_free_sgpr 102
  .amdhsa_accum_offset 256
  .amdhsa_group_segment_fixed_size 0
  .amdhsa_kernarg_size 120
  .amdhsa_user_sgpr_count 2
  .amdhsa_user_sgpr_kernarg_segment_ptr 1
  .amdhsa_system_sgpr_workgroup_id_x 1
.end_amdhsa_kernel
```
